```python
import torch

def _softmax(x, axis=-1):
    return torch.softmax(x, dim=axis)
def _gelu(x):
    return torch.nn.functional.gelu(x, approximate="tanh")
def _silu(x):
    return torch.nn.functional.silu(x)
def _sigmoid(x):
    return torch.sigmoid(x)
def _layernorm(x, axis=-1, eps=1e-5):
    m = x.mean(dim=axis, keepdim=True)
    v = x.var(dim=axis, keepdim=True, unbiased=False)
    return (x - m) / torch.sqrt(v + eps)
def _scatter_add(tgt, idx, src, axis=0):
    return tgt.clone().index_add_(axis, idx, src)
def _segment_sum(src, seg, n):
    out = torch.zeros((n,) + src.shape[1:], dtype=src.dtype)
    return out.index_add_(0, seg, src)
def _pad(x, pw):
    flat = tuple(v for pair in reversed(pw) for v in pair)
    return torch.nn.functional.pad(x, flat)

kernel_name = 'standalone__mha_softmax__near_ridge'

def setup_inputs():

    _w = (lambda a: (lambda t: t.to(torch.bfloat16) if t.is_floating_point() else t)(torch.as_tensor(a)))
    B, H, Sq, Sk, D = 16, 32, 256, 512, 128
    return {
        "q": _w((lambda *s: torch.randn(*s, dtype=torch.bfloat16) * 0.8)(B, H, Sq, D)),
        "k": _w((lambda *s: torch.randn(*s, dtype=torch.bfloat16) * 0.8)(B, H, Sk, D)),
        "v": _w((lambda *s: torch.randn(*s, dtype=torch.bfloat16) * 0.05)(B, H, Sk, D)),
    }

def reference(q, k, v):
    scale = q.shape[-1] ** -0.5
    scores = torch.einsum("bhqd,bhkd->bhqk", q, k) * scale
    p = _softmax(scores, axis=-1)
    return torch.einsum("bhqk,bhkd->bhqd", p, v)
```

```asm
; @launch grid=(256,1,1) block=(256,1,1) lds=149504
.amdgcn_target "amdgcn-amd-amdhsa--gfx950"
.text
.globl standalone__mha_softmax__near_ridge_kernel
.p2align 8
.type standalone__mha_softmax__near_ridge_kernel,@function
standalone__mha_softmax__near_ridge_kernel:
    s_cmp_ge_u32 s2, 256
    s_cbranch_scc1 L_end
    s_load_dwordx4 s[4:7], s[0:1], 0
    s_load_dwordx4 s[8:11], s[0:1], 16
    v_lshrrev_b32 v30, 6, v0
    v_and_b32 v0, 63, v0
    v_bfe_u32 v31, v0, 2, 2
    v_readfirstlane_b32 s28, v30
    v_lshlrev_b32 v29, 8, v31
    v_lshrrev_b32 v28, 4, v0
    v_lshl_add_u32 v29, v28, 6, v29
    v_and_b32 v27, 3, v0
    v_lshl_add_u32 v29, v27, 4, v29
    v_lshl_add_u32 v1, v30, 11, v29
    v_lshl_add_u32 v2, v30, 14, v29
    s_mul_i32 s29, s28, 4128
    s_mul_i32 s30, s28, 4352
    s_add_u32 s30, s30, 132096
    s_lshl_b32 s3, s2, 17
    s_lshl_b32 s38, s2, 18
    s_mov_b32 s14, 131072
    s_mov_b32 s15, 0x20000
    s_mov_b32 s18, 262144
    s_mov_b32 s19, 0x20000
    s_mov_b32 s22, 262144
    s_mov_b32 s23, 0x20000
    s_mov_b32 s26, 131072
    s_mov_b32 s27, 0x20000
    s_waitcnt lgkmcnt(0)
    s_add_u32 s16, s6, s38
    s_addc_u32 s17, s7, 0
    s_add_u32 s12, s4, s3
    s_addc_u32 s13, s5, 0
    s_add_u32 s20, s8, s38
    s_addc_u32 s21, s9, 0
    s_add_u32 s24, s10, s3
    s_addc_u32 s25, s11, 0
    s_add_u32 m0, s30, 0
    s_mov_b32 s37, 0
    buffer_load_dwordx4 v2, s[12:15], s37 offen nt lds
    buffer_load_dwordx4 v2, s[12:15], s37 offen offset:1024 nt lds
    s_add_u32 m0, s30, 2080
    s_mov_b32 s37, 2048
    buffer_load_dwordx4 v2, s[12:15], s37 offen nt lds
    buffer_load_dwordx4 v2, s[12:15], s37 offen offset:1024 nt lds
    s_add_u32 m0, s29, 66048
    s_mov_b32 s37, 0
    buffer_load_dwordx4 v1, s[16:19], s37 offen nt lds
    buffer_load_dwordx4 v1, s[16:19], s37 offen offset:1024 nt lds
    s_add_u32 m0, s29, 82560
    s_mov_b32 s37, 4096
    buffer_load_dwordx4 v2, s[12:15], s37 offen nt lds
    buffer_load_dwordx4 v2, s[12:15], s37 offen offset:1024 nt lds
    s_add_u32 m0, s29, 84640
    s_mov_b32 s37, 6144
    buffer_load_dwordx4 v2, s[12:15], s37 offen nt lds
    buffer_load_dwordx4 v2, s[12:15], s37 offen offset:1024 nt lds
    s_add_u32 m0, s29, 2048
    s_mov_b32 s37, 0
    buffer_load_dwordx4 v1, s[20:23], s37 offen nt lds
    s_add_u32 m0, m0, 32
    s_nop 0
    buffer_load_dwordx4 v1, s[20:23], s37 offen offset:1024 nt lds
    s_getpc_b64 s[52:53]
    s_lshr_b32 s3, s2, 3
    s_add_u32 s3, s3, s2
    s_and_b32 s3, s3, 7
    s_lshl_b32 s3, s3, 2
    s_add_u32 s3, s3, s28
    s_lshl_b32 s3, s3, 11
    v_and_b32 v24, 15, v0
    v_lshlrev_b32 v24, 7, v24
    v_add_u32 v24, s3, v24
    v_min_u32 v24, 0xb500, v24
    global_load_dword v22, v24, s[52:53]
    v_lshlrev_b32 v26, 6, v27
    v_lshl_add_u32 v26, v28, 4, v26
    v_bfe_u32 v31, v0, 2, 1
    v_lshl_add_u32 v26, v31, 10, v26
    v_bfe_u32 v31, v0, 3, 1
    v_mul_u32_u24 v25, 4128, v31
    v_add_u32 v3, v25, v26
    v_add_u32 v4, 66048, v3
    v_mul_u32_u24 v25, 2080, v31
    v_add3_u32 v7, v25, v26, s30
    v_add3_u32 v8, v25, v26, s29
    v_add_u32 v8, 66048, v8
    v_lshrrev_b32 v31, 1, v28
    v_mul_u32_u24 v25, 4128, v31
    v_and_b32 v31, 1, v28
    v_mul_u32_u24 v26, 1056, v31
    v_bfe_u32 v31, v0, 2, 2
    v_lshl_add_u32 v26, v31, 6, v26
    v_lshl_add_u32 v26, v27, 3, v26
    v_add_u32 v26, 2048, v26
    v_add_u32 v5, v25, v26
    v_add_u32 v6, 66048, v5
    v_and_b32 v31, 15, v0
    v_mul_u32_u24 v25, 272, v31
    v_lshlrev_b32 v26, 3, v28
    v_add3_u32 v9, v25, v26, s30
    v_mul_u32_u24 v25, 272, v28
    v_lshlrev_b32 v26, 4, v31
    v_add3_u32 v10, v25, v26, s30
    v_lshlrev_b32 v31, 4, v0
    v_lshl_add_u32 v11, v30, 14, v31
    v_mov_b32 v31, 0x3f803f80
    s_mov_b32 s39, 0x3e0293ee
    s_mov_b32 s40, 0x5d800000
    s_mov_b64 s[44:45], 0
    s_mov_b64 s[46:47], 0
    v_accvgpr_write_b32 a128, v31
    v_accvgpr_write_b32 a129, v31
    v_accvgpr_write_b32 a130, v31
    v_accvgpr_write_b32 a131, v31
    s_add_u32 m0, s29, 0
    s_mov_b32 s37, 8192
    buffer_load_dwordx4 v1, s[16:19], s37 offen nt lds
    buffer_load_dwordx4 v1, s[16:19], s37 offen offset:1024 nt lds
    s_add_u32 m0, s29, 99072
    s_mov_b32 s37, 8192
    buffer_load_dwordx4 v2, s[12:15], s37 offen nt lds
    buffer_load_dwordx4 v2, s[12:15], s37 offen offset:1024 nt lds
    s_add_u32 m0, s29, 101152
    s_mov_b32 s37, 10240
    buffer_load_dwordx4 v2, s[12:15], s37 offen nt lds
    buffer_load_dwordx4 v2, s[12:15], s37 offen offset:1024 nt lds
    s_waitcnt vmcnt(15)
    ds_read_b128 v[112:115], v7 offset:0
    ds_read_b128 v[116:119], v7 offset:256
    ds_read_b128 v[120:123], v7 offset:512
    ds_read_b128 v[124:127], v7 offset:768
    s_waitcnt lgkmcnt(3)
    v_lshlrev_b32 v28, 16, v112
    v_and_b32 v29, 0xffff0000, v112
    v_mul_f32 v28, s39, v28
    v_mul_f32 v29, s39, v29
    v_cvt_pk_bf16_f32 v28, v28, v29
    v_accvgpr_write_b32 a0, v28
    v_lshlrev_b32 v30, 16, v113
    v_and_b32 v31, 0xffff0000, v113
    v_mul_f32 v30, s39, v30
    v_mul_f32 v31, s39, v31
    v_cvt_pk_bf16_f32 v30, v30, v31
    v_accvgpr_write_b32 a1, v30
    v_lshlrev_b32 v28, 16, v114
    v_and_b32 v29, 0xffff0000, v114
    v_mul_f32 v28, s39, v28
    v_mul_f32 v29, s39, v29
    v_cvt_pk_bf16_f32 v28, v28, v29
    v_accvgpr_write_b32 a2, v28
    v_lshlrev_b32 v30, 16, v115
    v_and_b32 v31, 0xffff0000, v115
    v_mul_f32 v30, s39, v30
    v_mul_f32 v31, s39, v31
    v_cvt_pk_bf16_f32 v30, v30, v31
    v_accvgpr_write_b32 a3, v30
    s_waitcnt lgkmcnt(2)
    v_lshlrev_b32 v28, 16, v116
    v_and_b32 v29, 0xffff0000, v116
    v_mul_f32 v28, s39, v28
    v_mul_f32 v29, s39, v29
    v_cvt_pk_bf16_f32 v28, v28, v29
    v_accvgpr_write_b32 a4, v28
    v_lshlrev_b32 v30, 16, v117
    v_and_b32 v31, 0xffff0000, v117
    v_mul_f32 v30, s39, v30
    v_mul_f32 v31, s39, v31
    v_cvt_pk_bf16_f32 v30, v30, v31
    v_accvgpr_write_b32 a5, v30
    v_lshlrev_b32 v28, 16, v118
    v_and_b32 v29, 0xffff0000, v118
    v_mul_f32 v28, s39, v28
    v_mul_f32 v29, s39, v29
    v_cvt_pk_bf16_f32 v28, v28, v29
    v_accvgpr_write_b32 a6, v28
    v_lshlrev_b32 v30, 16, v119
    v_and_b32 v31, 0xffff0000, v119
    v_mul_f32 v30, s39, v30
    v_mul_f32 v31, s39, v31
    v_cvt_pk_bf16_f32 v30, v30, v31
    v_accvgpr_write_b32 a7, v30
    s_waitcnt lgkmcnt(1)
    v_lshlrev_b32 v28, 16, v120
    v_and_b32 v29, 0xffff0000, v120
    v_mul_f32 v28, s39, v28
    v_mul_f32 v29, s39, v29
    v_cvt_pk_bf16_f32 v28, v28, v29
    v_accvgpr_write_b32 a8, v28
    v_lshlrev_b32 v30, 16, v121
    v_and_b32 v31, 0xffff0000, v121
    v_mul_f32 v30, s39, v30
    v_mul_f32 v31, s39, v31
    v_cvt_pk_bf16_f32 v30, v30, v31
    v_accvgpr_write_b32 a9, v30
    v_lshlrev_b32 v28, 16, v122
    v_and_b32 v29, 0xffff0000, v122
    v_mul_f32 v28, s39, v28
    v_mul_f32 v29, s39, v29
    v_cvt_pk_bf16_f32 v28, v28, v29
    v_accvgpr_write_b32 a10, v28
    v_lshlrev_b32 v30, 16, v123
    v_and_b32 v31, 0xffff0000, v123
    v_mul_f32 v30, s39, v30
    v_mul_f32 v31, s39, v31
    v_cvt_pk_bf16_f32 v30, v30, v31
    v_accvgpr_write_b32 a11, v30
    s_waitcnt lgkmcnt(0)
    v_lshlrev_b32 v28, 16, v124
    v_and_b32 v29, 0xffff0000, v124
    v_mul_f32 v28, s39, v28
    v_mul_f32 v29, s39, v29
    v_cvt_pk_bf16_f32 v28, v28, v29
    v_accvgpr_write_b32 a12, v28
    v_lshlrev_b32 v30, 16, v125
    v_and_b32 v31, 0xffff0000, v125
    v_mul_f32 v30, s39, v30
    v_mul_f32 v31, s39, v31
    v_cvt_pk_bf16_f32 v30, v30, v31
    v_accvgpr_write_b32 a13, v30
    v_lshlrev_b32 v28, 16, v126
    v_and_b32 v29, 0xffff0000, v126
    v_mul_f32 v28, s39, v28
    v_mul_f32 v29, s39, v29
    v_cvt_pk_bf16_f32 v28, v28, v29
    v_accvgpr_write_b32 a14, v28
    v_lshlrev_b32 v30, 16, v127
    v_and_b32 v31, 0xffff0000, v127
    v_mul_f32 v30, s39, v30
    v_mul_f32 v31, s39, v31
    v_cvt_pk_bf16_f32 v30, v30, v31
    v_accvgpr_write_b32 a15, v30
    s_add_u32 m0, s29, 115584
    s_mov_b32 s37, 12288
    buffer_load_dwordx4 v2, s[12:15], s37 offen nt lds
    buffer_load_dwordx4 v2, s[12:15], s37 offen offset:1024 nt lds
    s_add_u32 m0, s29, 117664
    s_mov_b32 s37, 14336
    buffer_load_dwordx4 v2, s[12:15], s37 offen nt lds
    buffer_load_dwordx4 v2, s[12:15], s37 offen offset:1024 nt lds
    s_waitcnt vmcnt(17)
    s_barrier
    ds_read_b128 a[64:67], v4 offset:0
    ds_read_b128 a[68:71], v4 offset:8256
    ds_read_b128 a[72:75], v4 offset:256
    ds_read_b128 a[76:79], v4 offset:8512
    ds_read_b128 a[80:83], v4 offset:512
    ds_read_b128 a[84:87], v4 offset:8768
    ds_read_b128 a[88:91], v4 offset:768
    ds_read_b128 a[92:95], v4 offset:9024
    s_waitcnt vmcnt(13)
    ds_read_b128 v[112:115], v8 offset:16512
    ds_read_b128 v[116:119], v8 offset:16768
    ds_read_b128 v[120:123], v8 offset:17024
    ds_read_b128 v[124:127], v8 offset:17280
    s_waitcnt lgkmcnt(3)
    v_lshlrev_b32 v28, 16, v112
    v_and_b32 v29, 0xffff0000, v112
    v_mul_f32 v28, s39, v28
    v_mul_f32 v29, s39, v29
    v_cvt_pk_bf16_f32 v28, v28, v29
    v_accvgpr_write_b32 a16, v28
    v_lshlrev_b32 v30, 16, v113
    v_and_b32 v31, 0xffff0000, v113
    v_mul_f32 v30, s39, v30
    v_mul_f32 v31, s39, v31
    v_cvt_pk_bf16_f32 v30, v30, v31
    v_accvgpr_write_b32 a17, v30
    v_lshlrev_b32 v28, 16, v114
    v_and_b32 v29, 0xffff0000, v114
    v_mul_f32 v28, s39, v28
    v_mul_f32 v29, s39, v29
    v_cvt_pk_bf16_f32 v28, v28, v29
    v_accvgpr_write_b32 a18, v28
    v_lshlrev_b32 v30, 16, v115
    v_and_b32 v31, 0xffff0000, v115
    v_mul_f32 v30, s39, v30
    v_mul_f32 v31, s39, v31
    v_cvt_pk_bf16_f32 v30, v30, v31
    v_accvgpr_write_b32 a19, v30
    s_waitcnt lgkmcnt(2)
    v_lshlrev_b32 v28, 16, v116
    v_and_b32 v29, 0xffff0000, v116
    v_mul_f32 v28, s39, v28
    v_mul_f32 v29, s39, v29
    v_cvt_pk_bf16_f32 v28, v28, v29
    v_accvgpr_write_b32 a20, v28
    v_lshlrev_b32 v30, 16, v117
    v_and_b32 v31, 0xffff0000, v117
    v_mul_f32 v30, s39, v30
    v_mul_f32 v31, s39, v31
    v_cvt_pk_bf16_f32 v30, v30, v31
    v_accvgpr_write_b32 a21, v30
    v_lshlrev_b32 v28, 16, v118
    v_and_b32 v29, 0xffff0000, v118
    v_mul_f32 v28, s39, v28
    v_mul_f32 v29, s39, v29
    v_cvt_pk_bf16_f32 v28, v28, v29
    v_accvgpr_write_b32 a22, v28
    v_lshlrev_b32 v30, 16, v119
    v_and_b32 v31, 0xffff0000, v119
    v_mul_f32 v30, s39, v30
    v_mul_f32 v31, s39, v31
    v_cvt_pk_bf16_f32 v30, v30, v31
    v_accvgpr_write_b32 a23, v30
    s_waitcnt lgkmcnt(1)
    v_lshlrev_b32 v28, 16, v120
    v_and_b32 v29, 0xffff0000, v120
    v_mul_f32 v28, s39, v28
    v_mul_f32 v29, s39, v29
    v_cvt_pk_bf16_f32 v28, v28, v29
    v_accvgpr_write_b32 a24, v28
    v_lshlrev_b32 v30, 16, v121
    v_and_b32 v31, 0xffff0000, v121
    v_mul_f32 v30, s39, v30
    v_mul_f32 v31, s39, v31
    v_cvt_pk_bf16_f32 v30, v30, v31
    v_accvgpr_write_b32 a25, v30
    v_lshlrev_b32 v28, 16, v122
    v_and_b32 v29, 0xffff0000, v122
    v_mul_f32 v28, s39, v28
    v_mul_f32 v29, s39, v29
    v_cvt_pk_bf16_f32 v28, v28, v29
    v_accvgpr_write_b32 a26, v28
    v_lshlrev_b32 v30, 16, v123
    v_and_b32 v31, 0xffff0000, v123
    v_mul_f32 v30, s39, v30
    v_mul_f32 v31, s39, v31
    v_cvt_pk_bf16_f32 v30, v30, v31
    v_accvgpr_write_b32 a27, v30
    s_waitcnt lgkmcnt(0)
    v_lshlrev_b32 v28, 16, v124
    v_and_b32 v29, 0xffff0000, v124
    v_mul_f32 v28, s39, v28
    v_mul_f32 v29, s39, v29
    v_cvt_pk_bf16_f32 v28, v28, v29
    v_accvgpr_write_b32 a28, v28
    v_lshlrev_b32 v30, 16, v125
    v_and_b32 v31, 0xffff0000, v125
    v_mul_f32 v30, s39, v30
    v_mul_f32 v31, s39, v31
    v_cvt_pk_bf16_f32 v30, v30, v31
    v_accvgpr_write_b32 a29, v30
    v_lshlrev_b32 v28, 16, v126
    v_and_b32 v29, 0xffff0000, v126
    v_mul_f32 v28, s39, v28
    v_mul_f32 v29, s39, v29
    v_cvt_pk_bf16_f32 v28, v28, v29
    v_accvgpr_write_b32 a30, v28
    v_lshlrev_b32 v30, 16, v127
    v_and_b32 v31, 0xffff0000, v127
    v_mul_f32 v30, s39, v30
    v_mul_f32 v31, s39, v31
    v_cvt_pk_bf16_f32 v30, v30, v31
    v_accvgpr_write_b32 a31, v30
    s_add_u32 m0, s29, 16512
    s_mov_b32 s37, 16384
    buffer_load_dwordx4 v1, s[16:19], s37 offen nt lds
    buffer_load_dwordx4 v1, s[16:19], s37 offen offset:1024 nt lds
    s_add_u32 m0, s29, 18560
    s_mov_b32 s37, 8192
    buffer_load_dwordx4 v1, s[20:23], s37 offen nt lds
    s_add_u32 m0, m0, 32
    s_nop 0
    buffer_load_dwordx4 v1, s[20:23], s37 offen offset:1024 nt lds
    v_mfma_f32_16x16x32_bf16 v[32:35], a[64:67], a[0:3], 0
    v_mfma_f32_16x16x32_bf16 v[36:39], a[68:71], a[0:3], 0
    v_mfma_f32_16x16x32_bf16 v[32:35], a[72:75], a[4:7], v[32:35]
    v_mfma_f32_16x16x32_bf16 v[36:39], a[76:79], a[4:7], v[36:39]
    v_mfma_f32_16x16x32_bf16 v[32:35], a[80:83], a[8:11], v[32:35]
    v_mfma_f32_16x16x32_bf16 v[36:39], a[84:87], a[8:11], v[36:39]
    v_mfma_f32_16x16x32_bf16 v[32:35], a[88:91], a[12:15], v[32:35]
    v_mfma_f32_16x16x32_bf16 v[36:39], a[92:95], a[12:15], v[36:39]
    s_waitcnt vmcnt(12) lgkmcnt(0)
    s_barrier
    v_mfma_f32_16x16x32_bf16 v[40:43], a[64:67], a[16:19], 0
    s_waitcnt vmcnt(8)
    ds_read_b128 v[112:115], v8 offset:33024
    ds_read_b128 v[116:119], v8 offset:33280
    ds_read_b128 v[120:123], v8 offset:33536
    ds_read_b128 v[124:127], v8 offset:33792
    v_mfma_f32_16x16x32_bf16 v[44:47], a[68:71], a[16:19], 0
    v_mfma_f32_16x16x32_bf16 v[40:43], a[72:75], a[20:23], v[40:43]
    s_add_u32 m0, s30, 0
    s_waitcnt lgkmcnt(3)
    v_lshlrev_b32 v28, 16, v112
    v_and_b32 v29, 0xffff0000, v112
    v_mul_f32 v28, s39, v28
    v_mul_f32 v29, s39, v29
    v_cvt_pk_bf16_f32 v28, v28, v29
    v_accvgpr_write_b32 a32, v28
    v_lshlrev_b32 v30, 16, v113
    v_and_b32 v31, 0xffff0000, v113
    v_mul_f32 v30, s39, v30
    v_mul_f32 v31, s39, v31
    v_cvt_pk_bf16_f32 v30, v30, v31
    v_accvgpr_write_b32 a33, v30
    v_lshlrev_b32 v28, 16, v114
    v_and_b32 v29, 0xffff0000, v114
    v_mul_f32 v28, s39, v28
    v_mul_f32 v29, s39, v29
    v_cvt_pk_bf16_f32 v28, v28, v29
    v_accvgpr_write_b32 a34, v28
    v_lshlrev_b32 v30, 16, v115
    v_and_b32 v31, 0xffff0000, v115
    v_mul_f32 v30, s39, v30
    v_mul_f32 v31, s39, v31
    v_cvt_pk_bf16_f32 v30, v30, v31
    v_accvgpr_write_b32 a35, v30
    s_waitcnt lgkmcnt(2)
    v_lshlrev_b32 v28, 16, v116
    v_and_b32 v29, 0xffff0000, v116
    v_mul_f32 v28, s39, v28
    v_mul_f32 v29, s39, v29
    v_cvt_pk_bf16_f32 v28, v28, v29
    v_accvgpr_write_b32 a36, v28
    v_lshlrev_b32 v30, 16, v117
    v_and_b32 v31, 0xffff0000, v117
    v_mul_f32 v30, s39, v30
    v_mul_f32 v31, s39, v31
    v_cvt_pk_bf16_f32 v30, v30, v31
    v_accvgpr_write_b32 a37, v30
    v_lshlrev_b32 v28, 16, v118
    v_and_b32 v29, 0xffff0000, v118
    v_mul_f32 v28, s39, v28
    v_mul_f32 v29, s39, v29
    v_cvt_pk_bf16_f32 v28, v28, v29
    v_accvgpr_write_b32 a38, v28
    v_lshlrev_b32 v30, 16, v119
    v_and_b32 v31, 0xffff0000, v119
    v_mul_f32 v30, s39, v30
    v_mul_f32 v31, s39, v31
    v_cvt_pk_bf16_f32 v30, v30, v31
    v_accvgpr_write_b32 a39, v30
    s_waitcnt lgkmcnt(1)
    v_lshlrev_b32 v28, 16, v120
    v_and_b32 v29, 0xffff0000, v120
    v_mul_f32 v28, s39, v28
    v_mul_f32 v29, s39, v29
    v_cvt_pk_bf16_f32 v28, v28, v29
    v_accvgpr_write_b32 a40, v28
    v_lshlrev_b32 v30, 16, v121
    v_and_b32 v31, 0xffff0000, v121
    v_mul_f32 v30, s39, v30
    v_mul_f32 v31, s39, v31
    v_cvt_pk_bf16_f32 v30, v30, v31
    v_accvgpr_write_b32 a41, v30
    v_lshlrev_b32 v28, 16, v122
    v_and_b32 v29, 0xffff0000, v122
    v_mul_f32 v28, s39, v28
    v_mul_f32 v29, s39, v29
    v_cvt_pk_bf16_f32 v28, v28, v29
    v_accvgpr_write_b32 a42, v28
    v_lshlrev_b32 v30, 16, v123
    v_and_b32 v31, 0xffff0000, v123
    v_mul_f32 v30, s39, v30
    v_mul_f32 v31, s39, v31
    v_cvt_pk_bf16_f32 v30, v30, v31
    v_accvgpr_write_b32 a43, v30
    s_waitcnt lgkmcnt(0)
    v_lshlrev_b32 v28, 16, v124
    v_and_b32 v29, 0xffff0000, v124
    v_mul_f32 v28, s39, v28
    v_mul_f32 v29, s39, v29
    v_cvt_pk_bf16_f32 v28, v28, v29
    v_accvgpr_write_b32 a44, v28
    v_lshlrev_b32 v30, 16, v125
    v_and_b32 v31, 0xffff0000, v125
    v_mul_f32 v30, s39, v30
    v_mul_f32 v31, s39, v31
    v_cvt_pk_bf16_f32 v30, v30, v31
    v_accvgpr_write_b32 a45, v30
    v_lshlrev_b32 v28, 16, v126
    v_and_b32 v29, 0xffff0000, v126
    v_mul_f32 v28, s39, v28
    v_mul_f32 v29, s39, v29
    v_cvt_pk_bf16_f32 v28, v28, v29
    v_accvgpr_write_b32 a46, v28
    v_lshlrev_b32 v30, 16, v127
    v_and_b32 v31, 0xffff0000, v127
    v_mul_f32 v30, s39, v30
    v_mul_f32 v31, s39, v31
    v_cvt_pk_bf16_f32 v30, v30, v31
    v_accvgpr_write_b32 a47, v30
    v_mfma_f32_16x16x32_bf16 v[44:47], a[76:79], a[20:23], v[44:47]
    s_mov_b32 s42, 65536
    v_mfma_f32_16x16x32_bf16 v[40:43], a[80:83], a[24:27], v[40:43]
    s_waitcnt lgkmcnt(0)
    v_max3_f32 v24, v32, v33, v34
    v_max3_f32 v24, v24, v35, v36
    v_max3_f32 v24, v24, v37, v38
    v_max_f32 v24, v24, v39
    v_mov_b32 v25, v24
    v_mfma_f32_16x16x32_bf16 v[44:47], a[84:87], a[24:27], v[44:47]
    s_nop 0
    v_permlane16_swap_b32 v24, v25
    v_max_f32 v24, v24, v25
    v_mov_b32 v25, v24
    v_mfma_f32_16x16x32_bf16 v[40:43], a[88:91], a[28:31], v[40:43]
    s_nop 0
    v_permlane32_swap_b32 v24, v25
    v_max_f32 v24, v24, v25
    v_mul_f32 v80, -1.0, v24
    v_mul_f32 v81, -1.0, v24
    v_mul_f32 v82, -1.0, v24
    v_mul_f32 v83, -1.0, v24
    v_mfma_f32_16x16x32_bf16 v[44:47], a[92:95], a[28:31], v[44:47]
    v_add_f32 v32, v32, v80
    v_add_f32 v33, v33, v80
    buffer_load_dwordx4 v2, s[12:15], s42 offen nt lds
    v_exp_f32 v32, v32
    v_exp_f32 v33, v33
    buffer_load_dwordx4 v2, s[12:15], s42 offen offset:1024 nt lds
    v_max3_f32 v26, v40, v41, v42
    s_nop 0
    v_max3_f32 v26, v26, v43, v44
    v_max3_f32 v26, v26, v45, v46
    v_max_f32 v26, v26, v47
    v_mov_b32 v27, v26
    v_add_f32 v34, v34, v80
    v_add_f32 v35, v35, v80
    v_permlane16_swap_b32 v26, v27
    v_max_f32 v26, v26, v27
    v_mov_b32 v27, v26
    v_cvt_pk_bf16_f32 v64, v32, v33
    v_exp_f32 v34, v34
    s_add_u32 m0, s30, 2080
    v_permlane32_swap_b32 v26, v27
    v_max_f32 v26, v26, v27
    v_exp_f32 v35, v35
    v_mul_f32 v84, -1.0, v26
    s_mov_b32 s42, 67584
    v_mul_f32 v85, -1.0, v26
    v_mul_f32 v86, -1.0, v26
    v_add_f32 v36, v36, v80
    v_add_f32 v37, v37, v80
    ds_read_b64_tr_b16 a[96:97], v5 offset:0
    ds_read_b64_tr_b16 a[98:99], v5 offset:8256
    v_mul_f32 v87, -1.0, v26
    v_cvt_pk_bf16_f32 v65, v34, v35
    v_exp_f32 v36, v36
    v_mfma_f32_16x16x32_bf16 v[48:51], a[64:67], a[32:35], 0
    s_waitcnt vmcnt(6)
    ds_read_b128 v[112:115], v8 offset:49536
    ds_read_b128 v[116:119], v8 offset:49792
    ds_read_b128 v[120:123], v8 offset:50048
    ds_read_b128 v[124:127], v8 offset:50304
    ds_read_b64_tr_b16 a[100:101], v5 offset:32
    ds_read_b64_tr_b16 a[102:103], v5 offset:8288
    v_exp_f32 v37, v37
    v_mfma_f32_16x16x32_bf16 v[52:55], a[68:71], a[32:35], 0
    ds_read_b64_tr_b16 a[104:105], v5 offset:256
    ds_read_b64_tr_b16 a[106:107], v5 offset:8512
    v_add_f32 v38, v38, v80
    v_add_f32 v39, v39, v80
    v_mfma_f32_16x16x32_bf16 v[48:51], a[72:75], a[36:39], v[48:51]
    ds_read_b64_tr_b16 a[108:109], v5 offset:288
    ds_read_b64_tr_b16 a[110:111], v5 offset:8544
    s_waitcnt lgkmcnt(9)
    v_lshlrev_b32 v28, 16, v112
    v_and_b32 v29, 0xffff0000, v112
    v_mul_f32 v28, s39, v28
    v_mul_f32 v29, s39, v29
    v_cvt_pk_bf16_f32 v28, v28, v29
    v_accvgpr_write_b32 a48, v28
    v_lshlrev_b32 v30, 16, v113
    v_and_b32 v31, 0xffff0000, v113
    v_mul_f32 v30, s39, v30
    v_mul_f32 v31, s39, v31
    v_cvt_pk_bf16_f32 v30, v30, v31
    v_accvgpr_write_b32 a49, v30
    v_lshlrev_b32 v28, 16, v114
    v_and_b32 v29, 0xffff0000, v114
    v_mul_f32 v28, s39, v28
    v_mul_f32 v29, s39, v29
    v_cvt_pk_bf16_f32 v28, v28, v29
    v_accvgpr_write_b32 a50, v28
    v_lshlrev_b32 v30, 16, v115
    v_and_b32 v31, 0xffff0000, v115
    v_mul_f32 v30, s39, v30
    v_mul_f32 v31, s39, v31
    v_cvt_pk_bf16_f32 v30, v30, v31
    v_accvgpr_write_b32 a51, v30
    s_waitcnt lgkmcnt(8)
    v_lshlrev_b32 v28, 16, v116
    v_and_b32 v29, 0xffff0000, v116
    v_mul_f32 v28, s39, v28
    v_mul_f32 v29, s39, v29
    v_cvt_pk_bf16_f32 v28, v28, v29
    v_accvgpr_write_b32 a52, v28
    v_lshlrev_b32 v30, 16, v117
    v_and_b32 v31, 0xffff0000, v117
    v_mul_f32 v30, s39, v30
    v_mul_f32 v31, s39, v31
    v_cvt_pk_bf16_f32 v30, v30, v31
    v_accvgpr_write_b32 a53, v30
    v_lshlrev_b32 v28, 16, v118
    v_and_b32 v29, 0xffff0000, v118
    v_mul_f32 v28, s39, v28
    v_mul_f32 v29, s39, v29
    v_cvt_pk_bf16_f32 v28, v28, v29
    v_accvgpr_write_b32 a54, v28
    v_lshlrev_b32 v30, 16, v119
    v_and_b32 v31, 0xffff0000, v119
    v_mul_f32 v30, s39, v30
    v_mul_f32 v31, s39, v31
    v_cvt_pk_bf16_f32 v30, v30, v31
    v_accvgpr_write_b32 a55, v30
    s_waitcnt lgkmcnt(7)
    v_lshlrev_b32 v28, 16, v120
    v_and_b32 v29, 0xffff0000, v120
    v_mul_f32 v28, s39, v28
    v_mul_f32 v29, s39, v29
    v_cvt_pk_bf16_f32 v28, v28, v29
    v_accvgpr_write_b32 a56, v28
    v_lshlrev_b32 v30, 16, v121
    v_and_b32 v31, 0xffff0000, v121
    v_mul_f32 v30, s39, v30
    v_mul_f32 v31, s39, v31
    v_cvt_pk_bf16_f32 v30, v30, v31
    v_accvgpr_write_b32 a57, v30
    v_lshlrev_b32 v28, 16, v122
    v_and_b32 v29, 0xffff0000, v122
    v_mul_f32 v28, s39, v28
    v_mul_f32 v29, s39, v29
    v_cvt_pk_bf16_f32 v28, v28, v29
    v_accvgpr_write_b32 a58, v28
    v_lshlrev_b32 v30, 16, v123
    v_and_b32 v31, 0xffff0000, v123
    v_mul_f32 v30, s39, v30
    v_mul_f32 v31, s39, v31
    v_cvt_pk_bf16_f32 v30, v30, v31
    v_accvgpr_write_b32 a59, v30
    s_waitcnt lgkmcnt(6)
    v_lshlrev_b32 v28, 16, v124
    v_and_b32 v29, 0xffff0000, v124
    v_mul_f32 v28, s39, v28
    v_mul_f32 v29, s39, v29
    v_cvt_pk_bf16_f32 v28, v28, v29
    v_accvgpr_write_b32 a60, v28
    v_lshlrev_b32 v30, 16, v125
    v_and_b32 v31, 0xffff0000, v125
    v_mul_f32 v30, s39, v30
    v_mul_f32 v31, s39, v31
    v_cvt_pk_bf16_f32 v30, v30, v31
    v_accvgpr_write_b32 a61, v30
    v_lshlrev_b32 v28, 16, v126
    v_and_b32 v29, 0xffff0000, v126
    v_mul_f32 v28, s39, v28
    v_mul_f32 v29, s39, v29
    v_cvt_pk_bf16_f32 v28, v28, v29
    v_accvgpr_write_b32 a62, v28
    v_lshlrev_b32 v30, 16, v127
    v_and_b32 v31, 0xffff0000, v127
    v_mul_f32 v30, s39, v30
    v_mul_f32 v31, s39, v31
    v_cvt_pk_bf16_f32 v30, v30, v31
    v_accvgpr_write_b32 a63, v30
    v_cvt_pk_bf16_f32 v66, v36, v37
    v_exp_f32 v38, v38
    v_mfma_f32_16x16x32_bf16 v[52:55], a[76:79], a[36:39], v[52:55]
    ds_read_b64_tr_b16 a[112:113], v5 offset:512
    ds_read_b64_tr_b16 a[114:115], v5 offset:8768
    buffer_load_dwordx4 v2, s[12:15], s42 offen nt lds
    v_mov_b32 v12, v32
    v_exp_f32 v39, v39
    v_mfma_f32_16x16x32_bf16 v[48:51], a[80:83], a[40:43], v[48:51]
    s_waitcnt lgkmcnt(0)
    ds_read_b64_tr_b16 a[116:117], v5 offset:544
    ds_read_b64_tr_b16 a[118:119], v5 offset:8800
    v_mfma_f32_16x16x32_bf16 v[52:55], a[84:87], a[40:43], v[52:55]
    ds_read_b64_tr_b16 a[120:121], v5 offset:768
    ds_read_b64_tr_b16 a[122:123], v5 offset:9024
    v_cvt_pk_bf16_f32 v67, v38, v39
    v_mfma_f32_16x16x32_bf16 v[48:51], a[88:91], a[44:47], v[48:51]
    ds_read_b64_tr_b16 a[124:125], v5 offset:800
    ds_read_b64_tr_b16 a[126:127], v5 offset:9056
    v_mfma_f32_16x16x32_bf16 v[52:55], a[92:95], a[44:47], v[52:55]
    buffer_load_dwordx4 v2, s[12:15], s42 offen offset:1024 nt lds
    v_mfma_f32_16x16x32_bf16 v[128:131], a[96:99], v[64:67], 0
    v_add_f32 v12, v12, v33
    v_add_f32 v12, v12, v34
    v_mfma_f32_16x16x32_bf16 v[132:135], a[100:103], v[64:67], 0
    v_add_f32 v40, v40, v84
    v_add_f32 v41, v41, v84
    v_mfma_f32_16x16x32_bf16 v[136:139], a[104:107], v[64:67], 0
    s_add_u32 m0, s29, 33024
    v_exp_f32 v40, v40
    v_mfma_f32_16x16x32_bf16 v[140:143], a[108:111], v[64:67], 0
    s_mov_b32 s31, 24576
    v_exp_f32 v41, v41
    v_mfma_f32_16x16x32_bf16 v[144:147], a[112:115], v[64:67], 0
    s_waitcnt lgkmcnt(0)
    v_max3_f32 v24, v48, v49, v50
    v_max3_f32 v24, v24, v51, v52
    v_max3_f32 v24, v24, v53, v54
    v_max_f32 v24, v24, v55
    v_mov_b32 v25, v24
    v_add_f32 v42, v42, v84
    v_add_f32 v43, v43, v84
    v_mfma_f32_16x16x32_bf16 v[148:151], a[116:119], v[64:67], 0
    v_permlane16_swap_b32 v24, v25
    v_max_f32 v24, v24, v25
    v_mov_b32 v25, v24
    v_cvt_pk_bf16_f32 v68, v40, v41
    v_exp_f32 v42, v42
    v_mfma_f32_16x16x32_bf16 v[152:155], a[120:123], v[64:67], 0
    v_permlane32_swap_b32 v24, v25
    v_max_f32 v24, v24, v25
    v_exp_f32 v43, v43
    v_mul_f32 v88, -1.0, v24
    v_mfma_f32_16x16x32_bf16 v[156:159], a[124:127], v[64:67], 0
    v_mul_f32 v89, -1.0, v24
    v_mul_f32 v90, -1.0, v24
    v_add_f32 v44, v44, v84
    v_add_f32 v45, v45, v84
    buffer_load_dwordx4 v1, s[16:19], s31 offen nt lds
    v_mul_f32 v91, -1.0, v24
    v_cvt_pk_bf16_f32 v69, v42, v43
    v_exp_f32 v44, v44
    v_mfma_f32_16x16x32_bf16 v[56:59], a[64:67], a[48:51], 0
    v_exp_f32 v45, v45
    v_mfma_f32_16x16x32_bf16 v[60:63], a[68:71], a[48:51], 0
    v_add_f32 v46, v46, v84
    v_add_f32 v47, v47, v84
    v_mfma_f32_16x16x32_bf16 v[56:59], a[72:75], a[52:55], v[56:59]
    v_cvt_pk_bf16_f32 v70, v44, v45
    v_add_f32 v12, v12, v35
    v_exp_f32 v46, v46
    v_mfma_f32_16x16x32_bf16 v[60:63], a[76:79], a[52:55], v[60:63]
    buffer_load_dwordx4 v1, s[16:19], s31 offen offset:1024 nt lds
    v_exp_f32 v47, v47
    v_mfma_f32_16x16x32_bf16 v[56:59], a[80:83], a[56:59], v[56:59]
    v_add_f32 v12, v12, v36
    v_add_f32 v12, v12, v37
    v_mfma_f32_16x16x32_bf16 v[60:63], a[84:87], a[56:59], v[60:63]
    v_cvt_pk_bf16_f32 v71, v46, v47
    v_add_f32 v12, v12, v38
    v_mfma_f32_16x16x32_bf16 v[56:59], a[88:91], a[60:63], v[56:59]
    s_add_u32 m0, s29, 33024
    ds_read_b128 a[64:67], v3 offset:0
    v_add_f32 v12, v12, v39
    v_mfma_f32_16x16x32_bf16 v[60:63], a[92:95], a[60:63], v[60:63]
    s_mov_b32 s32, 14336
    v_add_f32 v48, v48, v88
    v_add_f32 v49, v49, v88
    v_mfma_f32_16x16x32_bf16 v[160:163], a[96:99], v[68:71], 0
    s_mov_b32 s33, 14304
    ds_read_b128 a[68:71], v3 offset:8256
    ds_read_b128 a[72:75], v3 offset:256
    v_mfma_f32_16x16x32_bf16 v[164:167], a[100:103], v[68:71], 0
    v_exp_f32 v48, v48
    v_mfma_f32_16x16x32_bf16 v[168:171], a[104:107], v[68:71], 0
    ds_read_b128 a[76:79], v3 offset:8512
    v_add_f32 v50, v50, v88
    v_mfma_f32_16x16x32_bf16 v[172:175], a[108:111], v[68:71], 0
    v_exp_f32 v49, v49
    v_mfma_f32_16x16x32_bf16 v[176:179], a[112:115], v[68:71], 0
    ds_read_b128 a[80:83], v3 offset:512
    buffer_load_dwordx4 v1, s[20:23], s32 offen offset:2048 nt lds
    v_max3_f32 v26, v56, v57, v58
    v_max3_f32 v26, v26, v59, v60
    v_max3_f32 v26, v26, v61, v62
    v_max_f32 v26, v26, v63
    v_mov_b32 v27, v26
    v_add_f32 v51, v51, v88
    v_mfma_f32_16x16x32_bf16 v[180:183], a[116:119], v[68:71], 0
    ds_read_b128 a[84:87], v3 offset:8768
    v_permlane16_swap_b32 v26, v27
    v_max_f32 v26, v26, v27
    v_mov_b32 v27, v26
    v_cvt_pk_bf16_f32 v72, v48, v49
    v_exp_f32 v50, v50
    v_mfma_f32_16x16x32_bf16 v[184:187], a[120:123], v[68:71], 0
    ds_read_b128 a[88:91], v3 offset:768
    v_permlane32_swap_b32 v26, v27
    v_max_f32 v26, v26, v27
    v_exp_f32 v51, v51
    v_mul_f32 v92, -1.0, v26
    v_mfma_f32_16x16x32_bf16 v[188:191], a[124:127], v[68:71], 0
    ds_read_b128 a[92:95], v3 offset:9024
    v_mul_f32 v93, -1.0, v26
    v_mul_f32 v94, -1.0, v26
    v_add_f32 v52, v52, v88
    v_add_f32 v53, v53, v88
    v_mfma_f32_16x16x32_bf16 a[136:139], a[128:131], v[68:71], 0
    s_waitcnt lgkmcnt(4)
    buffer_load_dwordx4 v1, s[20:23], s33 offen offset:3104 nt lds
    v_mul_f32 v95, -1.0, v26
    v_cvt_pk_bf16_f32 v73, v50, v51
    v_exp_f32 v52, v52
    v_mfma_f32_16x16x32_bf16 v[32:35], a[64:67], a[0:3], v[80:83]
    v_exp_f32 v53, v53
    v_mfma_f32_16x16x32_bf16 v[36:39], a[68:71], a[0:3], v[80:83]
    v_add_f32 v54, v54, v88
    v_add_f32 v55, v55, v88
    v_mfma_f32_16x16x32_bf16 v[32:35], a[72:75], a[4:7], v[32:35]
    s_add_u32 m0, s29, 82560
    v_cvt_pk_bf16_f32 v74, v52, v53
    v_mov_b32 v14, v48
    v_exp_f32 v54, v54
    v_mfma_f32_16x16x32_bf16 v[36:39], a[76:79], a[4:7], v[36:39]
    s_mov_b32 s42, 69632
    v_exp_f32 v55, v55
    s_waitcnt lgkmcnt(0)
    v_mfma_f32_16x16x32_bf16 v[32:35], a[80:83], a[8:11], v[32:35]
    v_add_f32 v14, v14, v49
    v_cvt_pk_bf16_f32 v75, v54, v55
    v_mfma_f32_16x16x32_bf16 v[36:39], a[84:87], a[8:11], v[36:39]
    v_add_f32 v14, v14, v50
    v_add_f32 v14, v14, v51
    v_mfma_f32_16x16x32_bf16 v[32:35], a[88:91], a[12:15], v[32:35]
    v_add_f32 v56, v56, v92
    v_add_f32 v57, v57, v92
    v_mfma_f32_16x16x32_bf16 v[36:39], a[92:95], a[12:15], v[36:39]
    v_exp_f32 v56, v56
    v_mfma_f32_16x16x32_bf16 v[192:195], a[96:99], v[72:75], 0
    buffer_load_dwordx4 v2, s[12:15], s42 offen nt lds
    v_mfma_f32_16x16x32_bf16 v[196:199], a[100:103], v[72:75], 0
    v_exp_f32 v57, v57
    v_mfma_f32_16x16x32_bf16 v[200:203], a[104:107], v[72:75], 0
    v_add_f32 v14, v14, v52
    v_add_f32 v14, v14, v53
    v_mfma_f32_16x16x32_bf16 v[204:207], a[108:111], v[72:75], 0
    v_add_f32 v58, v58, v92
    v_add_f32 v59, v59, v92
    v_mfma_f32_16x16x32_bf16 v[208:211], a[112:115], v[72:75], 0
    buffer_load_dwordx4 v2, s[12:15], s42 offen offset:1024 nt lds
    v_mfma_f32_16x16x32_bf16 v[212:215], a[116:119], v[72:75], 0
    v_cvt_pk_bf16_f32 v76, v56, v57
    v_add_f32 v14, v14, v54
    v_exp_f32 v58, v58
    v_mfma_f32_16x16x32_bf16 v[216:219], a[120:123], v[72:75], 0
    v_exp_f32 v59, v59
    v_mfma_f32_16x16x32_bf16 v[220:223], a[124:127], v[72:75], 0
    v_add_f32 v60, v60, v92
    v_add_f32 v61, v61, v92
    v_cvt_pk_bf16_f32 v77, v58, v59
    v_exp_f32 v60, v60
    v_mfma_f32_16x16x32_bf16 v[40:43], a[64:67], a[16:19], v[84:87]
    s_waitcnt vmcnt(10) lgkmcnt(0)
    s_barrier
    v_mfma_f32_16x16x32_bf16 v[44:47], a[68:71], a[16:19], v[84:87]
    v_exp_f32 v61, v61
    v_add_f32 v62, v62, v92
    v_add_f32 v63, v63, v92
    v_mfma_f32_16x16x32_bf16 v[40:43], a[72:75], a[20:23], v[40:43]
    s_add_u32 m0, s29, 84640
    v_cvt_pk_bf16_f32 v78, v60, v61
    v_add_f32 v14, v14, v55
    v_exp_f32 v62, v62
    v_mfma_f32_16x16x32_bf16 v[44:47], a[76:79], a[20:23], v[44:47]
    s_mov_b32 s42, 71680
    v_exp_f32 v63, v63
    v_mfma_f32_16x16x32_bf16 v[40:43], a[80:83], a[24:27], v[40:43]
    v_exp_f32 v32, v32
    v_mfma_f32_16x16x32_bf16 v[44:47], a[84:87], a[24:27], v[44:47]
    v_cvt_pk_bf16_f32 v79, v62, v63
    v_add_f32 v12, v12, v32
    v_mfma_f32_16x16x32_bf16 v[40:43], a[88:91], a[28:31], v[40:43]
    v_exp_f32 v33, v33
    v_mfma_f32_16x16x32_bf16 v[44:47], a[92:95], a[28:31], v[44:47]
    v_cvt_pk_bf16_f32 v64, v32, v33
    v_add_f32 v12, v12, v33
    v_mfma_f32_16x16x32_bf16 v[224:227], a[96:99], v[76:79], 0
    buffer_load_dwordx4 v2, s[12:15], s42 offen nt lds
    v_mfma_f32_16x16x32_bf16 v[228:231], a[100:103], v[76:79], 0
    v_exp_f32 v34, v34
    v_mfma_f32_16x16x32_bf16 v[232:235], a[104:107], v[76:79], 0
    v_exp_f32 v35, v35
    v_mfma_f32_16x16x32_bf16 v[236:239], a[108:111], v[76:79], 0
    ds_read_b64_tr_b16 a[96:97], v5 offset:16512
    ds_read_b64_tr_b16 a[98:99], v5 offset:24768
    v_mfma_f32_16x16x32_bf16 v[240:243], a[112:115], v[76:79], 0
    buffer_load_dwordx4 v2, s[12:15], s42 offen offset:1024 nt lds
    v_mfma_f32_16x16x32_bf16 v[244:247], a[116:119], v[76:79], 0
    ds_read_b64_tr_b16 a[100:101], v5 offset:16544
    v_cvt_pk_bf16_f32 v65, v34, v35
    v_mfma_f32_16x16x32_bf16 v[248:251], a[120:123], v[76:79], 0
    v_exp_f32 v36, v36
    v_mfma_f32_16x16x32_bf16 v[252:255], a[124:127], v[76:79], 0
    ds_read_b64_tr_b16 a[102:103], v5 offset:24800
    ds_read_b64_tr_b16 a[104:105], v5 offset:16768
    v_mfma_f32_16x16x32_bf16 a[144:147], a[128:131], v[76:79], 0
    v_exp_f32 v37, v37
    v_mfma_f32_16x16x32_bf16 v[48:51], a[64:67], a[32:35], v[88:91]
    ds_read_b64_tr_b16 a[106:107], v5 offset:25024
    v_cvt_pk_bf16_f32 v66, v36, v37
    v_mfma_f32_16x16x32_bf16 v[52:55], a[68:71], a[32:35], v[88:91]
    s_add_u32 m0, s29, 49536
    ds_read_b64_tr_b16 a[108:109], v5 offset:16800
    ds_read_b64_tr_b16 a[110:111], v5 offset:25056
    v_mfma_f32_16x16x32_bf16 v[48:51], a[72:75], a[36:39], v[48:51]
    s_mov_b32 s31, 32768
    v_exp_f32 v38, v38
    v_mfma_f32_16x16x32_bf16 v[52:55], a[76:79], a[36:39], v[52:55]
    ds_read_b64_tr_b16 a[112:113], v5 offset:17024
    ds_read_b64_tr_b16 a[114:115], v5 offset:25280
    v_exp_f32 v39, v39
    v_mfma_f32_16x16x32_bf16 v[48:51], a[80:83], a[40:43], v[48:51]
    ds_read_b64_tr_b16 a[116:117], v5 offset:17056
    ds_read_b64_tr_b16 a[118:119], v5 offset:25312
    v_mfma_f32_16x16x32_bf16 v[52:55], a[84:87], a[40:43], v[52:55]
    ds_read_b64_tr_b16 a[120:121], v5 offset:17280
    ds_read_b64_tr_b16 a[122:123], v5 offset:25536
    v_cvt_pk_bf16_f32 v67, v38, v39
    v_mfma_f32_16x16x32_bf16 v[48:51], a[88:91], a[44:47], v[48:51]
    ds_read_b64_tr_b16 a[124:125], v5 offset:17312
    ds_read_b64_tr_b16 a[126:127], v5 offset:25568
    v_mfma_f32_16x16x32_bf16 v[52:55], a[92:95], a[44:47], v[52:55]
    s_waitcnt lgkmcnt(8)
    buffer_load_dwordx4 v1, s[16:19], s31 offen nt lds
    v_mfma_f32_16x16x32_bf16 v[128:131], a[96:99], v[64:67], v[128:131]
    v_exp_f32 v40, v40
    v_mfma_f32_16x16x32_bf16 v[132:135], a[100:103], v[64:67], v[132:135]
    v_exp_f32 v41, v41
    v_mfma_f32_16x16x32_bf16 v[136:139], a[104:107], v[64:67], v[136:139]
    v_add_f32 v12, v12, v34
    v_add_f32 v12, v12, v35
    v_mfma_f32_16x16x32_bf16 v[140:143], a[108:111], v[64:67], v[140:143]
    s_waitcnt lgkmcnt(2)
    buffer_load_dwordx4 v1, s[16:19], s31 offen offset:1024 nt lds
    v_mfma_f32_16x16x32_bf16 v[144:147], a[112:115], v[64:67], v[144:147]
    v_add_f32 v12, v12, v36
    v_add_f32 v12, v12, v37
    v_mfma_f32_16x16x32_bf16 v[148:151], a[116:119], v[64:67], v[148:151]
    s_waitcnt vmcnt(10)
    ds_read_b128 a[148:151], v7 offset:0
    ds_read_b128 a[152:155], v7 offset:256
    ds_read_b128 a[156:159], v7 offset:512
    ds_read_b128 a[160:163], v7 offset:768
    v_cvt_pk_bf16_f32 v68, v40, v41
    v_add_f32 v12, v12, v38
    v_exp_f32 v42, v42
    v_mfma_f32_16x16x32_bf16 v[152:155], a[120:123], v[64:67], v[152:155]
    s_waitcnt lgkmcnt(4)
    v_exp_f32 v43, v43
    v_mfma_f32_16x16x32_bf16 v[156:159], a[124:127], v[64:67], v[156:159]
    v_add_f32 v12, v12, v39
    v_cvt_pk_bf16_f32 v69, v42, v43
    v_exp_f32 v44, v44
    v_mfma_f32_16x16x32_bf16 v[56:59], a[64:67], a[48:51], v[92:95]
    s_add_u32 m0, s29, 49536
    v_exp_f32 v45, v45
    v_mfma_f32_16x16x32_bf16 v[60:63], a[68:71], a[48:51], v[92:95]
    s_mov_b32 s32, 22528
    ds_read_b128 a[64:67], v3 offset:16512
    v_cvt_pk_bf16_f32 v70, v44, v45
    v_mfma_f32_16x16x32_bf16 v[56:59], a[72:75], a[52:55], v[56:59]
    s_waitcnt lgkmcnt(0)
    v_exp_f32 v46, v46
    v_mfma_f32_16x16x32_bf16 v[60:63], a[76:79], a[52:55], v[60:63]
    s_mov_b32 s33, 22496
    v_exp_f32 v47, v47
    v_mfma_f32_16x16x32_bf16 v[56:59], a[80:83], a[56:59], v[56:59]
    ds_read_b128 a[68:71], v3 offset:24768
    v_cvt_pk_bf16_f32 v71, v46, v47
    v_mfma_f32_16x16x32_bf16 v[60:63], a[84:87], a[56:59], v[60:63]
    v_exp_f32 v48, v48
    v_mfma_f32_16x16x32_bf16 v[56:59], a[88:91], a[60:63], v[56:59]
    buffer_load_dwordx4 v1, s[20:23], s32 offen offset:2048 nt lds
    v_mfma_f32_16x16x32_bf16 v[60:63], a[92:95], a[60:63], v[60:63]
    ds_read_b128 a[72:75], v3 offset:16768
    ds_read_b128 a[76:79], v3 offset:25024
    v_mfma_f32_16x16x32_bf16 v[160:163], a[96:99], v[68:71], v[160:163]
    v_exp_f32 v49, v49
    v_mfma_f32_16x16x32_bf16 v[164:167], a[100:103], v[68:71], v[164:167]
    ds_read_b128 a[80:83], v3 offset:17024
    v_cvt_pk_bf16_f32 v72, v48, v49
    v_mfma_f32_16x16x32_bf16 v[168:171], a[104:107], v[68:71], v[168:171]
    buffer_load_dwordx4 v1, s[20:23], s33 offen offset:3104 nt lds
    v_mfma_f32_16x16x32_bf16 v[172:175], a[108:111], v[68:71], v[172:175]
    ds_read_b128 a[84:87], v3 offset:25280
    ds_read_b128 a[88:91], v3 offset:17280
    v_mfma_f32_16x16x32_bf16 v[176:179], a[112:115], v[68:71], v[176:179]
    v_exp_f32 v50, v50
    v_mfma_f32_16x16x32_bf16 v[180:183], a[116:119], v[68:71], v[180:183]
    v_exp_f32 v51, v51
    v_mfma_f32_16x16x32_bf16 v[184:187], a[120:123], v[68:71], v[184:187]
    ds_read_b128 a[92:95], v3 offset:25536
    v_cvt_pk_bf16_f32 v73, v50, v51
    v_mfma_f32_16x16x32_bf16 v[188:191], a[124:127], v[68:71], v[188:191]
    v_exp_f32 v52, v52
    v_mfma_f32_16x16x32_bf16 a[136:139], a[128:131], v[68:71], a[136:139]
    s_add_u32 m0, s29, 66048
    v_exp_f32 v53, v53
    v_mfma_f32_16x16x32_bf16 v[32:35], a[64:67], a[0:3], v[80:83]
    s_mov_b32 s31, 40960
    v_cvt_pk_bf16_f32 v74, v52, v53
    v_add_f32 v14, v14, v48
    s_waitcnt lgkmcnt(1)
    v_mfma_f32_16x16x32_bf16 v[36:39], a[68:71], a[0:3], v[80:83]
    v_exp_f32 v54, v54
    v_mfma_f32_16x16x32_bf16 v[32:35], a[72:75], a[4:7], v[32:35]
    v_exp_f32 v55, v55
    v_mfma_f32_16x16x32_bf16 v[36:39], a[76:79], a[4:7], v[36:39]
    v_add_f32 v14, v14, v49
    v_cvt_pk_bf16_f32 v75, v54, v55
    v_mfma_f32_16x16x32_bf16 v[32:35], a[80:83], a[8:11], v[32:35]
    v_exp_f32 v56, v56
    v_mfma_f32_16x16x32_bf16 v[36:39], a[84:87], a[8:11], v[36:39]
    buffer_load_dwordx4 v1, s[16:19], s31 offen nt lds
    v_mfma_f32_16x16x32_bf16 v[32:35], a[88:91], a[12:15], v[32:35]
    s_waitcnt lgkmcnt(0)
    v_exp_f32 v57, v57
    v_mfma_f32_16x16x32_bf16 v[36:39], a[92:95], a[12:15], v[36:39]
    v_add_f32 v14, v14, v50
    v_add_f32 v14, v14, v51
    v_mfma_f32_16x16x32_bf16 v[192:195], a[96:99], v[72:75], v[192:195]
    v_add_f32 v14, v14, v52
    v_add_f32 v14, v14, v53
    v_mfma_f32_16x16x32_bf16 v[196:199], a[100:103], v[72:75], v[196:199]
    buffer_load_dwordx4 v1, s[16:19], s31 offen offset:1024 nt lds
    v_mfma_f32_16x16x32_bf16 v[200:203], a[104:107], v[72:75], v[200:203]
    v_cvt_pk_bf16_f32 v76, v56, v57
    v_add_f32 v14, v14, v54
    v_mfma_f32_16x16x32_bf16 v[204:207], a[108:111], v[72:75], v[204:207]
    v_exp_f32 v58, v58
    v_mfma_f32_16x16x32_bf16 v[208:211], a[112:115], v[72:75], v[208:211]
    v_exp_f32 v59, v59
    v_mfma_f32_16x16x32_bf16 v[212:215], a[116:119], v[72:75], v[212:215]
    v_add_f32 v14, v14, v55
    v_cvt_pk_bf16_f32 v77, v58, v59
    v_mfma_f32_16x16x32_bf16 v[216:219], a[120:123], v[72:75], v[216:219]
    v_exp_f32 v60, v60
    v_mfma_f32_16x16x32_bf16 v[220:223], a[124:127], v[72:75], v[220:223]
    v_exp_f32 v61, v61
    v_mfma_f32_16x16x32_bf16 v[40:43], a[64:67], a[16:19], v[84:87]
    s_waitcnt vmcnt(10) lgkmcnt(0)
    s_barrier
    v_mfma_f32_16x16x32_bf16 v[44:47], a[68:71], a[16:19], v[84:87]
    v_exp_f32 v62, v62
    v_mfma_f32_16x16x32_bf16 v[40:43], a[72:75], a[20:23], v[40:43]
    s_add_u32 m0, s29, 66048
    v_cvt_pk_bf16_f32 v78, v60, v61
    v_mfma_f32_16x16x32_bf16 v[44:47], a[76:79], a[20:23], v[44:47]
    s_mov_b32 s32, 30720
    v_exp_f32 v63, v63
    v_mfma_f32_16x16x32_bf16 v[40:43], a[80:83], a[24:27], v[40:43]
    s_mov_b32 s33, 30688
    v_exp_f32 v32, v32
    v_mfma_f32_16x16x32_bf16 v[44:47], a[84:87], a[24:27], v[44:47]
    v_cvt_pk_bf16_f32 v79, v62, v63
    v_add_f32 v12, v12, v32
    v_mfma_f32_16x16x32_bf16 v[40:43], a[88:91], a[28:31], v[40:43]
    s_waitcnt vmcnt(6)
    ds_read_b128 a[164:167], v8 offset:16512
    ds_read_b128 a[168:171], v8 offset:16768
    ds_read_b128 a[172:175], v8 offset:17024
    ds_read_b128 a[176:179], v8 offset:17280
    v_mfma_f32_16x16x32_bf16 v[44:47], a[92:95], a[28:31], v[44:47]
    v_exp_f32 v33, v33
    v_mfma_f32_16x16x32_bf16 v[224:227], a[96:99], v[76:79], v[224:227]
    buffer_load_dwordx4 v1, s[20:23], s32 offen offset:2048 nt lds
    v_mfma_f32_16x16x32_bf16 v[228:231], a[100:103], v[76:79], v[228:231]
    ds_read_b64_tr_b16 a[96:97], v5 offset:33024
    v_cvt_pk_bf16_f32 v64, v32, v33
    v_mfma_f32_16x16x32_bf16 v[232:235], a[104:107], v[76:79], v[232:235]
    v_exp_f32 v34, v34
    v_mfma_f32_16x16x32_bf16 v[236:239], a[108:111], v[76:79], v[236:239]
    v_exp_f32 v35, v35
    v_mfma_f32_16x16x32_bf16 v[240:243], a[112:115], v[76:79], v[240:243]
    s_waitcnt lgkmcnt(0)
    buffer_load_dwordx4 v1, s[20:23], s33 offen offset:3104 nt lds
    v_mfma_f32_16x16x32_bf16 v[244:247], a[116:119], v[76:79], v[244:247]
    ds_read_b64_tr_b16 a[98:99], v5 offset:41280
    v_cvt_pk_bf16_f32 v65, v34, v35
    v_mfma_f32_16x16x32_bf16 v[248:251], a[120:123], v[76:79], v[248:251]
    ds_read_b64_tr_b16 a[100:101], v5 offset:33056
    ds_read_b64_tr_b16 a[102:103], v5 offset:41312
    v_mfma_f32_16x16x32_bf16 v[252:255], a[124:127], v[76:79], v[252:255]
    v_exp_f32 v36, v36
    v_mfma_f32_16x16x32_bf16 a[144:147], a[128:131], v[76:79], a[144:147]
    v_exp_f32 v37, v37
    v_mfma_f32_16x16x32_bf16 v[48:51], a[64:67], a[32:35], v[88:91]
    ds_read_b64_tr_b16 a[104:105], v5 offset:33280
    ds_read_b64_tr_b16 a[106:107], v5 offset:41536
    v_mfma_f32_16x16x32_bf16 v[52:55], a[68:71], a[32:35], v[88:91]
    s_add_u32 m0, s29, 82560
    ds_read_b64_tr_b16 a[108:109], v5 offset:33312
    v_cvt_pk_bf16_f32 v66, v36, v37
    v_mfma_f32_16x16x32_bf16 v[48:51], a[72:75], a[36:39], v[48:51]
    s_mov_b32 s31, 49152
    ds_read_b64_tr_b16 a[110:111], v5 offset:41568
    v_add_f32 v12, v12, v33
    v_exp_f32 v38, v38
    v_mfma_f32_16x16x32_bf16 v[52:55], a[76:79], a[36:39], v[52:55]
    ds_read_b64_tr_b16 a[112:113], v5 offset:33536
    ds_read_b64_tr_b16 a[114:115], v5 offset:41792
    v_exp_f32 v39, v39
    v_mfma_f32_16x16x32_bf16 v[48:51], a[80:83], a[40:43], v[48:51]
    ds_read_b64_tr_b16 a[116:117], v5 offset:33568
    ds_read_b64_tr_b16 a[118:119], v5 offset:41824
    v_mfma_f32_16x16x32_bf16 v[52:55], a[84:87], a[40:43], v[52:55]
    ds_read_b64_tr_b16 a[120:121], v5 offset:33792
    ds_read_b64_tr_b16 a[122:123], v5 offset:42048
    v_cvt_pk_bf16_f32 v67, v38, v39
    v_mfma_f32_16x16x32_bf16 v[48:51], a[88:91], a[44:47], v[48:51]
    ds_read_b64_tr_b16 a[124:125], v5 offset:33824
    ds_read_b64_tr_b16 a[126:127], v5 offset:42080
    v_mfma_f32_16x16x32_bf16 v[52:55], a[92:95], a[44:47], v[52:55]
    s_waitcnt lgkmcnt(9)
    buffer_load_dwordx4 v1, s[16:19], s31 offen nt lds
    v_mfma_f32_16x16x32_bf16 v[128:131], a[96:99], v[64:67], v[128:131]
    v_exp_f32 v40, v40
    v_mfma_f32_16x16x32_bf16 v[132:135], a[100:103], v[64:67], v[132:135]
    v_exp_f32 v41, v41
    v_mfma_f32_16x16x32_bf16 v[136:139], a[104:107], v[64:67], v[136:139]
    s_waitcnt lgkmcnt(4)
    v_add_f32 v12, v12, v34
    v_add_f32 v12, v12, v35
    v_mfma_f32_16x16x32_bf16 v[140:143], a[108:111], v[64:67], v[140:143]
    buffer_load_dwordx4 v1, s[16:19], s31 offen offset:1024 nt lds
    v_mfma_f32_16x16x32_bf16 v[144:147], a[112:115], v[64:67], v[144:147]
    v_add_f32 v12, v12, v36
    v_add_f32 v12, v12, v37
    v_mfma_f32_16x16x32_bf16 v[148:151], a[116:119], v[64:67], v[148:151]
    s_waitcnt lgkmcnt(0)
    v_cvt_pk_bf16_f32 v68, v40, v41
    v_add_f32 v12, v12, v38
    v_exp_f32 v42, v42
    v_mfma_f32_16x16x32_bf16 v[152:155], a[120:123], v[64:67], v[152:155]
    v_exp_f32 v43, v43
    v_mfma_f32_16x16x32_bf16 v[156:159], a[124:127], v[64:67], v[156:159]
    v_add_f32 v12, v12, v39
    v_cvt_pk_bf16_f32 v69, v42, v43
    v_exp_f32 v44, v44
    v_mfma_f32_16x16x32_bf16 v[56:59], a[64:67], a[48:51], v[92:95]
    s_add_u32 m0, s29, 82560
    v_exp_f32 v45, v45
    v_mfma_f32_16x16x32_bf16 v[60:63], a[68:71], a[48:51], v[92:95]
    s_mov_b32 s32, 38912
    ds_read_b128 a[64:67], v3 offset:33024
    v_cvt_pk_bf16_f32 v70, v44, v45
    v_mfma_f32_16x16x32_bf16 v[56:59], a[72:75], a[52:55], v[56:59]
    s_mov_b32 s33, 38880
    v_exp_f32 v46, v46
    v_mfma_f32_16x16x32_bf16 v[60:63], a[76:79], a[52:55], v[60:63]
    v_exp_f32 v47, v47
    v_mfma_f32_16x16x32_bf16 v[56:59], a[80:83], a[56:59], v[56:59]
    ds_read_b128 a[68:71], v3 offset:41280
    v_cvt_pk_bf16_f32 v71, v46, v47
    v_mfma_f32_16x16x32_bf16 v[60:63], a[84:87], a[56:59], v[60:63]
    v_exp_f32 v48, v48
    v_mfma_f32_16x16x32_bf16 v[56:59], a[88:91], a[60:63], v[56:59]
    buffer_load_dwordx4 v1, s[20:23], s32 offen offset:2048 nt lds
    v_mfma_f32_16x16x32_bf16 v[60:63], a[92:95], a[60:63], v[60:63]
    ds_read_b128 a[72:75], v3 offset:33280
    ds_read_b128 a[76:79], v3 offset:41536
    v_mfma_f32_16x16x32_bf16 v[160:163], a[96:99], v[68:71], v[160:163]
    v_exp_f32 v49, v49
    v_mfma_f32_16x16x32_bf16 v[164:167], a[100:103], v[68:71], v[164:167]
    ds_read_b128 a[80:83], v3 offset:33536
    v_cvt_pk_bf16_f32 v72, v48, v49
    v_mfma_f32_16x16x32_bf16 v[168:171], a[104:107], v[68:71], v[168:171]
    buffer_load_dwordx4 v1, s[20:23], s33 offen offset:3104 nt lds
    v_mfma_f32_16x16x32_bf16 v[172:175], a[108:111], v[68:71], v[172:175]
    ds_read_b128 a[84:87], v3 offset:41792
    ds_read_b128 a[88:91], v3 offset:33792
    v_mfma_f32_16x16x32_bf16 v[176:179], a[112:115], v[68:71], v[176:179]
    v_exp_f32 v50, v50
    v_mfma_f32_16x16x32_bf16 v[180:183], a[116:119], v[68:71], v[180:183]
    v_exp_f32 v51, v51
    v_mfma_f32_16x16x32_bf16 v[184:187], a[120:123], v[68:71], v[184:187]
    ds_read_b128 a[92:95], v3 offset:42048
    v_cvt_pk_bf16_f32 v73, v50, v51
    v_mfma_f32_16x16x32_bf16 v[188:191], a[124:127], v[68:71], v[188:191]
    v_exp_f32 v52, v52
    v_mfma_f32_16x16x32_bf16 a[136:139], a[128:131], v[68:71], a[136:139]
    s_add_u32 m0, s30, 0
    v_exp_f32 v53, v53
    s_waitcnt lgkmcnt(1)
    v_mfma_f32_16x16x32_bf16 v[32:35], a[64:67], a[0:3], v[80:83]
    s_mov_b32 s42, 73728
    v_cvt_pk_bf16_f32 v74, v52, v53
    v_add_f32 v14, v14, v48
    v_mfma_f32_16x16x32_bf16 v[36:39], a[68:71], a[0:3], v[80:83]
    v_exp_f32 v54, v54
    v_mfma_f32_16x16x32_bf16 v[32:35], a[72:75], a[4:7], v[32:35]
    v_exp_f32 v55, v55
    v_mfma_f32_16x16x32_bf16 v[36:39], a[76:79], a[4:7], v[36:39]
    v_add_f32 v14, v14, v49
    v_cvt_pk_bf16_f32 v75, v54, v55
    v_mfma_f32_16x16x32_bf16 v[32:35], a[80:83], a[8:11], v[32:35]
    v_exp_f32 v56, v56
    v_mfma_f32_16x16x32_bf16 v[36:39], a[84:87], a[8:11], v[36:39]
    buffer_load_dwordx4 v2, s[12:15], s42 offen nt lds
    v_mfma_f32_16x16x32_bf16 v[32:35], a[88:91], a[12:15], v[32:35]
    s_waitcnt lgkmcnt(0)
    v_exp_f32 v57, v57
    v_mfma_f32_16x16x32_bf16 v[36:39], a[92:95], a[12:15], v[36:39]
    v_add_f32 v14, v14, v50
    v_add_f32 v14, v14, v51
    v_mfma_f32_16x16x32_bf16 v[192:195], a[96:99], v[72:75], v[192:195]
    v_add_f32 v14, v14, v52
    v_add_f32 v14, v14, v53
    v_mfma_f32_16x16x32_bf16 v[196:199], a[100:103], v[72:75], v[196:199]
    buffer_load_dwordx4 v2, s[12:15], s42 offen offset:1024 nt lds
    v_mfma_f32_16x16x32_bf16 v[200:203], a[104:107], v[72:75], v[200:203]
    v_cvt_pk_bf16_f32 v76, v56, v57
    v_add_f32 v14, v14, v54
    v_mfma_f32_16x16x32_bf16 v[204:207], a[108:111], v[72:75], v[204:207]
    v_exp_f32 v58, v58
    v_mfma_f32_16x16x32_bf16 v[208:211], a[112:115], v[72:75], v[208:211]
    v_exp_f32 v59, v59
    v_mfma_f32_16x16x32_bf16 v[212:215], a[116:119], v[72:75], v[212:215]
    v_add_f32 v14, v14, v55
    v_cvt_pk_bf16_f32 v77, v58, v59
    v_mfma_f32_16x16x32_bf16 v[216:219], a[120:123], v[72:75], v[216:219]
    v_exp_f32 v60, v60
    v_mfma_f32_16x16x32_bf16 v[220:223], a[124:127], v[72:75], v[220:223]
    v_exp_f32 v61, v61
    v_mfma_f32_16x16x32_bf16 v[40:43], a[64:67], a[16:19], v[84:87]
    s_waitcnt vmcnt(10) lgkmcnt(0)
    s_barrier
    v_mfma_f32_16x16x32_bf16 v[44:47], a[68:71], a[16:19], v[84:87]
    v_exp_f32 v62, v62
    v_mfma_f32_16x16x32_bf16 v[40:43], a[72:75], a[20:23], v[40:43]
    s_add_u32 m0, s30, 2080
    v_cvt_pk_bf16_f32 v78, v60, v61
    v_mfma_f32_16x16x32_bf16 v[44:47], a[76:79], a[20:23], v[44:47]
    s_mov_b32 s42, 75776
    v_exp_f32 v63, v63
    v_mfma_f32_16x16x32_bf16 v[40:43], a[80:83], a[24:27], v[40:43]
    v_exp_f32 v32, v32
    v_mfma_f32_16x16x32_bf16 v[44:47], a[84:87], a[24:27], v[44:47]
    v_cvt_pk_bf16_f32 v79, v62, v63
    v_add_f32 v12, v12, v32
    v_mfma_f32_16x16x32_bf16 v[40:43], a[88:91], a[28:31], v[40:43]
    v_exp_f32 v33, v33
    v_mfma_f32_16x16x32_bf16 v[44:47], a[92:95], a[28:31], v[44:47]
    v_cvt_pk_bf16_f32 v64, v32, v33
    v_add_f32 v12, v12, v33
    v_mfma_f32_16x16x32_bf16 v[224:227], a[96:99], v[76:79], v[224:227]
    buffer_load_dwordx4 v2, s[12:15], s42 offen nt lds
    v_mfma_f32_16x16x32_bf16 v[228:231], a[100:103], v[76:79], v[228:231]
    v_exp_f32 v34, v34
    v_mfma_f32_16x16x32_bf16 v[232:235], a[104:107], v[76:79], v[232:235]
    v_exp_f32 v35, v35
    v_mfma_f32_16x16x32_bf16 v[236:239], a[108:111], v[76:79], v[236:239]
    ds_read_b64_tr_b16 a[96:97], v5 offset:49536
    ds_read_b64_tr_b16 a[98:99], v5 offset:57792
    v_mfma_f32_16x16x32_bf16 v[240:243], a[112:115], v[76:79], v[240:243]
    buffer_load_dwordx4 v2, s[12:15], s42 offen offset:1024 nt lds
    v_mfma_f32_16x16x32_bf16 v[244:247], a[116:119], v[76:79], v[244:247]
    ds_read_b64_tr_b16 a[100:101], v5 offset:49568
    v_cvt_pk_bf16_f32 v65, v34, v35
    v_mfma_f32_16x16x32_bf16 v[248:251], a[120:123], v[76:79], v[248:251]
    v_exp_f32 v36, v36
    v_mfma_f32_16x16x32_bf16 v[252:255], a[124:127], v[76:79], v[252:255]
    ds_read_b64_tr_b16 a[102:103], v5 offset:57824
    ds_read_b64_tr_b16 a[104:105], v5 offset:49792
    v_mfma_f32_16x16x32_bf16 a[144:147], a[128:131], v[76:79], a[144:147]
    v_exp_f32 v37, v37
    v_mfma_f32_16x16x32_bf16 v[48:51], a[64:67], a[32:35], v[88:91]
    ds_read_b64_tr_b16 a[106:107], v5 offset:58048
    v_cvt_pk_bf16_f32 v66, v36, v37
    v_mfma_f32_16x16x32_bf16 v[52:55], a[68:71], a[32:35], v[88:91]
    ds_read_b64_tr_b16 a[108:109], v5 offset:49824
    ds_read_b64_tr_b16 a[110:111], v5 offset:58080
    v_mfma_f32_16x16x32_bf16 v[48:51], a[72:75], a[36:39], v[48:51]
    v_exp_f32 v38, v38
    v_mfma_f32_16x16x32_bf16 v[52:55], a[76:79], a[36:39], v[52:55]
    ds_read_b64_tr_b16 a[112:113], v5 offset:50048
    ds_read_b64_tr_b16 a[114:115], v5 offset:58304
    v_exp_f32 v39, v39
    v_mfma_f32_16x16x32_bf16 v[48:51], a[80:83], a[40:43], v[48:51]
    ds_read_b64_tr_b16 a[116:117], v5 offset:50080
    ds_read_b64_tr_b16 a[118:119], v5 offset:58336
    v_mfma_f32_16x16x32_bf16 v[52:55], a[84:87], a[40:43], v[52:55]
    ds_read_b64_tr_b16 a[120:121], v5 offset:50304
    ds_read_b64_tr_b16 a[122:123], v5 offset:58560
    v_cvt_pk_bf16_f32 v67, v38, v39
    v_mfma_f32_16x16x32_bf16 v[48:51], a[88:91], a[44:47], v[48:51]
    s_add_u32 m0, s29, 99072
    ds_read_b64_tr_b16 a[124:125], v5 offset:50336
    ds_read_b64_tr_b16 a[126:127], v5 offset:58592
    v_mfma_f32_16x16x32_bf16 v[52:55], a[92:95], a[44:47], v[52:55]
    s_mov_b32 s31, 57344
    v_exp_f32 v40, v40
    s_waitcnt lgkmcnt(8)
    v_mfma_f32_16x16x32_bf16 v[128:131], a[96:99], v[64:67], v[128:131]
    v_exp_f32 v41, v41
    v_mfma_f32_16x16x32_bf16 v[132:135], a[100:103], v[64:67], v[132:135]
    v_add_f32 v12, v12, v34
    v_add_f32 v12, v12, v35
    v_mfma_f32_16x16x32_bf16 v[136:139], a[104:107], v[64:67], v[136:139]
    v_add_f32 v12, v12, v36
    v_add_f32 v12, v12, v37
    v_mfma_f32_16x16x32_bf16 v[140:143], a[108:111], v[64:67], v[140:143]
    s_waitcnt lgkmcnt(2)
    v_cvt_pk_bf16_f32 v68, v40, v41
    v_add_f32 v12, v12, v38
    v_mfma_f32_16x16x32_bf16 v[144:147], a[112:115], v[64:67], v[144:147]
    buffer_load_dwordx4 v1, s[16:19], s31 offen nt lds
    v_mfma_f32_16x16x32_bf16 v[148:151], a[116:119], v[64:67], v[148:151]
    v_exp_f32 v42, v42
    v_mfma_f32_16x16x32_bf16 v[152:155], a[120:123], v[64:67], v[152:155]
    s_waitcnt lgkmcnt(0)
    v_exp_f32 v43, v43
    v_mfma_f32_16x16x32_bf16 v[156:159], a[124:127], v[64:67], v[156:159]
    v_add_f32 v12, v12, v39
    v_cvt_pk_bf16_f32 v69, v42, v43
    buffer_load_dwordx4 v1, s[16:19], s31 offen offset:1024 nt lds
    v_exp_f32 v44, v44
    v_mfma_f32_16x16x32_bf16 v[56:59], a[64:67], a[48:51], v[92:95]
    v_exp_f32 v45, v45
    v_mfma_f32_16x16x32_bf16 v[60:63], a[68:71], a[48:51], v[92:95]
    ds_read_b128 a[64:67], v3 offset:49536
    v_cvt_pk_bf16_f32 v70, v44, v45
    v_mfma_f32_16x16x32_bf16 v[56:59], a[72:75], a[52:55], v[56:59]
    v_exp_f32 v46, v46
    v_mfma_f32_16x16x32_bf16 v[60:63], a[76:79], a[52:55], v[60:63]
    v_exp_f32 v47, v47
    v_mfma_f32_16x16x32_bf16 v[56:59], a[80:83], a[56:59], v[56:59]
    ds_read_b128 a[68:71], v3 offset:57792
    v_cvt_pk_bf16_f32 v71, v46, v47
    v_mfma_f32_16x16x32_bf16 v[60:63], a[84:87], a[56:59], v[60:63]
    v_exp_f32 v48, v48
    v_mfma_f32_16x16x32_bf16 v[56:59], a[88:91], a[60:63], v[56:59]
    ds_read_b128 a[72:75], v3 offset:49792
    ds_read_b128 a[76:79], v3 offset:58048
    v_mfma_f32_16x16x32_bf16 v[60:63], a[92:95], a[60:63], v[60:63]
    v_exp_f32 v49, v49
    v_mfma_f32_16x16x32_bf16 v[160:163], a[96:99], v[68:71], v[160:163]
    ds_read_b128 a[80:83], v3 offset:50048
    v_cvt_pk_bf16_f32 v72, v48, v49
    v_mfma_f32_16x16x32_bf16 v[164:167], a[100:103], v[68:71], v[164:167]
    ds_read_b128 a[84:87], v3 offset:58304
    ds_read_b128 a[88:91], v3 offset:50304
    v_mfma_f32_16x16x32_bf16 v[168:171], a[104:107], v[68:71], v[168:171]
    s_add_u32 m0, s29, 99072
    v_exp_f32 v50, v50
    v_mfma_f32_16x16x32_bf16 v[172:175], a[108:111], v[68:71], v[172:175]
    s_mov_b32 s32, 47104
    v_exp_f32 v51, v51
    v_mfma_f32_16x16x32_bf16 v[176:179], a[112:115], v[68:71], v[176:179]
    s_mov_b32 s33, 47072
    ds_read_b128 a[92:95], v3 offset:58560
    v_cvt_pk_bf16_f32 v73, v50, v51
    v_mfma_f32_16x16x32_bf16 v[180:183], a[116:119], v[68:71], v[180:183]
    v_exp_f32 v52, v52
    v_mfma_f32_16x16x32_bf16 v[184:187], a[120:123], v[68:71], v[184:187]
    v_exp_f32 v53, v53
    v_mfma_f32_16x16x32_bf16 v[188:191], a[124:127], v[68:71], v[188:191]
    v_cvt_pk_bf16_f32 v74, v52, v53
    v_add_f32 v14, v14, v48
    v_mfma_f32_16x16x32_bf16 a[136:139], a[128:131], v[68:71], a[136:139]
    s_waitcnt lgkmcnt(1)
    buffer_load_dwordx4 v1, s[20:23], s32 offen offset:2048 nt lds
    v_mfma_f32_16x16x32_bf16 v[32:35], a[64:67], a[0:3], v[80:83]
    v_exp_f32 v54, v54
    v_mfma_f32_16x16x32_bf16 v[36:39], a[68:71], a[0:3], v[80:83]
    v_exp_f32 v55, v55
    v_mfma_f32_16x16x32_bf16 v[32:35], a[72:75], a[4:7], v[32:35]
    v_add_f32 v14, v14, v49
    v_cvt_pk_bf16_f32 v75, v54, v55
    v_mfma_f32_16x16x32_bf16 v[36:39], a[76:79], a[4:7], v[36:39]
    buffer_load_dwordx4 v1, s[20:23], s33 offen offset:3104 nt lds
    v_mfma_f32_16x16x32_bf16 v[32:35], a[80:83], a[8:11], v[32:35]
    v_exp_f32 v56, v56
    v_mfma_f32_16x16x32_bf16 v[36:39], a[84:87], a[8:11], v[36:39]
    v_exp_f32 v57, v57
    v_mfma_f32_16x16x32_bf16 v[32:35], a[88:91], a[12:15], v[32:35]
    s_waitcnt lgkmcnt(0)
    v_add_f32 v14, v14, v50
    v_add_f32 v14, v14, v51
    v_mfma_f32_16x16x32_bf16 v[36:39], a[92:95], a[12:15], v[36:39]
    v_add_f32 v14, v14, v52
    v_add_f32 v14, v14, v53
    v_mfma_f32_16x16x32_bf16 v[192:195], a[96:99], v[72:75], v[192:195]
    v_cvt_pk_bf16_f32 v76, v56, v57
    v_add_f32 v14, v14, v54
    v_mfma_f32_16x16x32_bf16 v[196:199], a[100:103], v[72:75], v[196:199]
    v_exp_f32 v58, v58
    v_mfma_f32_16x16x32_bf16 v[200:203], a[104:107], v[72:75], v[200:203]
    v_exp_f32 v59, v59
    v_mfma_f32_16x16x32_bf16 v[204:207], a[108:111], v[72:75], v[204:207]
    v_add_f32 v14, v14, v55
    v_cvt_pk_bf16_f32 v77, v58, v59
    v_mfma_f32_16x16x32_bf16 v[208:211], a[112:115], v[72:75], v[208:211]
    v_exp_f32 v60, v60
    v_mfma_f32_16x16x32_bf16 v[212:215], a[116:119], v[72:75], v[212:215]
    v_exp_f32 v61, v61
    v_mfma_f32_16x16x32_bf16 v[216:219], a[120:123], v[72:75], v[216:219]
    v_exp_f32 v62, v62
    v_mfma_f32_16x16x32_bf16 v[220:223], a[124:127], v[72:75], v[220:223]
    v_exp_f32 v63, v63
    v_mfma_f32_16x16x32_bf16 v[40:43], a[64:67], a[16:19], v[84:87]
    s_waitcnt vmcnt(12) lgkmcnt(0)
    s_barrier
    v_mfma_f32_16x16x32_bf16 v[44:47], a[68:71], a[16:19], v[84:87]
    v_accvgpr_read_b32 v29, a148
    v_cvt_pk_bf16_f32 v78, v60, v61
    v_mfma_f32_16x16x32_bf16 v[40:43], a[72:75], a[20:23], v[40:43]
    s_add_u32 m0, s29, 115584
    v_lshlrev_b32 v28, 16, v29
    v_cvt_pk_bf16_f32 v79, v62, v63
    v_mfma_f32_16x16x32_bf16 v[44:47], a[76:79], a[20:23], v[44:47]
    s_mov_b32 s31, 65536
    v_exp_f32 v32, v32
    v_mfma_f32_16x16x32_bf16 v[40:43], a[80:83], a[24:27], v[40:43]
    v_and_b32 v29, 0xffff0000, v29
    v_mul_f32 v28, s39, v28
    v_mfma_f32_16x16x32_bf16 v[44:47], a[84:87], a[24:27], v[44:47]
    v_exp_f32 v33, v33
    v_mfma_f32_16x16x32_bf16 v[40:43], a[88:91], a[28:31], v[40:43]
    v_cvt_pk_bf16_f32 v64, v32, v33
    v_mul_f32 v29, s39, v29
    v_mfma_f32_16x16x32_bf16 v[44:47], a[92:95], a[28:31], v[44:47]
    v_exp_f32 v34, v34
    v_mfma_f32_16x16x32_bf16 v[224:227], a[96:99], v[76:79], v[224:227]
    ds_read_b64_tr_b16 a[96:97], v6 offset:0
    buffer_load_dwordx4 v1, s[16:19], s31 offen nt lds
    v_cvt_pk_bf16_f32 v28, v28, v29
    v_mfma_f32_16x16x32_bf16 v[228:231], a[100:103], v[76:79], v[228:231]
    v_exp_f32 v35, v35
    v_mfma_f32_16x16x32_bf16 v[232:235], a[104:107], v[76:79], v[232:235]
    ds_read_b64_tr_b16 a[98:99], v6 offset:8256
    v_accvgpr_write_b32 a148, v28
    v_mfma_f32_16x16x32_bf16 v[236:239], a[108:111], v[76:79], v[236:239]
    v_accvgpr_read_b32 v31, a149
    v_cvt_pk_bf16_f32 v65, v34, v35
    v_mfma_f32_16x16x32_bf16 v[240:243], a[112:115], v[76:79], v[240:243]
    buffer_load_dwordx4 v1, s[16:19], s31 offen offset:1024 nt lds
    v_mfma_f32_16x16x32_bf16 v[244:247], a[116:119], v[76:79], v[244:247]
    ds_read_b64_tr_b16 a[100:101], v6 offset:32
    v_lshlrev_b32 v30, 16, v31
    v_mfma_f32_16x16x32_bf16 v[248:251], a[120:123], v[76:79], v[248:251]
    ds_read_b64_tr_b16 a[102:103], v6 offset:8288
    v_and_b32 v31, 0xffff0000, v31
    v_mfma_f32_16x16x32_bf16 v[252:255], a[124:127], v[76:79], v[252:255]
    v_exp_f32 v36, v36
    v_mfma_f32_16x16x32_bf16 a[144:147], a[128:131], v[76:79], a[144:147]
    ds_read_b64_tr_b16 a[104:105], v6 offset:256
    v_mul_f32 v30, s39, v30
    v_mfma_f32_16x16x32_bf16 v[48:51], a[64:67], a[32:35], v[88:91]
    ds_read_b64_tr_b16 a[106:107], v6 offset:8512
    v_mul_f32 v31, s39, v31
    v_exp_f32 v37, v37
    v_mfma_f32_16x16x32_bf16 v[52:55], a[68:71], a[32:35], v[88:91]
    ds_read_b64_tr_b16 a[108:109], v6 offset:288
    v_cvt_pk_bf16_f32 v66, v36, v37
    v_mfma_f32_16x16x32_bf16 v[48:51], a[72:75], a[36:39], v[48:51]
    ds_read_b64_tr_b16 a[110:111], v6 offset:8544
    v_cvt_pk_bf16_f32 v30, v30, v31
    v_exp_f32 v38, v38
    v_mfma_f32_16x16x32_bf16 v[52:55], a[76:79], a[36:39], v[52:55]
    ds_read_b64_tr_b16 a[112:113], v6 offset:512
    ds_read_b64_tr_b16 a[114:115], v6 offset:8768
    v_accvgpr_write_b32 a149, v30
    v_exp_f32 v39, v39
    v_mfma_f32_16x16x32_bf16 v[48:51], a[80:83], a[40:43], v[48:51]
    ds_read_b64_tr_b16 a[116:117], v6 offset:544
    ds_read_b64_tr_b16 a[118:119], v6 offset:8800
    v_mfma_f32_16x16x32_bf16 v[52:55], a[84:87], a[40:43], v[52:55]
    ds_read_b64_tr_b16 a[120:121], v6 offset:768
    ds_read_b64_tr_b16 a[122:123], v6 offset:9024
    v_accvgpr_read_b32 v29, a150
    v_cvt_pk_bf16_f32 v67, v38, v39
    v_mfma_f32_16x16x32_bf16 v[48:51], a[88:91], a[44:47], v[48:51]
    s_add_u32 m0, s29, 115584
    ds_read_b64_tr_b16 a[124:125], v6 offset:800
    ds_read_b64_tr_b16 a[126:127], v6 offset:9056
    v_lshlrev_b32 v28, 16, v29
    v_mfma_f32_16x16x32_bf16 v[52:55], a[92:95], a[44:47], v[52:55]
    s_mov_b32 s32, 55296
    v_add_f32 v12, v12, v32
    v_add_f32 v12, v12, v33
    s_waitcnt lgkmcnt(8)
    v_mfma_f32_16x16x32_bf16 v[128:131], a[96:99], v[64:67], v[128:131]
    s_mov_b32 s33, 55264
    v_and_b32 v29, 0xffff0000, v29
    v_add_f32 v12, v12, v34
    v_mfma_f32_16x16x32_bf16 v[132:135], a[100:103], v[64:67], v[132:135]
    v_mul_f32 v28, s39, v28
    v_add_f32 v12, v12, v35
    v_mfma_f32_16x16x32_bf16 v[136:139], a[104:107], v[64:67], v[136:139]
    v_exp_f32 v40, v40
    v_mfma_f32_16x16x32_bf16 v[140:143], a[108:111], v[64:67], v[140:143]
    s_waitcnt lgkmcnt(2)
    v_mul_f32 v29, s39, v29
    v_add_f32 v12, v12, v36
    v_exp_f32 v41, v41
    v_mfma_f32_16x16x32_bf16 v[144:147], a[112:115], v[64:67], v[144:147]
    buffer_load_dwordx4 v1, s[20:23], s32 offen offset:2048 nt lds
    v_cvt_pk_bf16_f32 v28, v28, v29
    v_add_f32 v12, v12, v37
    v_mfma_f32_16x16x32_bf16 v[148:151], a[116:119], v[64:67], v[148:151]
    v_cvt_pk_bf16_f32 v68, v40, v41
    v_add_f32 v12, v12, v38
    v_exp_f32 v42, v42
    v_mfma_f32_16x16x32_bf16 v[152:155], a[120:123], v[64:67], v[152:155]
    s_waitcnt lgkmcnt(0)
    v_accvgpr_write_b32 a150, v28
    v_add_f32 v12, v12, v39
    v_exp_f32 v43, v43
    v_mfma_f32_16x16x32_bf16 v[156:159], a[124:127], v[64:67], v[156:159]
    v_accvgpr_read_b32 v31, a151
    v_cvt_pk_bf16_f32 v69, v42, v43
    buffer_load_dwordx4 v1, s[20:23], s33 offen offset:3104 nt lds
    v_exp_f32 v44, v44
    v_mfma_f32_16x16x32_bf16 v[56:59], a[64:67], a[48:51], v[92:95]
    ds_read_b128 a[64:67], v4 offset:0
    v_lshlrev_b32 v30, 16, v31
    v_exp_f32 v45, v45
    v_mfma_f32_16x16x32_bf16 v[60:63], a[68:71], a[48:51], v[92:95]
    v_and_b32 v31, 0xffff0000, v31
    v_cvt_pk_bf16_f32 v70, v44, v45
    v_mfma_f32_16x16x32_bf16 v[56:59], a[72:75], a[52:55], v[56:59]
    v_exp_f32 v46, v46
    v_mfma_f32_16x16x32_bf16 v[60:63], a[76:79], a[52:55], v[60:63]
    ds_read_b128 a[68:71], v4 offset:8256
    v_mul_f32 v30, s39, v30
    v_exp_f32 v47, v47
    v_mfma_f32_16x16x32_bf16 v[56:59], a[80:83], a[56:59], v[56:59]
    v_mul_f32 v31, s39, v31
    v_cvt_pk_bf16_f32 v71, v46, v47
    v_mfma_f32_16x16x32_bf16 v[60:63], a[84:87], a[56:59], v[60:63]
    ds_read_b128 a[72:75], v4 offset:256
    ds_read_b128 a[76:79], v4 offset:8512
    v_mfma_f32_16x16x32_bf16 v[56:59], a[88:91], a[60:63], v[56:59]
    ds_read_b128 a[80:83], v4 offset:512
    v_cvt_pk_bf16_f32 v30, v30, v31
    v_mfma_f32_16x16x32_bf16 v[60:63], a[92:95], a[60:63], v[60:63]
    ds_read_b128 a[84:87], v4 offset:8768
    v_accvgpr_write_b32 a151, v30
    v_mfma_f32_16x16x32_bf16 v[160:163], a[96:99], v[68:71], v[160:163]
    v_exp_f32 v48, v48
    v_mfma_f32_16x16x32_bf16 v[164:167], a[100:103], v[68:71], v[164:167]
    ds_read_b128 a[88:91], v4 offset:768
    v_accvgpr_read_b32 v29, a152
    v_mfma_f32_16x16x32_bf16 v[168:171], a[104:107], v[68:71], v[168:171]
    s_add_u32 m0, s29, 0
    v_exp_f32 v49, v49
    v_mfma_f32_16x16x32_bf16 v[172:175], a[108:111], v[68:71], v[172:175]
    s_mov_b32 s31, 73728
    v_lshlrev_b32 v28, 16, v29
    v_cvt_pk_bf16_f32 v72, v48, v49
    v_mfma_f32_16x16x32_bf16 v[176:179], a[112:115], v[68:71], v[176:179]
    ds_read_b128 a[92:95], v4 offset:9024
    v_and_b32 v29, 0xffff0000, v29
    v_mfma_f32_16x16x32_bf16 v[180:183], a[116:119], v[68:71], v[180:183]
    v_exp_f32 v50, v50
    v_mfma_f32_16x16x32_bf16 v[184:187], a[120:123], v[68:71], v[184:187]
    v_mul_f32 v28, s39, v28
    v_add_f32 v14, v14, v48
    v_exp_f32 v51, v51
    v_mfma_f32_16x16x32_bf16 v[188:191], a[124:127], v[68:71], v[188:191]
    v_mul_f32 v29, s39, v29
    v_cvt_pk_bf16_f32 v73, v50, v51
    v_mfma_f32_16x16x32_bf16 a[136:139], a[128:131], v[68:71], a[136:139]
    s_waitcnt lgkmcnt(1)
    buffer_load_dwordx4 v1, s[16:19], s31 offen nt lds
    v_exp_f32 v52, v52
    v_mfma_f32_16x16x32_bf16 v[32:35], a[64:67], a[0:3], v[80:83]
    v_cvt_pk_bf16_f32 v28, v28, v29
    v_add_f32 v14, v14, v49
    v_exp_f32 v53, v53
    v_mfma_f32_16x16x32_bf16 v[36:39], a[68:71], a[0:3], v[80:83]
    v_accvgpr_write_b32 a152, v28
    v_cvt_pk_bf16_f32 v74, v52, v53
    v_mfma_f32_16x16x32_bf16 v[32:35], a[72:75], a[4:7], v[32:35]
    v_exp_f32 v54, v54
    v_mfma_f32_16x16x32_bf16 v[36:39], a[76:79], a[4:7], v[36:39]
    buffer_load_dwordx4 v1, s[16:19], s31 offen offset:1024 nt lds
    v_accvgpr_read_b32 v31, a153
    v_add_f32 v14, v14, v50
    v_exp_f32 v55, v55
    v_mfma_f32_16x16x32_bf16 v[32:35], a[80:83], a[8:11], v[32:35]
    v_lshlrev_b32 v30, 16, v31
    v_cvt_pk_bf16_f32 v75, v54, v55
    v_mfma_f32_16x16x32_bf16 v[36:39], a[84:87], a[8:11], v[36:39]
    v_add_f32 v14, v14, v51
    v_add_f32 v14, v14, v52
    v_mfma_f32_16x16x32_bf16 v[32:35], a[88:91], a[12:15], v[32:35]
    s_waitcnt lgkmcnt(0)
    v_and_b32 v31, 0xffff0000, v31
    v_add_f32 v14, v14, v53
    v_mfma_f32_16x16x32_bf16 v[36:39], a[92:95], a[12:15], v[36:39]
    v_mul_f32 v30, s39, v30
    v_add_f32 v14, v14, v54
    v_mfma_f32_16x16x32_bf16 v[192:195], a[96:99], v[72:75], v[192:195]
    v_exp_f32 v56, v56
    v_mfma_f32_16x16x32_bf16 v[196:199], a[100:103], v[72:75], v[196:199]
    v_mul_f32 v31, s39, v31
    v_add_f32 v14, v14, v55
    v_mfma_f32_16x16x32_bf16 v[200:203], a[104:107], v[72:75], v[200:203]
    v_cvt_pk_bf16_f32 v30, v30, v31
    v_accvgpr_write_b32 a153, v30
    v_mfma_f32_16x16x32_bf16 v[204:207], a[108:111], v[72:75], v[204:207]
    v_exp_f32 v57, v57
    v_mfma_f32_16x16x32_bf16 v[208:211], a[112:115], v[72:75], v[208:211]
    v_cvt_pk_bf16_f32 v76, v56, v57
    v_accvgpr_read_b32 v29, a154
    v_mfma_f32_16x16x32_bf16 v[212:215], a[116:119], v[72:75], v[212:215]
    v_exp_f32 v58, v58
    v_mfma_f32_16x16x32_bf16 v[216:219], a[120:123], v[72:75], v[216:219]
    v_exp_f32 v59, v59
    v_mfma_f32_16x16x32_bf16 v[220:223], a[124:127], v[72:75], v[220:223]
    v_lshlrev_b32 v28, 16, v29
    v_cvt_pk_bf16_f32 v77, v58, v59
    v_and_b32 v29, 0xffff0000, v29
    v_exp_f32 v60, v60
    v_mfma_f32_16x16x32_bf16 v[40:43], a[64:67], a[16:19], v[84:87]
    s_waitcnt vmcnt(14) lgkmcnt(0)
    s_barrier
    v_mfma_f32_16x16x32_bf16 v[44:47], a[68:71], a[16:19], v[84:87]
    v_exp_f32 v61, v61
    v_mul_f32 v28, s39, v28
    v_mfma_f32_16x16x32_bf16 v[40:43], a[72:75], a[20:23], v[40:43]
    s_add_u32 m0, s29, 0
    v_mul_f32 v29, s39, v29
    v_cvt_pk_bf16_f32 v78, v60, v61
    v_exp_f32 v62, v62
    v_mfma_f32_16x16x32_bf16 v[44:47], a[76:79], a[20:23], v[44:47]
    s_mov_b32 s32, 63488
    v_exp_f32 v63, v63
    v_mfma_f32_16x16x32_bf16 v[40:43], a[80:83], a[24:27], v[40:43]
    s_mov_b32 s33, 63456
    v_cvt_pk_bf16_f32 v28, v28, v29
    v_cvt_pk_bf16_f32 v79, v62, v63
    v_mfma_f32_16x16x32_bf16 v[44:47], a[84:87], a[24:27], v[44:47]
    v_accvgpr_write_b32 a154, v28
    v_accvgpr_read_b32 v31, a155
    v_mfma_f32_16x16x32_bf16 v[40:43], a[88:91], a[28:31], v[40:43]
    v_exp_f32 v32, v32
    v_mfma_f32_16x16x32_bf16 v[44:47], a[92:95], a[28:31], v[44:47]
    v_exp_f32 v33, v33
    v_mfma_f32_16x16x32_bf16 v[224:227], a[96:99], v[76:79], v[224:227]
    buffer_load_dwordx4 v1, s[20:23], s32 offen offset:2048 nt lds
    v_lshlrev_b32 v30, 16, v31
    v_cvt_pk_bf16_f32 v64, v32, v33
    v_mfma_f32_16x16x32_bf16 v[228:231], a[100:103], v[76:79], v[228:231]
    v_exp_f32 v34, v34
    v_mfma_f32_16x16x32_bf16 v[232:235], a[104:107], v[76:79], v[232:235]
    ds_read_b64_tr_b16 a[96:97], v6 offset:16512
    v_and_b32 v31, 0xffff0000, v31
    v_mfma_f32_16x16x32_bf16 v[236:239], a[108:111], v[76:79], v[236:239]
    ds_read_b64_tr_b16 a[98:99], v6 offset:24768
    v_mul_f32 v30, s39, v30
    v_mfma_f32_16x16x32_bf16 v[240:243], a[112:115], v[76:79], v[240:243]
    s_waitcnt vmcnt(11)
    ds_read_b128 a[180:183], v7 offset:0
    ds_read_b128 a[184:187], v7 offset:256
    ds_read_b128 a[188:191], v7 offset:512
    ds_read_b128 a[192:195], v7 offset:768
    buffer_load_dwordx4 v1, s[20:23], s33 offen offset:3104 nt lds
    v_mfma_f32_16x16x32_bf16 v[244:247], a[116:119], v[76:79], v[244:247]
    ds_read_b64_tr_b16 a[100:101], v6 offset:16544
    v_mul_f32 v31, s39, v31
    v_mfma_f32_16x16x32_bf16 v[248:251], a[120:123], v[76:79], v[248:251]
    ds_read_b64_tr_b16 a[102:103], v6 offset:24800
    v_cvt_pk_bf16_f32 v30, v30, v31
    v_exp_f32 v35, v35
    v_mfma_f32_16x16x32_bf16 v[252:255], a[124:127], v[76:79], v[252:255]
    ds_read_b64_tr_b16 a[104:105], v6 offset:16768
    v_cvt_pk_bf16_f32 v65, v34, v35
    v_mfma_f32_16x16x32_bf16 a[144:147], a[128:131], v[76:79], a[144:147]
    ds_read_b64_tr_b16 a[106:107], v6 offset:25024
    v_accvgpr_write_b32 a155, v30
    v_exp_f32 v36, v36
    v_mfma_f32_16x16x32_bf16 v[48:51], a[64:67], a[32:35], v[88:91]
    v_exp_f32 v37, v37
    v_accvgpr_read_b32 v29, a156
    v_mfma_f32_16x16x32_bf16 v[52:55], a[68:71], a[32:35], v[88:91]
    s_waitcnt lgkmcnt(0)
    ds_read_b64_tr_b16 a[108:109], v6 offset:16800
    v_cvt_pk_bf16_f32 v66, v36, v37
    v_mfma_f32_16x16x32_bf16 v[48:51], a[72:75], a[36:39], v[48:51]
    ds_read_b64_tr_b16 a[110:111], v6 offset:25056
    v_lshlrev_b32 v28, 16, v29
    v_exp_f32 v38, v38
    v_mfma_f32_16x16x32_bf16 v[52:55], a[76:79], a[36:39], v[52:55]
    ds_read_b64_tr_b16 a[112:113], v6 offset:17024
    ds_read_b64_tr_b16 a[114:115], v6 offset:25280
    v_add_f32 v12, v12, v32
    v_exp_f32 v39, v39
    v_mfma_f32_16x16x32_bf16 v[48:51], a[80:83], a[40:43], v[48:51]
    ds_read_b64_tr_b16 a[116:117], v6 offset:17056
    ds_read_b64_tr_b16 a[118:119], v6 offset:25312
    v_and_b32 v29, 0xffff0000, v29
    v_mfma_f32_16x16x32_bf16 v[52:55], a[84:87], a[40:43], v[52:55]
    ds_read_b64_tr_b16 a[120:121], v6 offset:17280
    ds_read_b64_tr_b16 a[122:123], v6 offset:25536
    v_mul_f32 v28, s39, v28
    v_cvt_pk_bf16_f32 v67, v38, v39
    v_mfma_f32_16x16x32_bf16 v[48:51], a[88:91], a[44:47], v[48:51]
    s_add_u32 m0, s29, 16512
    ds_read_b64_tr_b16 a[124:125], v6 offset:17312
    ds_read_b64_tr_b16 a[126:127], v6 offset:25568
    v_mfma_f32_16x16x32_bf16 v[52:55], a[92:95], a[44:47], v[52:55]
    s_mov_b32 s31, 81920
    v_mul_f32 v29, s39, v29
    v_add_f32 v12, v12, v33
    v_mfma_f32_16x16x32_bf16 v[128:131], a[96:99], v[64:67], v[128:131]
    v_cvt_pk_bf16_f32 v28, v28, v29
    v_add_f32 v12, v12, v34
    v_mfma_f32_16x16x32_bf16 v[132:135], a[100:103], v[64:67], v[132:135]
    v_add_f32 v12, v12, v35
    v_add_f32 v12, v12, v36
    v_mfma_f32_16x16x32_bf16 v[136:139], a[104:107], v[64:67], v[136:139]
    s_waitcnt lgkmcnt(4)
    v_accvgpr_write_b32 a156, v28
    v_add_f32 v12, v12, v37
    v_exp_f32 v40, v40
    v_mfma_f32_16x16x32_bf16 v[140:143], a[108:111], v[64:67], v[140:143]
    v_accvgpr_read_b32 v31, a157
    v_add_f32 v12, v12, v38
    v_exp_f32 v41, v41
    v_mfma_f32_16x16x32_bf16 v[144:147], a[112:115], v[64:67], v[144:147]
    buffer_load_dwordx4 v1, s[16:19], s31 offen nt lds
    v_mfma_f32_16x16x32_bf16 v[148:151], a[116:119], v[64:67], v[148:151]
    s_waitcnt lgkmcnt(0)
    v_lshlrev_b32 v30, 16, v31
    v_cvt_pk_bf16_f32 v68, v40, v41
    v_exp_f32 v42, v42
    v_mfma_f32_16x16x32_bf16 v[152:155], a[120:123], v[64:67], v[152:155]
    v_and_b32 v31, 0xffff0000, v31
    v_add_f32 v12, v12, v39
    v_exp_f32 v43, v43
    v_mfma_f32_16x16x32_bf16 v[156:159], a[124:127], v[64:67], v[156:159]
    v_cvt_pk_bf16_f32 v69, v42, v43
    v_mul_f32 v30, s39, v30
    buffer_load_dwordx4 v1, s[16:19], s31 offen offset:1024 nt lds
    v_exp_f32 v44, v44
    v_mfma_f32_16x16x32_bf16 v[56:59], a[64:67], a[48:51], v[92:95]
    ds_read_b128 a[64:67], v4 offset:16512
    v_mul_f32 v31, s39, v31
    v_exp_f32 v45, v45
    v_mfma_f32_16x16x32_bf16 v[60:63], a[68:71], a[48:51], v[92:95]
    v_cvt_pk_bf16_f32 v70, v44, v45
    v_cvt_pk_bf16_f32 v30, v30, v31
    v_mfma_f32_16x16x32_bf16 v[56:59], a[72:75], a[52:55], v[56:59]
    v_exp_f32 v46, v46
    v_mfma_f32_16x16x32_bf16 v[60:63], a[76:79], a[52:55], v[60:63]
    ds_read_b128 a[68:71], v4 offset:24768
    v_accvgpr_write_b32 a157, v30
    v_exp_f32 v47, v47
    v_mfma_f32_16x16x32_bf16 v[56:59], a[80:83], a[56:59], v[56:59]
    ds_read_b128 a[72:75], v4 offset:16768
    v_cvt_pk_bf16_f32 v71, v46, v47
    v_mfma_f32_16x16x32_bf16 v[60:63], a[84:87], a[56:59], v[60:63]
    ds_read_b128 a[76:79], v4 offset:25024
    v_accvgpr_read_b32 v29, a158
    v_mfma_f32_16x16x32_bf16 v[56:59], a[88:91], a[60:63], v[56:59]
    ds_read_b128 a[80:83], v4 offset:17024
    v_lshlrev_b32 v28, 16, v29
    v_mfma_f32_16x16x32_bf16 v[60:63], a[92:95], a[60:63], v[60:63]
    v_exp_f32 v48, v48
    v_mfma_f32_16x16x32_bf16 v[160:163], a[96:99], v[68:71], v[160:163]
    ds_read_b128 a[84:87], v4 offset:25280
    v_and_b32 v29, 0xffff0000, v29
    v_mfma_f32_16x16x32_bf16 v[164:167], a[100:103], v[68:71], v[164:167]
    ds_read_b128 a[88:91], v4 offset:17280
    v_mul_f32 v28, s39, v28
    v_mfma_f32_16x16x32_bf16 v[168:171], a[104:107], v[68:71], v[168:171]
    s_add_u32 m0, s29, 16512
    v_exp_f32 v49, v49
    v_mfma_f32_16x16x32_bf16 v[172:175], a[108:111], v[68:71], v[172:175]
    s_mov_b32 s32, 71680
    v_mul_f32 v29, s39, v29
    v_cvt_pk_bf16_f32 v72, v48, v49
    v_mfma_f32_16x16x32_bf16 v[176:179], a[112:115], v[68:71], v[176:179]
    s_mov_b32 s33, 71648
    ds_read_b128 a[92:95], v4 offset:25536
    v_cvt_pk_bf16_f32 v28, v28, v29
    v_mfma_f32_16x16x32_bf16 v[180:183], a[116:119], v[68:71], v[180:183]
    v_exp_f32 v50, v50
    v_mfma_f32_16x16x32_bf16 v[184:187], a[120:123], v[68:71], v[184:187]
    v_accvgpr_write_b32 a158, v28
    v_add_f32 v14, v14, v48
    v_exp_f32 v51, v51
    v_mfma_f32_16x16x32_bf16 v[188:191], a[124:127], v[68:71], v[188:191]
    v_accvgpr_read_b32 v31, a159
    v_cvt_pk_bf16_f32 v73, v50, v51
    v_mfma_f32_16x16x32_bf16 a[136:139], a[128:131], v[68:71], a[136:139]
    s_waitcnt lgkmcnt(1)
    buffer_load_dwordx4 v1, s[20:23], s32 offen offset:2048 nt lds
    v_exp_f32 v52, v52
    v_mfma_f32_16x16x32_bf16 v[32:35], a[64:67], a[0:3], v[80:83]
    v_lshlrev_b32 v30, 16, v31
    v_add_f32 v14, v14, v49
    v_exp_f32 v53, v53
    v_mfma_f32_16x16x32_bf16 v[36:39], a[68:71], a[0:3], v[80:83]
    v_and_b32 v31, 0xffff0000, v31
    v_cvt_pk_bf16_f32 v74, v52, v53
    v_mfma_f32_16x16x32_bf16 v[32:35], a[72:75], a[4:7], v[32:35]
    v_exp_f32 v54, v54
    v_mfma_f32_16x16x32_bf16 v[36:39], a[76:79], a[4:7], v[36:39]
    buffer_load_dwordx4 v1, s[20:23], s33 offen offset:3104 nt lds
    v_mul_f32 v30, s39, v30
    v_add_f32 v14, v14, v50
    v_exp_f32 v55, v55
    v_mfma_f32_16x16x32_bf16 v[32:35], a[80:83], a[8:11], v[32:35]
    v_mul_f32 v31, s39, v31
    v_cvt_pk_bf16_f32 v75, v54, v55
    v_mfma_f32_16x16x32_bf16 v[36:39], a[84:87], a[8:11], v[36:39]
    v_add_f32 v14, v14, v51
    v_add_f32 v14, v14, v52
    v_mfma_f32_16x16x32_bf16 v[32:35], a[88:91], a[12:15], v[32:35]
    s_waitcnt lgkmcnt(0)
    v_cvt_pk_bf16_f32 v30, v30, v31
    v_add_f32 v14, v14, v53
    v_mfma_f32_16x16x32_bf16 v[36:39], a[92:95], a[12:15], v[36:39]
    v_accvgpr_write_b32 a159, v30
    v_add_f32 v14, v14, v54
    v_mfma_f32_16x16x32_bf16 v[192:195], a[96:99], v[72:75], v[192:195]
    v_exp_f32 v56, v56
    v_mfma_f32_16x16x32_bf16 v[196:199], a[100:103], v[72:75], v[196:199]
    v_accvgpr_read_b32 v29, a160
    v_add_f32 v14, v14, v55
    v_mfma_f32_16x16x32_bf16 v[200:203], a[104:107], v[72:75], v[200:203]
    v_exp_f32 v57, v57
    v_mfma_f32_16x16x32_bf16 v[204:207], a[108:111], v[72:75], v[204:207]
    v_lshlrev_b32 v28, 16, v29
    v_cvt_pk_bf16_f32 v76, v56, v57
    v_mfma_f32_16x16x32_bf16 v[208:211], a[112:115], v[72:75], v[208:211]
    v_and_b32 v29, 0xffff0000, v29
    v_mul_f32 v28, s39, v28
    v_mfma_f32_16x16x32_bf16 v[212:215], a[116:119], v[72:75], v[212:215]
    v_exp_f32 v58, v58
    v_mfma_f32_16x16x32_bf16 v[216:219], a[120:123], v[72:75], v[216:219]
    v_exp_f32 v59, v59
    v_mfma_f32_16x16x32_bf16 v[220:223], a[124:127], v[72:75], v[220:223]
    v_mul_f32 v29, s39, v29
    v_cvt_pk_bf16_f32 v77, v58, v59
    v_exp_f32 v60, v60
    v_mfma_f32_16x16x32_bf16 v[40:43], a[64:67], a[16:19], v[84:87]
    s_waitcnt vmcnt(12) lgkmcnt(0)
    s_barrier
    v_mfma_f32_16x16x32_bf16 v[44:47], a[68:71], a[16:19], v[84:87]
    v_cvt_pk_bf16_f32 v28, v28, v29
    v_accvgpr_write_b32 a160, v28
    v_exp_f32 v61, v61
    v_mfma_f32_16x16x32_bf16 v[40:43], a[72:75], a[20:23], v[40:43]
    s_add_u32 m0, s30, 0
    v_cvt_pk_bf16_f32 v78, v60, v61
    v_accvgpr_read_b32 v31, a161
    v_exp_f32 v62, v62
    v_mfma_f32_16x16x32_bf16 v[44:47], a[76:79], a[20:23], v[44:47]
    s_mov_b32 s42, 77824
    v_exp_f32 v63, v63
    v_mfma_f32_16x16x32_bf16 v[40:43], a[80:83], a[24:27], v[40:43]
    v_lshlrev_b32 v30, 16, v31
    v_cvt_pk_bf16_f32 v79, v62, v63
    v_mfma_f32_16x16x32_bf16 v[44:47], a[84:87], a[24:27], v[44:47]
    v_exp_f32 v32, v32
    v_mfma_f32_16x16x32_bf16 v[40:43], a[88:91], a[28:31], v[40:43]
    v_and_b32 v31, 0xffff0000, v31
    v_mul_f32 v30, s39, v30
    v_mfma_f32_16x16x32_bf16 v[44:47], a[92:95], a[28:31], v[44:47]
    v_exp_f32 v33, v33
    v_mfma_f32_16x16x32_bf16 v[224:227], a[96:99], v[76:79], v[224:227]
    buffer_load_dwordx4 v2, s[12:15], s42 offen nt lds
    v_mfma_f32_16x16x32_bf16 v[228:231], a[100:103], v[76:79], v[228:231]
    v_mul_f32 v31, s39, v31
    v_cvt_pk_bf16_f32 v64, v32, v33
    v_mfma_f32_16x16x32_bf16 v[232:235], a[104:107], v[76:79], v[232:235]
    ds_read_b64_tr_b16 a[96:97], v6 offset:33024
    v_cvt_pk_bf16_f32 v30, v30, v31
    v_mfma_f32_16x16x32_bf16 v[236:239], a[108:111], v[76:79], v[236:239]
    v_exp_f32 v34, v34
    v_mfma_f32_16x16x32_bf16 v[240:243], a[112:115], v[76:79], v[240:243]
    ds_read_b64_tr_b16 a[98:99], v6 offset:41280
    buffer_load_dwordx4 v2, s[12:15], s42 offen offset:1024 nt lds
    v_accvgpr_write_b32 a161, v30
    v_mfma_f32_16x16x32_bf16 v[244:247], a[116:119], v[76:79], v[244:247]
    ds_read_b64_tr_b16 a[100:101], v6 offset:33056
    v_accvgpr_read_b32 v29, a162
    v_mfma_f32_16x16x32_bf16 v[248:251], a[120:123], v[76:79], v[248:251]
    v_exp_f32 v35, v35
    v_mfma_f32_16x16x32_bf16 v[252:255], a[124:127], v[76:79], v[252:255]
    v_lshlrev_b32 v28, 16, v29
    v_cvt_pk_bf16_f32 v65, v34, v35
    v_mfma_f32_16x16x32_bf16 a[144:147], a[128:131], v[76:79], a[144:147]
    ds_read_b64_tr_b16 a[102:103], v6 offset:41312
    v_and_b32 v29, 0xffff0000, v29
    v_exp_f32 v36, v36
    v_mfma_f32_16x16x32_bf16 v[48:51], a[64:67], a[32:35], v[88:91]
    v_exp_f32 v37, v37
    v_mfma_f32_16x16x32_bf16 v[52:55], a[68:71], a[32:35], v[88:91]
    ds_read_b64_tr_b16 a[104:105], v6 offset:33280
    ds_read_b64_tr_b16 a[106:107], v6 offset:41536
    v_mul_f32 v28, s39, v28
    v_mfma_f32_16x16x32_bf16 v[48:51], a[72:75], a[36:39], v[48:51]
    ds_read_b64_tr_b16 a[108:109], v6 offset:33312
    ds_read_b64_tr_b16 a[110:111], v6 offset:41568
    v_mul_f32 v29, s39, v29
    v_cvt_pk_bf16_f32 v66, v36, v37
    v_exp_f32 v38, v38
    v_mfma_f32_16x16x32_bf16 v[52:55], a[76:79], a[36:39], v[52:55]
    ds_read_b64_tr_b16 a[112:113], v6 offset:33536
    ds_read_b64_tr_b16 a[114:115], v6 offset:41792
    v_add_f32 v12, v12, v32
    v_exp_f32 v39, v39
    v_mfma_f32_16x16x32_bf16 v[48:51], a[80:83], a[40:43], v[48:51]
    ds_read_b64_tr_b16 a[116:117], v6 offset:33568
    ds_read_b64_tr_b16 a[118:119], v6 offset:41824
    v_cvt_pk_bf16_f32 v28, v28, v29
    v_mfma_f32_16x16x32_bf16 v[52:55], a[84:87], a[40:43], v[52:55]
    ds_read_b64_tr_b16 a[120:121], v6 offset:33792
    ds_read_b64_tr_b16 a[122:123], v6 offset:42048
    v_accvgpr_write_b32 a162, v28
    v_cvt_pk_bf16_f32 v67, v38, v39
    v_mfma_f32_16x16x32_bf16 v[48:51], a[88:91], a[44:47], v[48:51]
    s_add_u32 m0, s30, 2080
    ds_read_b64_tr_b16 a[124:125], v6 offset:33824
    ds_read_b64_tr_b16 a[126:127], v6 offset:42080
    v_mfma_f32_16x16x32_bf16 v[52:55], a[92:95], a[44:47], v[52:55]
    s_mov_b32 s42, 79872
    v_accvgpr_read_b32 v31, a163
    v_add_f32 v12, v12, v33
    s_waitcnt lgkmcnt(8)
    v_mfma_f32_16x16x32_bf16 v[128:131], a[96:99], v[64:67], v[128:131]
    v_lshlrev_b32 v30, 16, v31
    v_add_f32 v12, v12, v34
    v_mfma_f32_16x16x32_bf16 v[132:135], a[100:103], v[64:67], v[132:135]
    v_add_f32 v12, v12, v35
    v_add_f32 v12, v12, v36
    v_mfma_f32_16x16x32_bf16 v[136:139], a[104:107], v[64:67], v[136:139]
    v_and_b32 v31, 0xffff0000, v31
    v_add_f32 v12, v12, v37
    v_exp_f32 v40, v40
    v_mfma_f32_16x16x32_bf16 v[140:143], a[108:111], v[64:67], v[140:143]
    s_waitcnt lgkmcnt(2)
    v_mul_f32 v30, s39, v30
    v_add_f32 v12, v12, v38
    v_exp_f32 v41, v41
    v_mfma_f32_16x16x32_bf16 v[144:147], a[112:115], v[64:67], v[144:147]
    buffer_load_dwordx4 v2, s[12:15], s42 offen nt lds
    v_mfma_f32_16x16x32_bf16 v[148:151], a[116:119], v[64:67], v[148:151]
    v_mul_f32 v31, s39, v31
    v_cvt_pk_bf16_f32 v68, v40, v41
    v_exp_f32 v42, v42
    v_mfma_f32_16x16x32_bf16 v[152:155], a[120:123], v[64:67], v[152:155]
    s_waitcnt lgkmcnt(0)
    v_cvt_pk_bf16_f32 v30, v30, v31
    v_add_f32 v12, v12, v39
    v_exp_f32 v43, v43
    v_mfma_f32_16x16x32_bf16 v[156:159], a[124:127], v[64:67], v[156:159]
    v_cvt_pk_bf16_f32 v69, v42, v43
    v_accvgpr_write_b32 a163, v30
    buffer_load_dwordx4 v2, s[12:15], s42 offen offset:1024 nt lds
    v_exp_f32 v44, v44
    v_mfma_f32_16x16x32_bf16 v[56:59], a[64:67], a[48:51], v[92:95]
    v_exp_f32 v45, v45
    v_accvgpr_read_b32 v29, a164
    v_mfma_f32_16x16x32_bf16 v[60:63], a[68:71], a[48:51], v[92:95]
    ds_read_b128 a[64:67], v4 offset:33024
    v_cvt_pk_bf16_f32 v70, v44, v45
    v_mfma_f32_16x16x32_bf16 v[56:59], a[72:75], a[52:55], v[56:59]
    ds_read_b128 a[68:71], v4 offset:41280
    v_lshlrev_b32 v28, 16, v29
    v_exp_f32 v46, v46
    v_mfma_f32_16x16x32_bf16 v[60:63], a[76:79], a[52:55], v[60:63]
    v_exp_f32 v47, v47
    v_mfma_f32_16x16x32_bf16 v[56:59], a[80:83], a[56:59], v[56:59]
    v_and_b32 v29, 0xffff0000, v29
    v_cvt_pk_bf16_f32 v71, v46, v47
    v_mfma_f32_16x16x32_bf16 v[60:63], a[84:87], a[56:59], v[60:63]
    ds_read_b128 a[72:75], v4 offset:33280
    v_mul_f32 v28, s39, v28
    v_mfma_f32_16x16x32_bf16 v[56:59], a[88:91], a[60:63], v[56:59]
    v_exp_f32 v48, v48
    v_mfma_f32_16x16x32_bf16 v[60:63], a[92:95], a[60:63], v[60:63]
    ds_read_b128 a[76:79], v4 offset:41536
    v_mul_f32 v29, s39, v29
    v_mfma_f32_16x16x32_bf16 v[160:163], a[96:99], v[68:71], v[160:163]
    ds_read_b128 a[80:83], v4 offset:33536
    v_cvt_pk_bf16_f32 v28, v28, v29
    v_mfma_f32_16x16x32_bf16 v[164:167], a[100:103], v[68:71], v[164:167]
    v_exp_f32 v49, v49
    v_mfma_f32_16x16x32_bf16 v[168:171], a[104:107], v[68:71], v[168:171]
    s_add_u32 m0, s29, 33024
    v_accvgpr_write_b32 a164, v28
    v_cvt_pk_bf16_f32 v72, v48, v49
    v_mfma_f32_16x16x32_bf16 v[172:175], a[108:111], v[68:71], v[172:175]
    s_mov_b32 s31, 90112
    ds_read_b128 a[84:87], v4 offset:41792
    v_accvgpr_read_b32 v31, a165
    v_mfma_f32_16x16x32_bf16 v[176:179], a[112:115], v[68:71], v[176:179]
    v_exp_f32 v50, v50
    v_mfma_f32_16x16x32_bf16 v[180:183], a[116:119], v[68:71], v[180:183]
    ds_read_b128 a[88:91], v4 offset:33792
    v_lshlrev_b32 v30, 16, v31
    v_mfma_f32_16x16x32_bf16 v[184:187], a[120:123], v[68:71], v[184:187]
    ds_read_b128 a[92:95], v4 offset:42048
    v_and_b32 v31, 0xffff0000, v31
    v_exp_f32 v51, v51
    v_mfma_f32_16x16x32_bf16 v[188:191], a[124:127], v[68:71], v[188:191]
    v_cvt_pk_bf16_f32 v73, v50, v51
    v_add_f32 v14, v14, v48
    v_mfma_f32_16x16x32_bf16 a[136:139], a[128:131], v[68:71], a[136:139]
    s_waitcnt lgkmcnt(3)
    buffer_load_dwordx4 v1, s[16:19], s31 offen nt lds
    v_mul_f32 v30, s39, v30
    v_add_f32 v14, v14, v49
    v_exp_f32 v52, v52
    v_mfma_f32_16x16x32_bf16 v[32:35], a[64:67], a[0:3], v[80:83]
    v_mul_f32 v31, s39, v31
    v_add_f32 v14, v14, v50
    v_exp_f32 v53, v53
    v_mfma_f32_16x16x32_bf16 v[36:39], a[68:71], a[0:3], v[80:83]
    v_cvt_pk_bf16_f32 v74, v52, v53
    v_add_f32 v14, v14, v51
    v_mfma_f32_16x16x32_bf16 v[32:35], a[72:75], a[4:7], v[32:35]
    v_cvt_pk_bf16_f32 v30, v30, v31
    v_accvgpr_write_b32 a165, v30
    v_exp_f32 v54, v54
    v_mfma_f32_16x16x32_bf16 v[36:39], a[76:79], a[4:7], v[36:39]
    buffer_load_dwordx4 v1, s[16:19], s31 offen offset:1024 nt lds
    v_exp_f32 v55, v55
    v_mfma_f32_16x16x32_bf16 v[32:35], a[80:83], a[8:11], v[32:35]
    s_waitcnt lgkmcnt(0)
    v_cvt_pk_bf16_f32 v75, v54, v55
    v_add_f32 v14, v14, v52
    v_mfma_f32_16x16x32_bf16 v[36:39], a[84:87], a[8:11], v[36:39]
    v_accvgpr_read_b32 v29, a166
    v_add_f32 v14, v14, v53
    v_mfma_f32_16x16x32_bf16 v[32:35], a[88:91], a[12:15], v[32:35]
    v_lshlrev_b32 v28, 16, v29
    v_and_b32 v29, 0xffff0000, v29
    v_mfma_f32_16x16x32_bf16 v[36:39], a[92:95], a[12:15], v[36:39]
    v_exp_f32 v56, v56
    v_mfma_f32_16x16x32_bf16 v[192:195], a[96:99], v[72:75], v[192:195]
    v_exp_f32 v57, v57
    v_mfma_f32_16x16x32_bf16 v[196:199], a[100:103], v[72:75], v[196:199]
    v_mul_f32 v28, s39, v28
    v_cvt_pk_bf16_f32 v76, v56, v57
    v_mfma_f32_16x16x32_bf16 v[200:203], a[104:107], v[72:75], v[200:203]
    v_exp_f32 v58, v58
    v_mfma_f32_16x16x32_bf16 v[204:207], a[108:111], v[72:75], v[204:207]
    v_mul_f32 v29, s39, v29
    v_add_f32 v14, v14, v54
    v_mfma_f32_16x16x32_bf16 v[208:211], a[112:115], v[72:75], v[208:211]
    v_cvt_pk_bf16_f32 v28, v28, v29
    v_add_f32 v14, v14, v55
    v_mfma_f32_16x16x32_bf16 v[212:215], a[116:119], v[72:75], v[212:215]
    v_exp_f32 v59, v59
    v_mfma_f32_16x16x32_bf16 v[216:219], a[120:123], v[72:75], v[216:219]
    v_accvgpr_write_b32 a166, v28
    v_cvt_pk_bf16_f32 v77, v58, v59
    v_mfma_f32_16x16x32_bf16 v[220:223], a[124:127], v[72:75], v[220:223]
    v_accvgpr_read_b32 v31, a167
    v_lshlrev_b32 v30, 16, v31
    v_exp_f32 v60, v60
    v_mfma_f32_16x16x32_bf16 v[40:43], a[64:67], a[16:19], v[84:87]
    s_waitcnt vmcnt(14) lgkmcnt(0)
    s_barrier
    v_mfma_f32_16x16x32_bf16 v[44:47], a[68:71], a[16:19], v[84:87]
    v_exp_f32 v61, v61
    v_and_b32 v31, 0xffff0000, v31
    v_mfma_f32_16x16x32_bf16 v[40:43], a[72:75], a[20:23], v[40:43]
    s_add_u32 m0, s29, 33024
    v_cvt_pk_bf16_f32 v78, v60, v61
    v_mul_f32 v30, s39, v30
    v_exp_f32 v62, v62
    v_mfma_f32_16x16x32_bf16 v[44:47], a[76:79], a[20:23], v[44:47]
    s_mov_b32 s32, 79872
    v_exp_f32 v63, v63
    v_mfma_f32_16x16x32_bf16 v[40:43], a[80:83], a[24:27], v[40:43]
    s_mov_b32 s33, 79840
    v_mul_f32 v31, s39, v31
    v_cvt_pk_bf16_f32 v79, v62, v63
    v_mfma_f32_16x16x32_bf16 v[44:47], a[84:87], a[24:27], v[44:47]
    v_exp_f32 v32, v32
    v_mfma_f32_16x16x32_bf16 v[40:43], a[88:91], a[28:31], v[40:43]
    v_cvt_pk_bf16_f32 v30, v30, v31
    v_accvgpr_write_b32 a167, v30
    v_mfma_f32_16x16x32_bf16 v[44:47], a[92:95], a[28:31], v[44:47]
    v_exp_f32 v33, v33
    v_mfma_f32_16x16x32_bf16 v[224:227], a[96:99], v[76:79], v[224:227]
    buffer_load_dwordx4 v1, s[20:23], s32 offen offset:2048 nt lds
    v_mfma_f32_16x16x32_bf16 v[228:231], a[100:103], v[76:79], v[228:231]
    v_accvgpr_read_b32 v29, a168
    v_cvt_pk_bf16_f32 v64, v32, v33
    v_mfma_f32_16x16x32_bf16 v[232:235], a[104:107], v[76:79], v[232:235]
    v_exp_f32 v34, v34
    v_mfma_f32_16x16x32_bf16 v[236:239], a[108:111], v[76:79], v[236:239]
    ds_read_b64_tr_b16 a[96:97], v6 offset:49536
    v_lshlrev_b32 v28, 16, v29
    v_mfma_f32_16x16x32_bf16 v[240:243], a[112:115], v[76:79], v[240:243]
    ds_read_b64_tr_b16 a[98:99], v6 offset:57792
    buffer_load_dwordx4 v1, s[20:23], s33 offen offset:3104 nt lds
    v_and_b32 v29, 0xffff0000, v29
    v_mfma_f32_16x16x32_bf16 v[244:247], a[116:119], v[76:79], v[244:247]
    v_exp_f32 v35, v35
    v_mfma_f32_16x16x32_bf16 v[248:251], a[120:123], v[76:79], v[248:251]
    v_mul_f32 v28, s39, v28
    v_cvt_pk_bf16_f32 v65, v34, v35
    v_mfma_f32_16x16x32_bf16 v[252:255], a[124:127], v[76:79], v[252:255]
    ds_read_b64_tr_b16 a[100:101], v6 offset:49568
    v_mul_f32 v29, s39, v29
    v_mfma_f32_16x16x32_bf16 a[144:147], a[128:131], v[76:79], a[144:147]
    v_exp_f32 v36, v36
    v_mfma_f32_16x16x32_bf16 v[48:51], a[64:67], a[32:35], v[88:91]
    ds_read_b64_tr_b16 a[102:103], v6 offset:57824
    v_cvt_pk_bf16_f32 v28, v28, v29
    v_exp_f32 v37, v37
    v_mfma_f32_16x16x32_bf16 v[52:55], a[68:71], a[32:35], v[88:91]
    ds_read_b64_tr_b16 a[104:105], v6 offset:49792
    ds_read_b64_tr_b16 a[106:107], v6 offset:58048
    v_accvgpr_write_b32 a168, v28
    v_mfma_f32_16x16x32_bf16 v[48:51], a[72:75], a[36:39], v[48:51]
    ds_read_b64_tr_b16 a[108:109], v6 offset:49824
    ds_read_b64_tr_b16 a[110:111], v6 offset:58080
    v_cvt_pk_bf16_f32 v66, v36, v37
    v_exp_f32 v38, v38
    v_mfma_f32_16x16x32_bf16 v[52:55], a[76:79], a[36:39], v[52:55]
    ds_read_b64_tr_b16 a[112:113], v6 offset:50048
    ds_read_b64_tr_b16 a[114:115], v6 offset:58304
    v_accvgpr_read_b32 v31, a169
    v_exp_f32 v39, v39
    v_mfma_f32_16x16x32_bf16 v[48:51], a[80:83], a[40:43], v[48:51]
    ds_read_b64_tr_b16 a[116:117], v6 offset:50080
    ds_read_b64_tr_b16 a[118:119], v6 offset:58336
    v_lshlrev_b32 v30, 16, v31
    v_mfma_f32_16x16x32_bf16 v[52:55], a[84:87], a[40:43], v[52:55]
    ds_read_b64_tr_b16 a[120:121], v6 offset:50304
    ds_read_b64_tr_b16 a[122:123], v6 offset:58560
    v_cvt_pk_bf16_f32 v67, v38, v39
    v_mfma_f32_16x16x32_bf16 v[48:51], a[88:91], a[44:47], v[48:51]
    s_add_u32 m0, s29, 49536
    ds_read_b64_tr_b16 a[124:125], v6 offset:50336
    ds_read_b64_tr_b16 a[126:127], v6 offset:58592
    v_and_b32 v31, 0xffff0000, v31
    v_mfma_f32_16x16x32_bf16 v[52:55], a[92:95], a[44:47], v[52:55]
    s_mov_b32 s31, 98304
    v_mul_f32 v30, s39, v30
    v_add_f32 v12, v12, v32
    s_waitcnt lgkmcnt(8)
    v_mfma_f32_16x16x32_bf16 v[128:131], a[96:99], v[64:67], v[128:131]
    v_add_f32 v12, v12, v33
    v_add_f32 v12, v12, v34
    v_mfma_f32_16x16x32_bf16 v[132:135], a[100:103], v[64:67], v[132:135]
    v_mul_f32 v31, s39, v31
    v_add_f32 v12, v12, v35
    v_mfma_f32_16x16x32_bf16 v[136:139], a[104:107], v[64:67], v[136:139]
    v_cvt_pk_bf16_f32 v30, v30, v31
    v_add_f32 v12, v12, v36
    v_exp_f32 v40, v40
    v_mfma_f32_16x16x32_bf16 v[140:143], a[108:111], v[64:67], v[140:143]
    s_waitcnt lgkmcnt(2)
    v_exp_f32 v41, v41
    v_mfma_f32_16x16x32_bf16 v[144:147], a[112:115], v[64:67], v[144:147]
    buffer_load_dwordx4 v1, s[16:19], s31 offen nt lds
    v_accvgpr_write_b32 a169, v30
    v_add_f32 v12, v12, v37
    v_mfma_f32_16x16x32_bf16 v[148:151], a[116:119], v[64:67], v[148:151]
    v_accvgpr_read_b32 v29, a170
    v_cvt_pk_bf16_f32 v68, v40, v41
    v_exp_f32 v42, v42
    v_mfma_f32_16x16x32_bf16 v[152:155], a[120:123], v[64:67], v[152:155]
    s_waitcnt lgkmcnt(0)
    v_exp_f32 v43, v43
    v_mfma_f32_16x16x32_bf16 v[156:159], a[124:127], v[64:67], v[156:159]
    v_lshlrev_b32 v28, 16, v29
    v_add_f32 v12, v12, v38
    buffer_load_dwordx4 v1, s[16:19], s31 offen offset:1024 nt lds
    v_and_b32 v29, 0xffff0000, v29
    v_cvt_pk_bf16_f32 v69, v42, v43
    v_exp_f32 v44, v44
    v_mfma_f32_16x16x32_bf16 v[56:59], a[64:67], a[48:51], v[92:95]
    v_exp_f32 v45, v45
    v_mfma_f32_16x16x32_bf16 v[60:63], a[68:71], a[48:51], v[92:95]
    v_mul_f32 v28, s39, v28
    v_add_f32 v12, v12, v39
    v_mfma_f32_16x16x32_bf16 v[56:59], a[72:75], a[52:55], v[56:59]
    v_mul_f32 v29, s39, v29
    v_cvt_pk_bf16_f32 v70, v44, v45
    v_exp_f32 v46, v46
    v_mfma_f32_16x16x32_bf16 v[60:63], a[76:79], a[52:55], v[60:63]
    v_exp_f32 v47, v47
    v_mfma_f32_16x16x32_bf16 v[56:59], a[80:83], a[56:59], v[56:59]
    v_cvt_pk_bf16_f32 v28, v28, v29
    v_cvt_pk_bf16_f32 v71, v46, v47
    v_mfma_f32_16x16x32_bf16 v[60:63], a[84:87], a[56:59], v[60:63]
    ds_read_b128 a[64:67], v4 offset:49536
    v_accvgpr_write_b32 a170, v28
    v_mfma_f32_16x16x32_bf16 v[56:59], a[88:91], a[60:63], v[56:59]
    ds_read_b128 a[68:71], v4 offset:57792
    ds_read_b128 a[72:75], v4 offset:49792
    v_mfma_f32_16x16x32_bf16 v[60:63], a[92:95], a[60:63], v[60:63]
    ds_read_b128 a[76:79], v4 offset:58048
    v_accvgpr_read_b32 v31, a171
    v_mfma_f32_16x16x32_bf16 v[160:163], a[96:99], v[68:71], v[160:163]
    ds_read_b128 a[80:83], v4 offset:50048
    v_lshlrev_b32 v30, 16, v31
    v_mfma_f32_16x16x32_bf16 v[164:167], a[100:103], v[68:71], v[164:167]
    v_exp_f32 v48, v48
    v_mfma_f32_16x16x32_bf16 v[168:171], a[104:107], v[68:71], v[168:171]
    s_add_u32 m0, s29, 49536
    ds_read_b128 a[84:87], v4 offset:58304
    v_and_b32 v31, 0xffff0000, v31
    v_mfma_f32_16x16x32_bf16 v[172:175], a[108:111], v[68:71], v[172:175]
    s_mov_b32 s32, 88064
    ds_read_b128 a[88:91], v4 offset:50304
    v_mul_f32 v30, s39, v30
    v_exp_f32 v49, v49
    v_mfma_f32_16x16x32_bf16 v[176:179], a[112:115], v[68:71], v[176:179]
    s_mov_b32 s33, 88032
    ds_read_b128 a[92:95], v4 offset:58560
    v_cvt_pk_bf16_f32 v72, v48, v49
    v_mfma_f32_16x16x32_bf16 v[180:183], a[116:119], v[68:71], v[180:183]
    v_mul_f32 v31, s39, v31
    v_cvt_pk_bf16_f32 v30, v30, v31
    v_exp_f32 v50, v50
    v_mfma_f32_16x16x32_bf16 v[184:187], a[120:123], v[68:71], v[184:187]
    v_exp_f32 v51, v51
    v_mfma_f32_16x16x32_bf16 v[188:191], a[124:127], v[68:71], v[188:191]
    v_cvt_pk_bf16_f32 v73, v50, v51
    v_add_f32 v14, v14, v48
    v_mfma_f32_16x16x32_bf16 a[136:139], a[128:131], v[68:71], a[136:139]
    s_waitcnt lgkmcnt(2)
    buffer_load_dwordx4 v1, s[20:23], s32 offen offset:2048 nt lds
    v_accvgpr_write_b32 a171, v30
    v_add_f32 v14, v14, v49
    v_exp_f32 v52, v52
    v_mfma_f32_16x16x32_bf16 v[32:35], a[64:67], a[0:3], v[80:83]
    v_exp_f32 v53, v53
    v_accvgpr_read_b32 v29, a172
    v_mfma_f32_16x16x32_bf16 v[36:39], a[68:71], a[0:3], v[80:83]
    v_cvt_pk_bf16_f32 v74, v52, v53
    v_add_f32 v14, v14, v50
    v_mfma_f32_16x16x32_bf16 v[32:35], a[72:75], a[4:7], v[32:35]
    v_lshlrev_b32 v28, 16, v29
    v_add_f32 v14, v14, v51
    v_exp_f32 v54, v54
    v_mfma_f32_16x16x32_bf16 v[36:39], a[76:79], a[4:7], v[36:39]
    buffer_load_dwordx4 v1, s[20:23], s33 offen offset:3104 nt lds
    v_exp_f32 v55, v55
    v_mfma_f32_16x16x32_bf16 v[32:35], a[80:83], a[8:11], v[32:35]
    v_and_b32 v29, 0xffff0000, v29
    v_cvt_pk_bf16_f32 v75, v54, v55
    v_mfma_f32_16x16x32_bf16 v[36:39], a[84:87], a[8:11], v[36:39]
    s_waitcnt lgkmcnt(0)
    v_mul_f32 v28, s39, v28
    v_add_f32 v14, v14, v52
    v_mfma_f32_16x16x32_bf16 v[32:35], a[88:91], a[12:15], v[32:35]
    v_exp_f32 v56, v56
    v_mfma_f32_16x16x32_bf16 v[36:39], a[92:95], a[12:15], v[36:39]
    v_mul_f32 v29, s39, v29
    v_add_f32 v14, v14, v53
    v_mfma_f32_16x16x32_bf16 v[192:195], a[96:99], v[72:75], v[192:195]
    v_cvt_pk_bf16_f32 v28, v28, v29
    v_add_f32 v14, v14, v54
    v_mfma_f32_16x16x32_bf16 v[196:199], a[100:103], v[72:75], v[196:199]
    v_exp_f32 v57, v57
    v_mfma_f32_16x16x32_bf16 v[200:203], a[104:107], v[72:75], v[200:203]
    v_accvgpr_write_b32 a172, v28
    v_cvt_pk_bf16_f32 v76, v56, v57
    v_mfma_f32_16x16x32_bf16 v[204:207], a[108:111], v[72:75], v[204:207]
    v_accvgpr_read_b32 v31, a173
    v_add_f32 v14, v14, v55
    v_mfma_f32_16x16x32_bf16 v[208:211], a[112:115], v[72:75], v[208:211]
    v_exp_f32 v58, v58
    v_mfma_f32_16x16x32_bf16 v[212:215], a[116:119], v[72:75], v[212:215]
    v_lshlrev_b32 v30, 16, v31
    v_and_b32 v31, 0xffff0000, v31
    v_mfma_f32_16x16x32_bf16 v[216:219], a[120:123], v[72:75], v[216:219]
    v_exp_f32 v59, v59
    v_mfma_f32_16x16x32_bf16 v[220:223], a[124:127], v[72:75], v[220:223]
    v_cvt_pk_bf16_f32 v77, v58, v59
    v_mul_f32 v30, s39, v30
    v_exp_f32 v60, v60
    v_mfma_f32_16x16x32_bf16 v[40:43], a[64:67], a[16:19], v[84:87]
    s_waitcnt vmcnt(12) lgkmcnt(0)
    s_barrier
    v_mfma_f32_16x16x32_bf16 v[44:47], a[68:71], a[16:19], v[84:87]
    v_mul_f32 v31, s39, v31
    v_cvt_pk_bf16_f32 v30, v30, v31
    v_exp_f32 v61, v61
    v_mfma_f32_16x16x32_bf16 v[40:43], a[72:75], a[20:23], v[40:43]
    s_add_u32 m0, s29, 66048
    v_cvt_pk_bf16_f32 v78, v60, v61
    v_accvgpr_write_b32 a173, v30
    v_exp_f32 v62, v62
    v_mfma_f32_16x16x32_bf16 v[44:47], a[76:79], a[20:23], v[44:47]
    s_mov_b32 s31, 106496
    v_exp_f32 v63, v63
    v_mfma_f32_16x16x32_bf16 v[40:43], a[80:83], a[24:27], v[40:43]
    v_cvt_pk_bf16_f32 v79, v62, v63
    v_accvgpr_read_b32 v29, a174
    v_mfma_f32_16x16x32_bf16 v[44:47], a[84:87], a[24:27], v[44:47]
    v_exp_f32 v32, v32
    v_mfma_f32_16x16x32_bf16 v[40:43], a[88:91], a[28:31], v[40:43]
    v_lshlrev_b32 v28, 16, v29
    v_and_b32 v29, 0xffff0000, v29
    v_mfma_f32_16x16x32_bf16 v[44:47], a[92:95], a[28:31], v[44:47]
    v_exp_f32 v33, v33
    v_mfma_f32_16x16x32_bf16 v[224:227], a[96:99], v[76:79], v[224:227]
    ds_read_b64_tr_b16 a[96:97], v5 offset:0
    v_cvt_pk_bf16_f32 v64, v32, v33
    v_mfma_f32_16x16x32_bf16 v[228:231], a[100:103], v[76:79], v[228:231]
    ds_read_b64_tr_b16 a[98:99], v5 offset:8256
    v_mul_f32 v28, s39, v28
    v_mfma_f32_16x16x32_bf16 v[232:235], a[104:107], v[76:79], v[232:235]
    v_exp_f32 v34, v34
    v_mfma_f32_16x16x32_bf16 v[236:239], a[108:111], v[76:79], v[236:239]
    ds_read_b64_tr_b16 a[100:101], v5 offset:32
    v_mul_f32 v29, s39, v29
    v_mfma_f32_16x16x32_bf16 v[240:243], a[112:115], v[76:79], v[240:243]
    ds_read_b64_tr_b16 a[102:103], v5 offset:8288
    v_cvt_pk_bf16_f32 v28, v28, v29
    v_mfma_f32_16x16x32_bf16 v[244:247], a[116:119], v[76:79], v[244:247]
    v_exp_f32 v35, v35
    v_mfma_f32_16x16x32_bf16 v[248:251], a[120:123], v[76:79], v[248:251]
    v_accvgpr_write_b32 a174, v28
    v_cvt_pk_bf16_f32 v65, v34, v35
    v_mfma_f32_16x16x32_bf16 v[252:255], a[124:127], v[76:79], v[252:255]
    ds_read_b64_tr_b16 a[104:105], v5 offset:256
    v_accvgpr_read_b32 v31, a175
    v_mfma_f32_16x16x32_bf16 a[144:147], a[128:131], v[76:79], a[144:147]
    buffer_load_dwordx4 v1, s[16:19], s31 offen nt lds
    v_exp_f32 v36, v36
    v_mfma_f32_16x16x32_bf16 v[48:51], a[64:67], a[32:35], v[88:91]
    ds_read_b64_tr_b16 a[106:107], v5 offset:8512
    v_lshlrev_b32 v30, 16, v31
    v_exp_f32 v37, v37
    v_mfma_f32_16x16x32_bf16 v[52:55], a[68:71], a[32:35], v[88:91]
    v_and_b32 v31, 0xffff0000, v31
    v_cvt_pk_bf16_f32 v66, v36, v37
    v_mfma_f32_16x16x32_bf16 v[48:51], a[72:75], a[36:39], v[48:51]
    ds_read_b64_tr_b16 a[108:109], v5 offset:288
    ds_read_b64_tr_b16 a[110:111], v5 offset:8544
    v_exp_f32 v38, v38
    v_mfma_f32_16x16x32_bf16 v[52:55], a[76:79], a[36:39], v[52:55]
    ds_read_b64_tr_b16 a[112:113], v5 offset:512
    ds_read_b64_tr_b16 a[114:115], v5 offset:8768
    buffer_load_dwordx4 v1, s[16:19], s31 offen offset:1024 nt lds
    v_mul_f32 v30, s39, v30
    v_exp_f32 v39, v39
    v_mfma_f32_16x16x32_bf16 v[48:51], a[80:83], a[40:43], v[48:51]
    ds_read_b64_tr_b16 a[116:117], v5 offset:544
    ds_read_b64_tr_b16 a[118:119], v5 offset:8800
    v_mul_f32 v31, s39, v31
    v_mfma_f32_16x16x32_bf16 v[52:55], a[84:87], a[40:43], v[52:55]
    ds_read_b64_tr_b16 a[120:121], v5 offset:768
    ds_read_b64_tr_b16 a[122:123], v5 offset:9024
    v_cvt_pk_bf16_f32 v67, v38, v39
    v_mfma_f32_16x16x32_bf16 v[48:51], a[88:91], a[44:47], v[48:51]
    ds_read_b64_tr_b16 a[124:125], v5 offset:800
    ds_read_b64_tr_b16 a[126:127], v5 offset:9056
    v_cvt_pk_bf16_f32 v30, v30, v31
    v_mfma_f32_16x16x32_bf16 v[52:55], a[92:95], a[44:47], v[52:55]
    s_waitcnt lgkmcnt(10)
    v_accvgpr_write_b32 a175, v30
    v_add_f32 v12, v12, v32
    v_mfma_f32_16x16x32_bf16 v[128:131], a[96:99], v[64:67], v[128:131]
    v_add_f32 v12, v12, v33
    v_add_f32 v12, v12, v34
    v_mfma_f32_16x16x32_bf16 v[132:135], a[100:103], v[64:67], v[132:135]
    v_accvgpr_read_b32 v29, a176
    v_add_f32 v12, v12, v35
    v_mfma_f32_16x16x32_bf16 v[136:139], a[104:107], v[64:67], v[136:139]
    s_waitcnt lgkmcnt(4)
    v_exp_f32 v40, v40
    v_mfma_f32_16x16x32_bf16 v[140:143], a[108:111], v[64:67], v[140:143]
    v_lshlrev_b32 v28, 16, v29
    v_add_f32 v12, v12, v36
    v_exp_f32 v41, v41
    v_mfma_f32_16x16x32_bf16 v[144:147], a[112:115], v[64:67], v[144:147]
    v_and_b32 v29, 0xffff0000, v29
    v_add_f32 v12, v12, v37
    v_mfma_f32_16x16x32_bf16 v[148:151], a[116:119], v[64:67], v[148:151]
    s_waitcnt lgkmcnt(0)
    v_cvt_pk_bf16_f32 v68, v40, v41
    v_add_f32 v12, v12, v38
    v_exp_f32 v42, v42
    v_mfma_f32_16x16x32_bf16 v[152:155], a[120:123], v[64:67], v[152:155]
    v_mul_f32 v28, s39, v28
    v_add_f32 v12, v12, v39
    v_exp_f32 v43, v43
    v_mfma_f32_16x16x32_bf16 v[156:159], a[124:127], v[64:67], v[156:159]
    v_mul_f32 v29, s39, v29
    v_cvt_pk_bf16_f32 v69, v42, v43
    v_exp_f32 v44, v44
    v_mfma_f32_16x16x32_bf16 v[56:59], a[64:67], a[48:51], v[92:95]
    s_add_u32 m0, s29, 66048
    ds_read_b128 a[64:67], v3 offset:0
    v_cvt_pk_bf16_f32 v28, v28, v29
    v_exp_f32 v45, v45
    v_mfma_f32_16x16x32_bf16 v[60:63], a[68:71], a[48:51], v[92:95]
    s_mov_b32 s32, 96256
    v_accvgpr_write_b32 a176, v28
    v_cvt_pk_bf16_f32 v70, v44, v45
    v_mfma_f32_16x16x32_bf16 v[56:59], a[72:75], a[52:55], v[56:59]
    s_mov_b32 s33, 96224
    v_exp_f32 v46, v46
    v_mfma_f32_16x16x32_bf16 v[60:63], a[76:79], a[52:55], v[60:63]
    ds_read_b128 a[68:71], v3 offset:8256
    v_accvgpr_read_b32 v31, a177
    v_exp_f32 v47, v47
    v_mfma_f32_16x16x32_bf16 v[56:59], a[80:83], a[56:59], v[56:59]
    v_lshlrev_b32 v30, 16, v31
    v_cvt_pk_bf16_f32 v71, v46, v47
    v_mfma_f32_16x16x32_bf16 v[60:63], a[84:87], a[56:59], v[60:63]
    ds_read_b128 a[72:75], v3 offset:256
    ds_read_b128 a[76:79], v3 offset:8512
    v_mfma_f32_16x16x32_bf16 v[56:59], a[88:91], a[60:63], v[56:59]
    ds_read_b128 a[80:83], v3 offset:512
    v_and_b32 v31, 0xffff0000, v31
    v_mfma_f32_16x16x32_bf16 v[60:63], a[92:95], a[60:63], v[60:63]
    ds_read_b128 a[84:87], v3 offset:8768
    v_mul_f32 v30, s39, v30
    v_mfma_f32_16x16x32_bf16 v[160:163], a[96:99], v[68:71], v[160:163]
    v_exp_f32 v48, v48
    v_mfma_f32_16x16x32_bf16 v[164:167], a[100:103], v[68:71], v[164:167]
    ds_read_b128 a[88:91], v3 offset:768
    v_mul_f32 v31, s39, v31
    v_mfma_f32_16x16x32_bf16 v[168:171], a[104:107], v[68:71], v[168:171]
    ds_read_b128 a[92:95], v3 offset:9024
    v_cvt_pk_bf16_f32 v30, v30, v31
    v_mfma_f32_16x16x32_bf16 v[172:175], a[108:111], v[68:71], v[172:175]
    v_exp_f32 v49, v49
    v_mfma_f32_16x16x32_bf16 v[176:179], a[112:115], v[68:71], v[176:179]
    v_accvgpr_write_b32 a177, v30
    v_cvt_pk_bf16_f32 v72, v48, v49
    v_mfma_f32_16x16x32_bf16 v[180:183], a[116:119], v[68:71], v[180:183]
    v_accvgpr_read_b32 v29, a178
    v_add_f32 v14, v14, v48
    v_exp_f32 v50, v50
    v_mfma_f32_16x16x32_bf16 v[184:187], a[120:123], v[68:71], v[184:187]
    buffer_load_dwordx4 v1, s[20:23], s32 offen offset:2048 nt lds
    v_exp_f32 v51, v51
    v_mfma_f32_16x16x32_bf16 v[188:191], a[124:127], v[68:71], v[188:191]
    v_lshlrev_b32 v28, 16, v29
    v_cvt_pk_bf16_f32 v73, v50, v51
    v_mfma_f32_16x16x32_bf16 a[136:139], a[128:131], v[68:71], a[136:139]
    s_waitcnt lgkmcnt(0)
    v_and_b32 v29, 0xffff0000, v29
    v_add_f32 v14, v14, v49
    v_exp_f32 v52, v52
    v_mfma_f32_16x16x32_bf16 v[32:35], a[64:67], a[0:3], v[80:83]
    v_exp_f32 v53, v53
    v_mfma_f32_16x16x32_bf16 v[36:39], a[68:71], a[0:3], v[80:83]
    buffer_load_dwordx4 v1, s[20:23], s33 offen offset:3104 nt lds
    v_mul_f32 v28, s39, v28
    v_cvt_pk_bf16_f32 v74, v52, v53
    v_mfma_f32_16x16x32_bf16 v[32:35], a[72:75], a[4:7], v[32:35]
    v_mul_f32 v29, s39, v29
    v_add_f32 v14, v14, v50
    v_exp_f32 v54, v54
    v_mfma_f32_16x16x32_bf16 v[36:39], a[76:79], a[4:7], v[36:39]
    v_exp_f32 v55, v55
    v_mfma_f32_16x16x32_bf16 v[32:35], a[80:83], a[8:11], v[32:35]
    v_cvt_pk_bf16_f32 v28, v28, v29
    v_cvt_pk_bf16_f32 v75, v54, v55
    v_mfma_f32_16x16x32_bf16 v[36:39], a[84:87], a[8:11], v[36:39]
    v_accvgpr_write_b32 a178, v28
    v_add_f32 v14, v14, v51
    v_mfma_f32_16x16x32_bf16 v[32:35], a[88:91], a[12:15], v[32:35]
    v_exp_f32 v56, v56
    v_mfma_f32_16x16x32_bf16 v[36:39], a[92:95], a[12:15], v[36:39]
    v_accvgpr_read_b32 v31, a179
    v_add_f32 v14, v14, v52
    v_mfma_f32_16x16x32_bf16 v[192:195], a[96:99], v[72:75], v[192:195]
    v_lshlrev_b32 v30, 16, v31
    v_add_f32 v14, v14, v53
    v_mfma_f32_16x16x32_bf16 v[196:199], a[100:103], v[72:75], v[196:199]
    v_exp_f32 v57, v57
    v_mfma_f32_16x16x32_bf16 v[200:203], a[104:107], v[72:75], v[200:203]
    v_and_b32 v31, 0xffff0000, v31
    v_cvt_pk_bf16_f32 v76, v56, v57
    v_mfma_f32_16x16x32_bf16 v[204:207], a[108:111], v[72:75], v[204:207]
    v_mul_f32 v30, s39, v30
    v_add_f32 v14, v14, v54
    v_mfma_f32_16x16x32_bf16 v[208:211], a[112:115], v[72:75], v[208:211]
    v_exp_f32 v58, v58
    v_mfma_f32_16x16x32_bf16 v[212:215], a[116:119], v[72:75], v[212:215]
    v_mul_f32 v31, s39, v31
    v_add_f32 v14, v14, v55
    v_mfma_f32_16x16x32_bf16 v[216:219], a[120:123], v[72:75], v[216:219]
    v_cvt_pk_bf16_f32 v30, v30, v31
    v_accvgpr_write_b32 a179, v30
    v_exp_f32 v59, v59
    v_mfma_f32_16x16x32_bf16 v[220:223], a[124:127], v[72:75], v[220:223]
    v_exp_f32 v60, v60
    v_cvt_pk_bf16_f32 v77, v58, v59
    v_mfma_f32_16x16x32_bf16 v[40:43], a[64:67], a[16:19], v[84:87]
    v_exp_f32 v61, v61
    v_accvgpr_read_b32 v29, a180
    v_mfma_f32_16x16x32_bf16 v[44:47], a[68:71], a[16:19], v[84:87]
    v_cvt_pk_bf16_f32 v78, v60, v61
    v_lshlrev_b32 v28, 16, v29
    v_mfma_f32_16x16x32_bf16 v[40:43], a[72:75], a[20:23], v[40:43]
    s_add_u32 m0, s29, 82560
    v_exp_f32 v62, v62
    v_mfma_f32_16x16x32_bf16 v[44:47], a[76:79], a[20:23], v[44:47]
    s_mov_b32 s31, 114688
    v_exp_f32 v63, v63
    v_mfma_f32_16x16x32_bf16 v[40:43], a[80:83], a[24:27], v[40:43]
    v_and_b32 v29, 0xffff0000, v29
    v_cvt_pk_bf16_f32 v79, v62, v63
    v_mfma_f32_16x16x32_bf16 v[44:47], a[84:87], a[24:27], v[44:47]
    v_mul_f32 v28, s39, v28
    v_mul_f32 v29, s39, v29
    v_mfma_f32_16x16x32_bf16 v[40:43], a[88:91], a[28:31], v[40:43]
    v_exp_f32 v32, v32
    v_mfma_f32_16x16x32_bf16 v[44:47], a[92:95], a[28:31], v[44:47]
    v_exp_f32 v33, v33
    v_mfma_f32_16x16x32_bf16 v[224:227], a[96:99], v[76:79], v[224:227]
    v_cvt_pk_bf16_f32 v28, v28, v29
    v_cvt_pk_bf16_f32 v64, v32, v33
    v_mfma_f32_16x16x32_bf16 v[228:231], a[100:103], v[76:79], v[228:231]
    v_exp_f32 v34, v34
    v_mfma_f32_16x16x32_bf16 v[232:235], a[104:107], v[76:79], v[232:235]
    ds_read_b64_tr_b16 a[96:97], v5 offset:16512
    v_accvgpr_write_b32 a180, v28
    v_mfma_f32_16x16x32_bf16 v[236:239], a[108:111], v[76:79], v[236:239]
    ds_read_b64_tr_b16 a[98:99], v5 offset:24768
    v_accvgpr_read_b32 v31, a181
    v_mfma_f32_16x16x32_bf16 v[240:243], a[112:115], v[76:79], v[240:243]
    s_waitcnt vmcnt(12)
    ds_read_b128 a[196:199], v7 offset:0
    ds_read_b128 a[200:203], v7 offset:256
    ds_read_b128 a[204:207], v7 offset:512
    ds_read_b128 a[208:211], v7 offset:768
    v_mfma_f32_16x16x32_bf16 v[244:247], a[116:119], v[76:79], v[244:247]
    ds_read_b64_tr_b16 a[100:101], v5 offset:16544
    v_lshlrev_b32 v30, 16, v31
    v_mfma_f32_16x16x32_bf16 v[248:251], a[120:123], v[76:79], v[248:251]
    ds_read_b64_tr_b16 a[102:103], v5 offset:24800
    v_and_b32 v31, 0xffff0000, v31
    v_exp_f32 v35, v35
    v_mfma_f32_16x16x32_bf16 v[252:255], a[124:127], v[76:79], v[252:255]
    ds_read_b64_tr_b16 a[104:105], v5 offset:16768
    v_cvt_pk_bf16_f32 v65, v34, v35
    v_mfma_f32_16x16x32_bf16 a[144:147], a[128:131], v[76:79], a[144:147]
    ds_read_b64_tr_b16 a[106:107], v5 offset:25024
    buffer_load_dwordx4 v1, s[16:19], s31 offen nt lds
    v_mul_f32 v30, s39, v30
    v_exp_f32 v36, v36
    v_mfma_f32_16x16x32_bf16 v[48:51], a[64:67], a[32:35], v[88:91]
    ds_read_b64_tr_b16 a[108:109], v5 offset:16800
    v_mul_f32 v31, s39, v31
    v_exp_f32 v37, v37
    v_mfma_f32_16x16x32_bf16 v[52:55], a[68:71], a[32:35], v[88:91]
    s_waitcnt lgkmcnt(0)
    ds_read_b64_tr_b16 a[110:111], v5 offset:25056
    v_cvt_pk_bf16_f32 v66, v36, v37
    v_mfma_f32_16x16x32_bf16 v[48:51], a[72:75], a[36:39], v[48:51]
    v_cvt_pk_bf16_f32 v30, v30, v31
    v_add_f32 v12, v12, v32
    v_exp_f32 v38, v38
    v_mfma_f32_16x16x32_bf16 v[52:55], a[76:79], a[36:39], v[52:55]
    ds_read_b64_tr_b16 a[112:113], v5 offset:17024
    ds_read_b64_tr_b16 a[114:115], v5 offset:25280
    buffer_load_dwordx4 v1, s[16:19], s31 offen offset:1024 nt lds
    v_accvgpr_write_b32 a181, v30
    v_exp_f32 v39, v39
    v_mfma_f32_16x16x32_bf16 v[48:51], a[80:83], a[40:43], v[48:51]
    ds_read_b64_tr_b16 a[116:117], v5 offset:17056
    ds_read_b64_tr_b16 a[118:119], v5 offset:25312
    v_mfma_f32_16x16x32_bf16 v[52:55], a[84:87], a[40:43], v[52:55]
    ds_read_b64_tr_b16 a[120:121], v5 offset:17280
    ds_read_b64_tr_b16 a[122:123], v5 offset:25536
    v_accvgpr_read_b32 v29, a182
    v_cvt_pk_bf16_f32 v67, v38, v39
    v_mfma_f32_16x16x32_bf16 v[48:51], a[88:91], a[44:47], v[48:51]
    ds_read_b64_tr_b16 a[124:125], v5 offset:17312
    ds_read_b64_tr_b16 a[126:127], v5 offset:25568
    v_lshlrev_b32 v28, 16, v29
    v_mfma_f32_16x16x32_bf16 v[52:55], a[92:95], a[44:47], v[52:55]
    v_add_f32 v12, v12, v33
    v_add_f32 v12, v12, v34
    v_mfma_f32_16x16x32_bf16 v[128:131], a[96:99], v[64:67], v[128:131]
    v_and_b32 v29, 0xffff0000, v29
    v_add_f32 v12, v12, v35
    v_mfma_f32_16x16x32_bf16 v[132:135], a[100:103], v[64:67], v[132:135]
    v_mul_f32 v28, s39, v28
    v_add_f32 v12, v12, v36
    v_mfma_f32_16x16x32_bf16 v[136:139], a[104:107], v[64:67], v[136:139]
    s_waitcnt lgkmcnt(4)
    v_exp_f32 v40, v40
    v_mfma_f32_16x16x32_bf16 v[140:143], a[108:111], v[64:67], v[140:143]
    v_mul_f32 v29, s39, v29
    v_add_f32 v12, v12, v37
    v_exp_f32 v41, v41
    v_mfma_f32_16x16x32_bf16 v[144:147], a[112:115], v[64:67], v[144:147]
    v_cvt_pk_bf16_f32 v28, v28, v29
    v_cvt_pk_bf16_f32 v68, v40, v41
    v_mfma_f32_16x16x32_bf16 v[148:151], a[116:119], v[64:67], v[148:151]
    s_waitcnt lgkmcnt(0)
    v_exp_f32 v42, v42
    v_mfma_f32_16x16x32_bf16 v[152:155], a[120:123], v[64:67], v[152:155]
    v_accvgpr_write_b32 a182, v28
    v_add_f32 v12, v12, v38
    v_exp_f32 v43, v43
    v_mfma_f32_16x16x32_bf16 v[156:159], a[124:127], v[64:67], v[156:159]
    v_accvgpr_read_b32 v31, a183
    v_add_f32 v12, v12, v39
    v_cvt_pk_bf16_f32 v69, v42, v43
    v_exp_f32 v44, v44
    v_mfma_f32_16x16x32_bf16 v[56:59], a[64:67], a[48:51], v[92:95]
    s_add_u32 m0, s29, 82560
    ds_read_b128 a[64:67], v3 offset:16512
    v_lshlrev_b32 v30, 16, v31
    v_exp_f32 v45, v45
    v_mfma_f32_16x16x32_bf16 v[60:63], a[68:71], a[48:51], v[92:95]
    s_mov_b32 s32, 104448
    v_and_b32 v31, 0xffff0000, v31
    v_cvt_pk_bf16_f32 v70, v44, v45
    v_mfma_f32_16x16x32_bf16 v[56:59], a[72:75], a[52:55], v[56:59]
    s_mov_b32 s33, 104416
    v_exp_f32 v46, v46
    v_mfma_f32_16x16x32_bf16 v[60:63], a[76:79], a[52:55], v[60:63]
    ds_read_b128 a[68:71], v3 offset:24768
    v_mul_f32 v30, s39, v30
    v_exp_f32 v47, v47
    v_mfma_f32_16x16x32_bf16 v[56:59], a[80:83], a[56:59], v[56:59]
    v_mul_f32 v31, s39, v31
    v_cvt_pk_bf16_f32 v71, v46, v47
    v_mfma_f32_16x16x32_bf16 v[60:63], a[84:87], a[56:59], v[60:63]
    ds_read_b128 a[72:75], v3 offset:16768
    ds_read_b128 a[76:79], v3 offset:25024
    v_mfma_f32_16x16x32_bf16 v[56:59], a[88:91], a[60:63], v[56:59]
    ds_read_b128 a[80:83], v3 offset:17024
    v_cvt_pk_bf16_f32 v30, v30, v31
    v_mfma_f32_16x16x32_bf16 v[60:63], a[92:95], a[60:63], v[60:63]
    ds_read_b128 a[84:87], v3 offset:25280
    v_accvgpr_write_b32 a183, v30
    v_mfma_f32_16x16x32_bf16 v[160:163], a[96:99], v[68:71], v[160:163]
    v_exp_f32 v48, v48
    v_mfma_f32_16x16x32_bf16 v[164:167], a[100:103], v[68:71], v[164:167]
    ds_read_b128 a[88:91], v3 offset:17280
    v_accvgpr_read_b32 v29, a184
    v_mfma_f32_16x16x32_bf16 v[168:171], a[104:107], v[68:71], v[168:171]
    v_exp_f32 v49, v49
    v_mfma_f32_16x16x32_bf16 v[172:175], a[108:111], v[68:71], v[172:175]
    v_lshlrev_b32 v28, 16, v29
    v_cvt_pk_bf16_f32 v72, v48, v49
    v_mfma_f32_16x16x32_bf16 v[176:179], a[112:115], v[68:71], v[176:179]
    ds_read_b128 a[92:95], v3 offset:25536
    v_and_b32 v29, 0xffff0000, v29
    v_mfma_f32_16x16x32_bf16 v[180:183], a[116:119], v[68:71], v[180:183]
    v_exp_f32 v50, v50
    v_mfma_f32_16x16x32_bf16 v[184:187], a[120:123], v[68:71], v[184:187]
    buffer_load_dwordx4 v1, s[20:23], s32 offen offset:2048 nt lds
    v_mul_f32 v28, s39, v28
    v_add_f32 v14, v14, v48
    v_exp_f32 v51, v51
    v_mfma_f32_16x16x32_bf16 v[188:191], a[124:127], v[68:71], v[188:191]
    v_mul_f32 v29, s39, v29
    v_cvt_pk_bf16_f32 v73, v50, v51
    v_mfma_f32_16x16x32_bf16 a[136:139], a[128:131], v[68:71], a[136:139]
    s_waitcnt lgkmcnt(1)
    v_exp_f32 v52, v52
    v_mfma_f32_16x16x32_bf16 v[32:35], a[64:67], a[0:3], v[80:83]
    v_cvt_pk_bf16_f32 v28, v28, v29
    v_add_f32 v14, v14, v49
    v_exp_f32 v53, v53
    v_mfma_f32_16x16x32_bf16 v[36:39], a[68:71], a[0:3], v[80:83]
    buffer_load_dwordx4 v1, s[20:23], s33 offen offset:3104 nt lds
    v_accvgpr_write_b32 a184, v28
    v_cvt_pk_bf16_f32 v74, v52, v53
    v_mfma_f32_16x16x32_bf16 v[32:35], a[72:75], a[4:7], v[32:35]
    v_exp_f32 v54, v54
    v_mfma_f32_16x16x32_bf16 v[36:39], a[76:79], a[4:7], v[36:39]
    v_accvgpr_read_b32 v31, a185
    v_add_f32 v14, v14, v50
    v_exp_f32 v55, v55
    v_mfma_f32_16x16x32_bf16 v[32:35], a[80:83], a[8:11], v[32:35]
    v_lshlrev_b32 v30, 16, v31
    v_cvt_pk_bf16_f32 v75, v54, v55
    v_mfma_f32_16x16x32_bf16 v[36:39], a[84:87], a[8:11], v[36:39]
    v_add_f32 v14, v14, v51
    v_add_f32 v14, v14, v52
    v_mfma_f32_16x16x32_bf16 v[32:35], a[88:91], a[12:15], v[32:35]
    s_waitcnt lgkmcnt(0)
    v_and_b32 v31, 0xffff0000, v31
    v_add_f32 v14, v14, v53
    v_mfma_f32_16x16x32_bf16 v[36:39], a[92:95], a[12:15], v[36:39]
    v_mul_f32 v30, s39, v30
    v_add_f32 v14, v14, v54
    v_mfma_f32_16x16x32_bf16 v[192:195], a[96:99], v[72:75], v[192:195]
    v_exp_f32 v56, v56
    v_mfma_f32_16x16x32_bf16 v[196:199], a[100:103], v[72:75], v[196:199]
    v_mul_f32 v31, s39, v31
    v_add_f32 v14, v14, v55
    v_mfma_f32_16x16x32_bf16 v[200:203], a[104:107], v[72:75], v[200:203]
    v_cvt_pk_bf16_f32 v30, v30, v31
    v_accvgpr_write_b32 a185, v30
    v_mfma_f32_16x16x32_bf16 v[204:207], a[108:111], v[72:75], v[204:207]
    v_exp_f32 v57, v57
    v_mfma_f32_16x16x32_bf16 v[208:211], a[112:115], v[72:75], v[208:211]
    v_cvt_pk_bf16_f32 v76, v56, v57
    v_accvgpr_read_b32 v29, a186
    v_mfma_f32_16x16x32_bf16 v[212:215], a[116:119], v[72:75], v[212:215]
    v_exp_f32 v58, v58
    v_mfma_f32_16x16x32_bf16 v[216:219], a[120:123], v[72:75], v[216:219]
    v_exp_f32 v59, v59
    v_mfma_f32_16x16x32_bf16 v[220:223], a[124:127], v[72:75], v[220:223]
    v_lshlrev_b32 v28, 16, v29
    v_cvt_pk_bf16_f32 v77, v58, v59
    v_and_b32 v29, 0xffff0000, v29
    v_exp_f32 v60, v60
    v_mfma_f32_16x16x32_bf16 v[40:43], a[64:67], a[16:19], v[84:87]
    s_waitcnt vmcnt(8) lgkmcnt(0)
    s_barrier
    v_mfma_f32_16x16x32_bf16 v[44:47], a[68:71], a[16:19], v[84:87]
    v_exp_f32 v61, v61
    v_mul_f32 v28, s39, v28
    v_mfma_f32_16x16x32_bf16 v[40:43], a[72:75], a[20:23], v[40:43]
    s_add_u32 m0, s29, 99072
    v_mul_f32 v29, s39, v29
    v_cvt_pk_bf16_f32 v78, v60, v61
    v_exp_f32 v62, v62
    v_mfma_f32_16x16x32_bf16 v[44:47], a[76:79], a[20:23], v[44:47]
    s_mov_b32 s31, 122880
    v_exp_f32 v63, v63
    v_mfma_f32_16x16x32_bf16 v[40:43], a[80:83], a[24:27], v[40:43]
    v_cvt_pk_bf16_f32 v28, v28, v29
    v_cvt_pk_bf16_f32 v79, v62, v63
    v_mfma_f32_16x16x32_bf16 v[44:47], a[84:87], a[24:27], v[44:47]
    v_accvgpr_write_b32 a186, v28
    v_accvgpr_read_b32 v31, a187
    v_mfma_f32_16x16x32_bf16 v[40:43], a[88:91], a[28:31], v[40:43]
    v_exp_f32 v32, v32
    v_mfma_f32_16x16x32_bf16 v[44:47], a[92:95], a[28:31], v[44:47]
    v_exp_f32 v33, v33
    v_mfma_f32_16x16x32_bf16 v[224:227], a[96:99], v[76:79], v[224:227]
    v_lshlrev_b32 v30, 16, v31
    v_cvt_pk_bf16_f32 v64, v32, v33
    v_mfma_f32_16x16x32_bf16 v[228:231], a[100:103], v[76:79], v[228:231]
    v_exp_f32 v34, v34
    v_mfma_f32_16x16x32_bf16 v[232:235], a[104:107], v[76:79], v[232:235]
    ds_read_b64_tr_b16 a[96:97], v5 offset:33024
    v_and_b32 v31, 0xffff0000, v31
    v_mfma_f32_16x16x32_bf16 v[236:239], a[108:111], v[76:79], v[236:239]
    ds_read_b64_tr_b16 a[98:99], v5 offset:41280
    v_mul_f32 v30, s39, v30
    v_mfma_f32_16x16x32_bf16 v[240:243], a[112:115], v[76:79], v[240:243]
    v_exp_f32 v35, v35
    v_mfma_f32_16x16x32_bf16 v[244:247], a[116:119], v[76:79], v[244:247]
    v_mul_f32 v31, s39, v31
    v_cvt_pk_bf16_f32 v65, v34, v35
    v_mfma_f32_16x16x32_bf16 v[248:251], a[120:123], v[76:79], v[248:251]
    ds_read_b64_tr_b16 a[100:101], v5 offset:33056
    v_cvt_pk_bf16_f32 v30, v30, v31
    v_mfma_f32_16x16x32_bf16 v[252:255], a[124:127], v[76:79], v[252:255]
    v_exp_f32 v36, v36
    v_mfma_f32_16x16x32_bf16 a[144:147], a[128:131], v[76:79], a[144:147]
    ds_read_b64_tr_b16 a[102:103], v5 offset:41312
    buffer_load_dwordx4 v1, s[16:19], s31 offen nt lds
    v_accvgpr_write_b32 a187, v30
    v_mfma_f32_16x16x32_bf16 v[48:51], a[64:67], a[32:35], v[88:91]
    v_exp_f32 v37, v37
    v_accvgpr_read_b32 v29, a188
    v_mfma_f32_16x16x32_bf16 v[52:55], a[68:71], a[32:35], v[88:91]
    ds_read_b64_tr_b16 a[104:105], v5 offset:33280
    ds_read_b64_tr_b16 a[106:107], v5 offset:41536
    v_mfma_f32_16x16x32_bf16 v[48:51], a[72:75], a[36:39], v[48:51]
    ds_read_b64_tr_b16 a[108:109], v5 offset:33312
    ds_read_b64_tr_b16 a[110:111], v5 offset:41568
    v_lshlrev_b32 v28, 16, v29
    v_cvt_pk_bf16_f32 v66, v36, v37
    v_exp_f32 v38, v38
    v_mfma_f32_16x16x32_bf16 v[52:55], a[76:79], a[36:39], v[52:55]
    ds_read_b64_tr_b16 a[112:113], v5 offset:33536
    ds_read_b64_tr_b16 a[114:115], v5 offset:41792
    buffer_load_dwordx4 v1, s[16:19], s31 offen offset:1024 nt lds
    v_add_f32 v12, v12, v32
    v_exp_f32 v39, v39
    v_mfma_f32_16x16x32_bf16 v[48:51], a[80:83], a[40:43], v[48:51]
    ds_read_b64_tr_b16 a[116:117], v5 offset:33568
    ds_read_b64_tr_b16 a[118:119], v5 offset:41824
    v_and_b32 v29, 0xffff0000, v29
    v_mfma_f32_16x16x32_bf16 v[52:55], a[84:87], a[40:43], v[52:55]
    ds_read_b64_tr_b16 a[120:121], v5 offset:33792
    ds_read_b64_tr_b16 a[122:123], v5 offset:42048
    v_mul_f32 v28, s39, v28
    v_cvt_pk_bf16_f32 v67, v38, v39
    v_mfma_f32_16x16x32_bf16 v[48:51], a[88:91], a[44:47], v[48:51]
    ds_read_b64_tr_b16 a[124:125], v5 offset:33824
    ds_read_b64_tr_b16 a[126:127], v5 offset:42080
    v_mfma_f32_16x16x32_bf16 v[52:55], a[92:95], a[44:47], v[52:55]
    s_waitcnt lgkmcnt(10)
    v_mul_f32 v29, s39, v29
    v_add_f32 v12, v12, v33
    v_mfma_f32_16x16x32_bf16 v[128:131], a[96:99], v[64:67], v[128:131]
    v_cvt_pk_bf16_f32 v28, v28, v29
    v_add_f32 v12, v12, v34
    v_mfma_f32_16x16x32_bf16 v[132:135], a[100:103], v[64:67], v[132:135]
    v_add_f32 v12, v12, v35
    v_add_f32 v12, v12, v36
    v_mfma_f32_16x16x32_bf16 v[136:139], a[104:107], v[64:67], v[136:139]
    s_waitcnt lgkmcnt(4)
    v_accvgpr_write_b32 a188, v28
    v_add_f32 v12, v12, v37
    v_exp_f32 v40, v40
    v_mfma_f32_16x16x32_bf16 v[140:143], a[108:111], v[64:67], v[140:143]
    v_accvgpr_read_b32 v31, a189
    v_add_f32 v12, v12, v38
    v_exp_f32 v41, v41
    v_mfma_f32_16x16x32_bf16 v[144:147], a[112:115], v[64:67], v[144:147]
    v_cvt_pk_bf16_f32 v68, v40, v41
    v_add_f32 v12, v12, v39
    v_mfma_f32_16x16x32_bf16 v[148:151], a[116:119], v[64:67], v[148:151]
    s_waitcnt lgkmcnt(0)
    v_lshlrev_b32 v30, 16, v31
    v_and_b32 v31, 0xffff0000, v31
    v_exp_f32 v42, v42
    v_mfma_f32_16x16x32_bf16 v[152:155], a[120:123], v[64:67], v[152:155]
    v_exp_f32 v43, v43
    v_mfma_f32_16x16x32_bf16 v[156:159], a[124:127], v[64:67], v[156:159]
    v_cvt_pk_bf16_f32 v69, v42, v43
    v_mul_f32 v30, s39, v30
    v_exp_f32 v44, v44
    v_mfma_f32_16x16x32_bf16 v[56:59], a[64:67], a[48:51], v[92:95]
    s_add_u32 m0, s29, 99072
    ds_read_b128 a[64:67], v3 offset:33024
    v_mul_f32 v31, s39, v31
    v_exp_f32 v45, v45
    v_mfma_f32_16x16x32_bf16 v[60:63], a[68:71], a[48:51], v[92:95]
    s_mov_b32 s32, 112640
    v_cvt_pk_bf16_f32 v70, v44, v45
    v_cvt_pk_bf16_f32 v30, v30, v31
    v_mfma_f32_16x16x32_bf16 v[56:59], a[72:75], a[52:55], v[56:59]
    s_mov_b32 s33, 112608
    v_exp_f32 v46, v46
    v_mfma_f32_16x16x32_bf16 v[60:63], a[76:79], a[52:55], v[60:63]
    ds_read_b128 a[68:71], v3 offset:41280
    v_accvgpr_write_b32 a189, v30
    v_exp_f32 v47, v47
    v_mfma_f32_16x16x32_bf16 v[56:59], a[80:83], a[56:59], v[56:59]
    ds_read_b128 a[72:75], v3 offset:33280
    v_cvt_pk_bf16_f32 v71, v46, v47
    v_mfma_f32_16x16x32_bf16 v[60:63], a[84:87], a[56:59], v[60:63]
    ds_read_b128 a[76:79], v3 offset:41536
    v_accvgpr_read_b32 v29, a190
    v_mfma_f32_16x16x32_bf16 v[56:59], a[88:91], a[60:63], v[56:59]
    ds_read_b128 a[80:83], v3 offset:33536
    v_lshlrev_b32 v28, 16, v29
    v_mfma_f32_16x16x32_bf16 v[60:63], a[92:95], a[60:63], v[60:63]
    v_exp_f32 v48, v48
    v_mfma_f32_16x16x32_bf16 v[160:163], a[96:99], v[68:71], v[160:163]
    ds_read_b128 a[84:87], v3 offset:41792
    v_and_b32 v29, 0xffff0000, v29
    v_mfma_f32_16x16x32_bf16 v[164:167], a[100:103], v[68:71], v[164:167]
    ds_read_b128 a[88:91], v3 offset:33792
    v_mul_f32 v28, s39, v28
    v_mfma_f32_16x16x32_bf16 v[168:171], a[104:107], v[68:71], v[168:171]
    v_exp_f32 v49, v49
    v_mfma_f32_16x16x32_bf16 v[172:175], a[108:111], v[68:71], v[172:175]
    v_mul_f32 v29, s39, v29
    v_cvt_pk_bf16_f32 v72, v48, v49
    v_mfma_f32_16x16x32_bf16 v[176:179], a[112:115], v[68:71], v[176:179]
    ds_read_b128 a[92:95], v3 offset:42048
    v_cvt_pk_bf16_f32 v28, v28, v29
    v_mfma_f32_16x16x32_bf16 v[180:183], a[116:119], v[68:71], v[180:183]
    v_exp_f32 v50, v50
    v_mfma_f32_16x16x32_bf16 v[184:187], a[120:123], v[68:71], v[184:187]
    buffer_load_dwordx4 v1, s[20:23], s32 offen offset:2048 nt lds
    v_accvgpr_write_b32 a190, v28
    v_add_f32 v14, v14, v48
    v_exp_f32 v51, v51
    v_mfma_f32_16x16x32_bf16 v[188:191], a[124:127], v[68:71], v[188:191]
    v_accvgpr_read_b32 v31, a191
    v_cvt_pk_bf16_f32 v73, v50, v51
    v_mfma_f32_16x16x32_bf16 a[136:139], a[128:131], v[68:71], a[136:139]
    s_waitcnt lgkmcnt(1)
    v_exp_f32 v52, v52
    v_mfma_f32_16x16x32_bf16 v[32:35], a[64:67], a[0:3], v[80:83]
    v_lshlrev_b32 v30, 16, v31
    v_add_f32 v14, v14, v49
    v_exp_f32 v53, v53
    v_mfma_f32_16x16x32_bf16 v[36:39], a[68:71], a[0:3], v[80:83]
    buffer_load_dwordx4 v1, s[20:23], s33 offen offset:3104 nt lds
    v_and_b32 v31, 0xffff0000, v31
    v_cvt_pk_bf16_f32 v74, v52, v53
    v_mfma_f32_16x16x32_bf16 v[32:35], a[72:75], a[4:7], v[32:35]
    v_exp_f32 v54, v54
    v_mfma_f32_16x16x32_bf16 v[36:39], a[76:79], a[4:7], v[36:39]
    v_mul_f32 v30, s39, v30
    v_add_f32 v14, v14, v50
    v_exp_f32 v55, v55
    v_mfma_f32_16x16x32_bf16 v[32:35], a[80:83], a[8:11], v[32:35]
    v_mul_f32 v31, s39, v31
    v_cvt_pk_bf16_f32 v75, v54, v55
    v_mfma_f32_16x16x32_bf16 v[36:39], a[84:87], a[8:11], v[36:39]
    v_add_f32 v14, v14, v51
    v_add_f32 v14, v14, v52
    v_mfma_f32_16x16x32_bf16 v[32:35], a[88:91], a[12:15], v[32:35]
    s_waitcnt lgkmcnt(0)
    v_cvt_pk_bf16_f32 v30, v30, v31
    v_add_f32 v14, v14, v53
    v_mfma_f32_16x16x32_bf16 v[36:39], a[92:95], a[12:15], v[36:39]
    v_accvgpr_write_b32 a191, v30
    v_add_f32 v14, v14, v54
    v_mfma_f32_16x16x32_bf16 v[192:195], a[96:99], v[72:75], v[192:195]
    v_exp_f32 v56, v56
    v_mfma_f32_16x16x32_bf16 v[196:199], a[100:103], v[72:75], v[196:199]
    v_accvgpr_read_b32 v29, a192
    v_add_f32 v14, v14, v55
    v_mfma_f32_16x16x32_bf16 v[200:203], a[104:107], v[72:75], v[200:203]
    v_exp_f32 v57, v57
    v_mfma_f32_16x16x32_bf16 v[204:207], a[108:111], v[72:75], v[204:207]
    v_lshlrev_b32 v28, 16, v29
    v_cvt_pk_bf16_f32 v76, v56, v57
    v_mfma_f32_16x16x32_bf16 v[208:211], a[112:115], v[72:75], v[208:211]
    v_and_b32 v29, 0xffff0000, v29
    v_mul_f32 v28, s39, v28
    v_mfma_f32_16x16x32_bf16 v[212:215], a[116:119], v[72:75], v[212:215]
    v_exp_f32 v58, v58
    v_mfma_f32_16x16x32_bf16 v[216:219], a[120:123], v[72:75], v[216:219]
    v_exp_f32 v59, v59
    v_mfma_f32_16x16x32_bf16 v[220:223], a[124:127], v[72:75], v[220:223]
    v_mul_f32 v29, s39, v29
    v_cvt_pk_bf16_f32 v77, v58, v59
    v_exp_f32 v60, v60
    v_mfma_f32_16x16x32_bf16 v[40:43], a[64:67], a[16:19], v[84:87]
    v_cvt_pk_bf16_f32 v28, v28, v29
    v_accvgpr_write_b32 a192, v28
    v_exp_f32 v61, v61
    v_mfma_f32_16x16x32_bf16 v[44:47], a[68:71], a[16:19], v[84:87]
    v_cvt_pk_bf16_f32 v78, v60, v61
    v_accvgpr_read_b32 v31, a193
    v_mfma_f32_16x16x32_bf16 v[40:43], a[72:75], a[20:23], v[40:43]
    s_add_u32 m0, s29, 115584
    v_exp_f32 v62, v62
    v_mfma_f32_16x16x32_bf16 v[44:47], a[76:79], a[20:23], v[44:47]
    s_mov_b32 s31, 131072
    v_exp_f32 v63, v63
    v_mfma_f32_16x16x32_bf16 v[40:43], a[80:83], a[24:27], v[40:43]
    v_lshlrev_b32 v30, 16, v31
    v_cvt_pk_bf16_f32 v79, v62, v63
    v_mfma_f32_16x16x32_bf16 v[44:47], a[84:87], a[24:27], v[44:47]
    v_exp_f32 v32, v32
    v_mfma_f32_16x16x32_bf16 v[40:43], a[88:91], a[28:31], v[40:43]
    v_and_b32 v31, 0xffff0000, v31
    v_mul_f32 v30, s39, v30
    v_mfma_f32_16x16x32_bf16 v[44:47], a[92:95], a[28:31], v[44:47]
    v_exp_f32 v33, v33
    v_mfma_f32_16x16x32_bf16 v[224:227], a[96:99], v[76:79], v[224:227]
    ds_read_b64_tr_b16 a[96:97], v5 offset:49536
    v_cvt_pk_bf16_f32 v64, v32, v33
    v_mfma_f32_16x16x32_bf16 v[228:231], a[100:103], v[76:79], v[228:231]
    ds_read_b64_tr_b16 a[98:99], v5 offset:57792
    v_mul_f32 v31, s39, v31
    v_mfma_f32_16x16x32_bf16 v[232:235], a[104:107], v[76:79], v[232:235]
    ds_read_b64_tr_b16 a[100:101], v5 offset:49568
    v_cvt_pk_bf16_f32 v30, v30, v31
    v_mfma_f32_16x16x32_bf16 v[236:239], a[108:111], v[76:79], v[236:239]
    v_exp_f32 v34, v34
    v_mfma_f32_16x16x32_bf16 v[240:243], a[112:115], v[76:79], v[240:243]
    ds_read_b64_tr_b16 a[102:103], v5 offset:57824
    v_accvgpr_write_b32 a193, v30
    v_mfma_f32_16x16x32_bf16 v[244:247], a[116:119], v[76:79], v[244:247]
    ds_read_b64_tr_b16 a[104:105], v5 offset:49792
    v_accvgpr_read_b32 v29, a194
    v_mfma_f32_16x16x32_bf16 v[248:251], a[120:123], v[76:79], v[248:251]
    v_exp_f32 v35, v35
    v_mfma_f32_16x16x32_bf16 v[252:255], a[124:127], v[76:79], v[252:255]
    v_lshlrev_b32 v28, 16, v29
    v_cvt_pk_bf16_f32 v65, v34, v35
    v_mfma_f32_16x16x32_bf16 a[144:147], a[128:131], v[76:79], a[144:147]
    ds_read_b64_tr_b16 a[106:107], v5 offset:58048
    buffer_load_dwordx4 v1, s[16:19], s31 offen nt lds
    v_and_b32 v29, 0xffff0000, v29
    v_exp_f32 v36, v36
    v_mfma_f32_16x16x32_bf16 v[48:51], a[64:67], a[32:35], v[88:91]
    v_exp_f32 v37, v37
    v_mfma_f32_16x16x32_bf16 v[52:55], a[68:71], a[32:35], v[88:91]
    v_mul_f32 v28, s39, v28
    v_cvt_pk_bf16_f32 v66, v36, v37
    v_mfma_f32_16x16x32_bf16 v[48:51], a[72:75], a[36:39], v[48:51]
    ds_read_b64_tr_b16 a[108:109], v5 offset:49824
    ds_read_b64_tr_b16 a[110:111], v5 offset:58080
    v_mul_f32 v29, s39, v29
    v_exp_f32 v38, v38
    v_mfma_f32_16x16x32_bf16 v[52:55], a[76:79], a[36:39], v[52:55]
    ds_read_b64_tr_b16 a[112:113], v5 offset:50048
    ds_read_b64_tr_b16 a[114:115], v5 offset:58304
    buffer_load_dwordx4 v1, s[16:19], s31 offen offset:1024 nt lds
    v_add_f32 v12, v12, v32
    v_exp_f32 v39, v39
    v_mfma_f32_16x16x32_bf16 v[48:51], a[80:83], a[40:43], v[48:51]
    ds_read_b64_tr_b16 a[116:117], v5 offset:50080
    ds_read_b64_tr_b16 a[118:119], v5 offset:58336
    v_cvt_pk_bf16_f32 v28, v28, v29
    v_mfma_f32_16x16x32_bf16 v[52:55], a[84:87], a[40:43], v[52:55]
    ds_read_b64_tr_b16 a[120:121], v5 offset:50304
    ds_read_b64_tr_b16 a[122:123], v5 offset:58560
    v_accvgpr_write_b32 a194, v28
    v_cvt_pk_bf16_f32 v67, v38, v39
    v_mfma_f32_16x16x32_bf16 v[48:51], a[88:91], a[44:47], v[48:51]
    ds_read_b64_tr_b16 a[124:125], v5 offset:50336
    ds_read_b64_tr_b16 a[126:127], v5 offset:58592
    v_mfma_f32_16x16x32_bf16 v[52:55], a[92:95], a[44:47], v[52:55]
    s_waitcnt lgkmcnt(10)
    v_accvgpr_read_b32 v31, a195
    v_add_f32 v12, v12, v33
    v_mfma_f32_16x16x32_bf16 v[128:131], a[96:99], v[64:67], v[128:131]
    v_lshlrev_b32 v30, 16, v31
    v_add_f32 v12, v12, v34
    v_mfma_f32_16x16x32_bf16 v[132:135], a[100:103], v[64:67], v[132:135]
    v_add_f32 v12, v12, v35
    v_add_f32 v12, v12, v36
    v_mfma_f32_16x16x32_bf16 v[136:139], a[104:107], v[64:67], v[136:139]
    s_waitcnt lgkmcnt(4)
    v_and_b32 v31, 0xffff0000, v31
    v_add_f32 v12, v12, v37
    v_exp_f32 v40, v40
    v_mfma_f32_16x16x32_bf16 v[140:143], a[108:111], v[64:67], v[140:143]
    v_mul_f32 v30, s39, v30
    v_add_f32 v12, v12, v38
    v_exp_f32 v41, v41
    v_mfma_f32_16x16x32_bf16 v[144:147], a[112:115], v[64:67], v[144:147]
    v_cvt_pk_bf16_f32 v68, v40, v41
    v_add_f32 v12, v12, v39
    v_mfma_f32_16x16x32_bf16 v[148:151], a[116:119], v[64:67], v[148:151]
    s_waitcnt lgkmcnt(0)
    v_mul_f32 v31, s39, v31
    v_cvt_pk_bf16_f32 v30, v30, v31
    v_exp_f32 v42, v42
    v_mfma_f32_16x16x32_bf16 v[152:155], a[120:123], v[64:67], v[152:155]
    v_exp_f32 v43, v43
    v_mfma_f32_16x16x32_bf16 v[156:159], a[124:127], v[64:67], v[156:159]
    v_cvt_pk_bf16_f32 v69, v42, v43
    v_accvgpr_write_b32 a195, v30
    v_exp_f32 v44, v44
    v_mfma_f32_16x16x32_bf16 v[56:59], a[64:67], a[48:51], v[92:95]
    s_add_u32 m0, s29, 115584
    v_exp_f32 v45, v45
    v_accvgpr_read_b32 v29, a196
    v_mfma_f32_16x16x32_bf16 v[60:63], a[68:71], a[48:51], v[92:95]
    s_mov_b32 s32, 120832
    ds_read_b128 a[64:67], v3 offset:49536
    v_cvt_pk_bf16_f32 v70, v44, v45
    v_mfma_f32_16x16x32_bf16 v[56:59], a[72:75], a[52:55], v[56:59]
    s_mov_b32 s33, 120800
    ds_read_b128 a[68:71], v3 offset:57792
    v_lshlrev_b32 v28, 16, v29
    v_exp_f32 v46, v46
    v_mfma_f32_16x16x32_bf16 v[60:63], a[76:79], a[52:55], v[60:63]
    v_exp_f32 v47, v47
    v_mfma_f32_16x16x32_bf16 v[56:59], a[80:83], a[56:59], v[56:59]
    v_and_b32 v29, 0xffff0000, v29
    v_cvt_pk_bf16_f32 v71, v46, v47
    v_mfma_f32_16x16x32_bf16 v[60:63], a[84:87], a[56:59], v[60:63]
    ds_read_b128 a[72:75], v3 offset:49792
    v_mul_f32 v28, s39, v28
    v_mfma_f32_16x16x32_bf16 v[56:59], a[88:91], a[60:63], v[56:59]
    v_exp_f32 v48, v48
    v_mfma_f32_16x16x32_bf16 v[60:63], a[92:95], a[60:63], v[60:63]
    ds_read_b128 a[76:79], v3 offset:58048
    v_mul_f32 v29, s39, v29
    v_mfma_f32_16x16x32_bf16 v[160:163], a[96:99], v[68:71], v[160:163]
    ds_read_b128 a[80:83], v3 offset:50048
    v_cvt_pk_bf16_f32 v28, v28, v29
    v_mfma_f32_16x16x32_bf16 v[164:167], a[100:103], v[68:71], v[164:167]
    v_exp_f32 v49, v49
    v_mfma_f32_16x16x32_bf16 v[168:171], a[104:107], v[68:71], v[168:171]
    v_accvgpr_write_b32 a196, v28
    v_cvt_pk_bf16_f32 v72, v48, v49
    v_mfma_f32_16x16x32_bf16 v[172:175], a[108:111], v[68:71], v[172:175]
    ds_read_b128 a[84:87], v3 offset:58304
    v_accvgpr_read_b32 v31, a197
    v_mfma_f32_16x16x32_bf16 v[176:179], a[112:115], v[68:71], v[176:179]
    v_exp_f32 v50, v50
    v_mfma_f32_16x16x32_bf16 v[180:183], a[116:119], v[68:71], v[180:183]
    ds_read_b128 a[88:91], v3 offset:50304
    v_lshlrev_b32 v30, 16, v31
    v_mfma_f32_16x16x32_bf16 v[184:187], a[120:123], v[68:71], v[184:187]
    ds_read_b128 a[92:95], v3 offset:58560
    buffer_load_dwordx4 v1, s[20:23], s32 offen offset:2048 nt lds
    v_and_b32 v31, 0xffff0000, v31
    v_exp_f32 v51, v51
    v_mfma_f32_16x16x32_bf16 v[188:191], a[124:127], v[68:71], v[188:191]
    v_cvt_pk_bf16_f32 v73, v50, v51
    v_add_f32 v14, v14, v48
    v_mfma_f32_16x16x32_bf16 a[136:139], a[128:131], v[68:71], a[136:139]
    s_waitcnt lgkmcnt(3)
    v_mul_f32 v30, s39, v30
    v_add_f32 v14, v14, v49
    v_exp_f32 v52, v52
    v_mfma_f32_16x16x32_bf16 v[32:35], a[64:67], a[0:3], v[80:83]
    v_mul_f32 v31, s39, v31
    v_add_f32 v14, v14, v50
    v_exp_f32 v53, v53
    v_mfma_f32_16x16x32_bf16 v[36:39], a[68:71], a[0:3], v[80:83]
    buffer_load_dwordx4 v1, s[20:23], s33 offen offset:3104 nt lds
    v_mfma_f32_16x16x32_bf16 v[32:35], a[72:75], a[4:7], v[32:35]
    v_cvt_pk_bf16_f32 v30, v30, v31
    v_cvt_pk_bf16_f32 v74, v52, v53
    v_exp_f32 v54, v54
    v_mfma_f32_16x16x32_bf16 v[36:39], a[76:79], a[4:7], v[36:39]
    v_accvgpr_write_b32 a197, v30
    v_add_f32 v14, v14, v51
    v_exp_f32 v55, v55
    v_mfma_f32_16x16x32_bf16 v[32:35], a[80:83], a[8:11], v[32:35]
    s_waitcnt lgkmcnt(0)
    v_cvt_pk_bf16_f32 v75, v54, v55
    v_add_f32 v14, v14, v52
    v_mfma_f32_16x16x32_bf16 v[36:39], a[84:87], a[8:11], v[36:39]
    v_accvgpr_read_b32 v29, a198
    v_add_f32 v14, v14, v53
    v_mfma_f32_16x16x32_bf16 v[32:35], a[88:91], a[12:15], v[32:35]
    v_lshlrev_b32 v28, 16, v29
    v_and_b32 v29, 0xffff0000, v29
    v_mfma_f32_16x16x32_bf16 v[36:39], a[92:95], a[12:15], v[36:39]
    v_exp_f32 v56, v56
    v_mfma_f32_16x16x32_bf16 v[192:195], a[96:99], v[72:75], v[192:195]
    v_exp_f32 v57, v57
    v_mfma_f32_16x16x32_bf16 v[196:199], a[100:103], v[72:75], v[196:199]
    v_mul_f32 v28, s39, v28
    v_cvt_pk_bf16_f32 v76, v56, v57
    v_mfma_f32_16x16x32_bf16 v[200:203], a[104:107], v[72:75], v[200:203]
    v_exp_f32 v58, v58
    v_mfma_f32_16x16x32_bf16 v[204:207], a[108:111], v[72:75], v[204:207]
    v_mul_f32 v29, s39, v29
    v_add_f32 v14, v14, v54
    v_mfma_f32_16x16x32_bf16 v[208:211], a[112:115], v[72:75], v[208:211]
    v_cvt_pk_bf16_f32 v28, v28, v29
    v_add_f32 v14, v14, v55
    v_mfma_f32_16x16x32_bf16 v[212:215], a[116:119], v[72:75], v[212:215]
    v_exp_f32 v59, v59
    v_mfma_f32_16x16x32_bf16 v[216:219], a[120:123], v[72:75], v[216:219]
    v_accvgpr_write_b32 a198, v28
    v_cvt_pk_bf16_f32 v77, v58, v59
    v_mfma_f32_16x16x32_bf16 v[220:223], a[124:127], v[72:75], v[220:223]
    v_accvgpr_read_b32 v31, a199
    v_lshlrev_b32 v30, 16, v31
    v_exp_f32 v60, v60
    v_mfma_f32_16x16x32_bf16 v[40:43], a[64:67], a[16:19], v[84:87]
    s_waitcnt vmcnt(8) lgkmcnt(0)
    s_barrier
    v_mfma_f32_16x16x32_bf16 v[44:47], a[68:71], a[16:19], v[84:87]
    v_exp_f32 v61, v61
    v_and_b32 v31, 0xffff0000, v31
    v_mfma_f32_16x16x32_bf16 v[40:43], a[72:75], a[20:23], v[40:43]
    s_add_u32 m0, s29, 0
    v_cvt_pk_bf16_f32 v78, v60, v61
    v_mul_f32 v30, s39, v30
    v_exp_f32 v62, v62
    v_mfma_f32_16x16x32_bf16 v[44:47], a[76:79], a[20:23], v[44:47]
    s_mov_b32 s31, 139264
    v_exp_f32 v63, v63
    v_mfma_f32_16x16x32_bf16 v[40:43], a[80:83], a[24:27], v[40:43]
    v_mul_f32 v31, s39, v31
    v_cvt_pk_bf16_f32 v79, v62, v63
    v_mfma_f32_16x16x32_bf16 v[44:47], a[84:87], a[24:27], v[44:47]
    v_exp_f32 v32, v32
    v_mfma_f32_16x16x32_bf16 v[40:43], a[88:91], a[28:31], v[40:43]
    v_cvt_pk_bf16_f32 v30, v30, v31
    v_accvgpr_write_b32 a199, v30
    v_mfma_f32_16x16x32_bf16 v[44:47], a[92:95], a[28:31], v[44:47]
    v_exp_f32 v33, v33
    v_mfma_f32_16x16x32_bf16 v[224:227], a[96:99], v[76:79], v[224:227]
    ds_read_b64_tr_b16 a[96:97], v6 offset:0
    v_cvt_pk_bf16_f32 v64, v32, v33
    v_mfma_f32_16x16x32_bf16 v[228:231], a[100:103], v[76:79], v[228:231]
    ds_read_b64_tr_b16 a[98:99], v6 offset:8256
    v_accvgpr_read_b32 v29, a200
    v_mfma_f32_16x16x32_bf16 v[232:235], a[104:107], v[76:79], v[232:235]
    v_exp_f32 v34, v34
    v_mfma_f32_16x16x32_bf16 v[236:239], a[108:111], v[76:79], v[236:239]
    ds_read_b64_tr_b16 a[100:101], v6 offset:32
    v_lshlrev_b32 v28, 16, v29
    v_mfma_f32_16x16x32_bf16 v[240:243], a[112:115], v[76:79], v[240:243]
    ds_read_b64_tr_b16 a[102:103], v6 offset:8288
    v_and_b32 v29, 0xffff0000, v29
    v_mfma_f32_16x16x32_bf16 v[244:247], a[116:119], v[76:79], v[244:247]
    v_exp_f32 v35, v35
    v_mfma_f32_16x16x32_bf16 v[248:251], a[120:123], v[76:79], v[248:251]
    v_mul_f32 v28, s39, v28
    v_cvt_pk_bf16_f32 v65, v34, v35
    v_mfma_f32_16x16x32_bf16 v[252:255], a[124:127], v[76:79], v[252:255]
    ds_read_b64_tr_b16 a[104:105], v6 offset:256
    v_mul_f32 v29, s39, v29
    v_mfma_f32_16x16x32_bf16 a[144:147], a[128:131], v[76:79], a[144:147]
    buffer_load_dwordx4 v1, s[16:19], s31 offen nt lds
    v_exp_f32 v36, v36
    v_mfma_f32_16x16x32_bf16 v[48:51], a[64:67], a[32:35], v[88:91]
    ds_read_b64_tr_b16 a[106:107], v6 offset:8512
    v_cvt_pk_bf16_f32 v28, v28, v29
    v_exp_f32 v37, v37
    v_mfma_f32_16x16x32_bf16 v[52:55], a[68:71], a[32:35], v[88:91]
    v_accvgpr_write_b32 a200, v28
    v_cvt_pk_bf16_f32 v66, v36, v37
    v_mfma_f32_16x16x32_bf16 v[48:51], a[72:75], a[36:39], v[48:51]
    ds_read_b64_tr_b16 a[108:109], v6 offset:288
    ds_read_b64_tr_b16 a[110:111], v6 offset:8544
    v_exp_f32 v38, v38
    v_mfma_f32_16x16x32_bf16 v[52:55], a[76:79], a[36:39], v[52:55]
    ds_read_b64_tr_b16 a[112:113], v6 offset:512
    ds_read_b64_tr_b16 a[114:115], v6 offset:8768
    buffer_load_dwordx4 v1, s[16:19], s31 offen offset:1024 nt lds
    v_accvgpr_read_b32 v31, a201
    v_exp_f32 v39, v39
    v_mfma_f32_16x16x32_bf16 v[48:51], a[80:83], a[40:43], v[48:51]
    ds_read_b64_tr_b16 a[116:117], v6 offset:544
    ds_read_b64_tr_b16 a[118:119], v6 offset:8800
    v_lshlrev_b32 v30, 16, v31
    v_mfma_f32_16x16x32_bf16 v[52:55], a[84:87], a[40:43], v[52:55]
    ds_read_b64_tr_b16 a[120:121], v6 offset:768
    ds_read_b64_tr_b16 a[122:123], v6 offset:9024
    v_cvt_pk_bf16_f32 v67, v38, v39
    v_mfma_f32_16x16x32_bf16 v[48:51], a[88:91], a[44:47], v[48:51]
    ds_read_b64_tr_b16 a[124:125], v6 offset:800
    ds_read_b64_tr_b16 a[126:127], v6 offset:9056
    v_and_b32 v31, 0xffff0000, v31
    v_mfma_f32_16x16x32_bf16 v[52:55], a[92:95], a[44:47], v[52:55]
    s_waitcnt lgkmcnt(10)
    v_mul_f32 v30, s39, v30
    v_add_f32 v12, v12, v32
    v_mfma_f32_16x16x32_bf16 v[128:131], a[96:99], v[64:67], v[128:131]
    v_add_f32 v12, v12, v33
    v_add_f32 v12, v12, v34
    v_mfma_f32_16x16x32_bf16 v[132:135], a[100:103], v[64:67], v[132:135]
    v_mul_f32 v31, s39, v31
    v_add_f32 v12, v12, v35
    v_mfma_f32_16x16x32_bf16 v[136:139], a[104:107], v[64:67], v[136:139]
    s_waitcnt lgkmcnt(4)
    v_cvt_pk_bf16_f32 v30, v30, v31
    v_add_f32 v12, v12, v36
    v_exp_f32 v40, v40
    v_mfma_f32_16x16x32_bf16 v[140:143], a[108:111], v[64:67], v[140:143]
    v_exp_f32 v41, v41
    v_mfma_f32_16x16x32_bf16 v[144:147], a[112:115], v[64:67], v[144:147]
    v_accvgpr_write_b32 a201, v30
    v_add_f32 v12, v12, v37
    v_mfma_f32_16x16x32_bf16 v[148:151], a[116:119], v[64:67], v[148:151]
    s_waitcnt lgkmcnt(0)
    v_accvgpr_read_b32 v29, a202
    v_cvt_pk_bf16_f32 v68, v40, v41
    v_exp_f32 v42, v42
    v_mfma_f32_16x16x32_bf16 v[152:155], a[120:123], v[64:67], v[152:155]
    v_exp_f32 v43, v43
    v_mfma_f32_16x16x32_bf16 v[156:159], a[124:127], v[64:67], v[156:159]
    v_lshlrev_b32 v28, 16, v29
    v_add_f32 v12, v12, v38
    v_and_b32 v29, 0xffff0000, v29
    v_cvt_pk_bf16_f32 v69, v42, v43
    v_exp_f32 v44, v44
    v_mfma_f32_16x16x32_bf16 v[56:59], a[64:67], a[48:51], v[92:95]
    s_add_u32 m0, s29, 0
    v_exp_f32 v45, v45
    v_mfma_f32_16x16x32_bf16 v[60:63], a[68:71], a[48:51], v[92:95]
    s_mov_b32 s32, 129024
    v_mul_f32 v28, s39, v28
    v_add_f32 v12, v12, v39
    v_mfma_f32_16x16x32_bf16 v[56:59], a[72:75], a[52:55], v[56:59]
    s_mov_b32 s33, 128992
    v_mul_f32 v29, s39, v29
    v_cvt_pk_bf16_f32 v70, v44, v45
    v_exp_f32 v46, v46
    v_mfma_f32_16x16x32_bf16 v[60:63], a[76:79], a[52:55], v[60:63]
    v_exp_f32 v47, v47
    v_mfma_f32_16x16x32_bf16 v[56:59], a[80:83], a[56:59], v[56:59]
    v_cvt_pk_bf16_f32 v28, v28, v29
    v_cvt_pk_bf16_f32 v71, v46, v47
    v_mfma_f32_16x16x32_bf16 v[60:63], a[84:87], a[56:59], v[60:63]
    ds_read_b128 a[64:67], v4 offset:0
    v_accvgpr_write_b32 a202, v28
    v_mfma_f32_16x16x32_bf16 v[56:59], a[88:91], a[60:63], v[56:59]
    ds_read_b128 a[68:71], v4 offset:8256
    ds_read_b128 a[72:75], v4 offset:256
    v_mfma_f32_16x16x32_bf16 v[60:63], a[92:95], a[60:63], v[60:63]
    ds_read_b128 a[76:79], v4 offset:8512
    v_accvgpr_read_b32 v31, a203
    v_mfma_f32_16x16x32_bf16 v[160:163], a[96:99], v[68:71], v[160:163]
    ds_read_b128 a[80:83], v4 offset:512
    v_lshlrev_b32 v30, 16, v31
    v_mfma_f32_16x16x32_bf16 v[164:167], a[100:103], v[68:71], v[164:167]
    v_exp_f32 v48, v48
    v_mfma_f32_16x16x32_bf16 v[168:171], a[104:107], v[68:71], v[168:171]
    ds_read_b128 a[84:87], v4 offset:8768
    v_and_b32 v31, 0xffff0000, v31
    v_mfma_f32_16x16x32_bf16 v[172:175], a[108:111], v[68:71], v[172:175]
    ds_read_b128 a[88:91], v4 offset:768
    v_mul_f32 v30, s39, v30
    v_exp_f32 v49, v49
    v_mfma_f32_16x16x32_bf16 v[176:179], a[112:115], v[68:71], v[176:179]
    ds_read_b128 a[92:95], v4 offset:9024
    v_cvt_pk_bf16_f32 v72, v48, v49
    v_mfma_f32_16x16x32_bf16 v[180:183], a[116:119], v[68:71], v[180:183]
    v_mul_f32 v31, s39, v31
    v_cvt_pk_bf16_f32 v30, v30, v31
    v_exp_f32 v50, v50
    v_mfma_f32_16x16x32_bf16 v[184:187], a[120:123], v[68:71], v[184:187]
    buffer_load_dwordx4 v1, s[20:23], s32 offen offset:2048 nt lds
    v_exp_f32 v51, v51
    v_mfma_f32_16x16x32_bf16 v[188:191], a[124:127], v[68:71], v[188:191]
    v_cvt_pk_bf16_f32 v73, v50, v51
    v_add_f32 v14, v14, v48
    v_mfma_f32_16x16x32_bf16 a[136:139], a[128:131], v[68:71], a[136:139]
    s_waitcnt lgkmcnt(2)
    v_accvgpr_write_b32 a203, v30
    v_add_f32 v14, v14, v49
    v_exp_f32 v52, v52
    v_mfma_f32_16x16x32_bf16 v[32:35], a[64:67], a[0:3], v[80:83]
    v_exp_f32 v53, v53
    v_accvgpr_read_b32 v29, a204
    v_mfma_f32_16x16x32_bf16 v[36:39], a[68:71], a[0:3], v[80:83]
    buffer_load_dwordx4 v1, s[20:23], s33 offen offset:3104 nt lds
    v_mfma_f32_16x16x32_bf16 v[32:35], a[72:75], a[4:7], v[32:35]
    v_lshlrev_b32 v28, 16, v29
    v_cvt_pk_bf16_f32 v74, v52, v53
    v_exp_f32 v54, v54
    v_mfma_f32_16x16x32_bf16 v[36:39], a[76:79], a[4:7], v[36:39]
    v_exp_f32 v55, v55
    v_mfma_f32_16x16x32_bf16 v[32:35], a[80:83], a[8:11], v[32:35]
    v_and_b32 v29, 0xffff0000, v29
    v_cvt_pk_bf16_f32 v75, v54, v55
    v_mfma_f32_16x16x32_bf16 v[36:39], a[84:87], a[8:11], v[36:39]
    s_waitcnt lgkmcnt(0)
    v_mul_f32 v28, s39, v28
    v_add_f32 v14, v14, v50
    v_mfma_f32_16x16x32_bf16 v[32:35], a[88:91], a[12:15], v[32:35]
    v_add_f32 v14, v14, v51
    v_add_f32 v14, v14, v52
    v_mfma_f32_16x16x32_bf16 v[36:39], a[92:95], a[12:15], v[36:39]
    v_mul_f32 v29, s39, v29
    v_add_f32 v14, v14, v53
    v_mfma_f32_16x16x32_bf16 v[192:195], a[96:99], v[72:75], v[192:195]
    v_cvt_pk_bf16_f32 v28, v28, v29
    v_add_f32 v14, v14, v54
    v_mfma_f32_16x16x32_bf16 v[196:199], a[100:103], v[72:75], v[196:199]
    v_exp_f32 v56, v56
    v_mfma_f32_16x16x32_bf16 v[200:203], a[104:107], v[72:75], v[200:203]
    v_accvgpr_write_b32 a204, v28
    v_add_f32 v14, v14, v55
    v_mfma_f32_16x16x32_bf16 v[204:207], a[108:111], v[72:75], v[204:207]
    v_accvgpr_read_b32 v31, a205
    v_lshlrev_b32 v30, 16, v31
    v_exp_f32 v57, v57
    v_mfma_f32_16x16x32_bf16 v[208:211], a[112:115], v[72:75], v[208:211]
    v_cvt_pk_bf16_f32 v76, v56, v57
    v_and_b32 v31, 0xffff0000, v31
    v_mfma_f32_16x16x32_bf16 v[212:215], a[116:119], v[72:75], v[212:215]
    v_exp_f32 v58, v58
    v_mfma_f32_16x16x32_bf16 v[216:219], a[120:123], v[72:75], v[216:219]
    v_exp_f32 v59, v59
    v_mfma_f32_16x16x32_bf16 v[220:223], a[124:127], v[72:75], v[220:223]
    v_cvt_pk_bf16_f32 v77, v58, v59
    v_mul_f32 v30, s39, v30
    v_exp_f32 v60, v60
    v_mfma_f32_16x16x32_bf16 v[40:43], a[64:67], a[16:19], v[84:87]
    v_mul_f32 v31, s39, v31
    v_cvt_pk_bf16_f32 v30, v30, v31
    v_exp_f32 v61, v61
    v_mfma_f32_16x16x32_bf16 v[44:47], a[68:71], a[16:19], v[84:87]
    v_cvt_pk_bf16_f32 v78, v60, v61
    v_accvgpr_write_b32 a205, v30
    v_mfma_f32_16x16x32_bf16 v[40:43], a[72:75], a[20:23], v[40:43]
    s_add_u32 m0, s29, 16512
    v_exp_f32 v62, v62
    v_mfma_f32_16x16x32_bf16 v[44:47], a[76:79], a[20:23], v[44:47]
    s_mov_b32 s31, 147456
    v_exp_f32 v63, v63
    v_mfma_f32_16x16x32_bf16 v[40:43], a[80:83], a[24:27], v[40:43]
    v_cvt_pk_bf16_f32 v79, v62, v63
    v_accvgpr_read_b32 v29, a206
    v_mfma_f32_16x16x32_bf16 v[44:47], a[84:87], a[24:27], v[44:47]
    v_exp_f32 v32, v32
    v_mfma_f32_16x16x32_bf16 v[40:43], a[88:91], a[28:31], v[40:43]
    v_lshlrev_b32 v28, 16, v29
    v_and_b32 v29, 0xffff0000, v29
    v_mfma_f32_16x16x32_bf16 v[44:47], a[92:95], a[28:31], v[44:47]
    v_exp_f32 v33, v33
    v_mfma_f32_16x16x32_bf16 v[224:227], a[96:99], v[76:79], v[224:227]
    ds_read_b64_tr_b16 a[96:97], v6 offset:16512
    v_cvt_pk_bf16_f32 v64, v32, v33
    v_mfma_f32_16x16x32_bf16 v[228:231], a[100:103], v[76:79], v[228:231]
    ds_read_b64_tr_b16 a[98:99], v6 offset:24768
    v_mul_f32 v28, s39, v28
    v_mfma_f32_16x16x32_bf16 v[232:235], a[104:107], v[76:79], v[232:235]
    v_exp_f32 v34, v34
    v_mfma_f32_16x16x32_bf16 v[236:239], a[108:111], v[76:79], v[236:239]
    ds_read_b64_tr_b16 a[100:101], v6 offset:16544
    v_mul_f32 v29, s39, v29
    v_mfma_f32_16x16x32_bf16 v[240:243], a[112:115], v[76:79], v[240:243]
    ds_read_b64_tr_b16 a[102:103], v6 offset:24800
    v_cvt_pk_bf16_f32 v28, v28, v29
    v_mfma_f32_16x16x32_bf16 v[244:247], a[116:119], v[76:79], v[244:247]
    v_exp_f32 v35, v35
    v_mfma_f32_16x16x32_bf16 v[248:251], a[120:123], v[76:79], v[248:251]
    v_accvgpr_write_b32 a206, v28
    v_cvt_pk_bf16_f32 v65, v34, v35
    v_mfma_f32_16x16x32_bf16 v[252:255], a[124:127], v[76:79], v[252:255]
    ds_read_b64_tr_b16 a[104:105], v6 offset:16768
    v_accvgpr_read_b32 v31, a207
    v_mfma_f32_16x16x32_bf16 a[144:147], a[128:131], v[76:79], a[144:147]
    buffer_load_dwordx4 v1, s[16:19], s31 offen nt lds
    v_exp_f32 v36, v36
    v_mfma_f32_16x16x32_bf16 v[48:51], a[64:67], a[32:35], v[88:91]
    ds_read_b64_tr_b16 a[106:107], v6 offset:25024
    v_lshlrev_b32 v30, 16, v31
    v_exp_f32 v37, v37
    v_mfma_f32_16x16x32_bf16 v[52:55], a[68:71], a[32:35], v[88:91]
    v_and_b32 v31, 0xffff0000, v31
    v_cvt_pk_bf16_f32 v66, v36, v37
    v_mfma_f32_16x16x32_bf16 v[48:51], a[72:75], a[36:39], v[48:51]
    ds_read_b64_tr_b16 a[108:109], v6 offset:16800
    ds_read_b64_tr_b16 a[110:111], v6 offset:25056
    v_exp_f32 v38, v38
    v_mfma_f32_16x16x32_bf16 v[52:55], a[76:79], a[36:39], v[52:55]
    ds_read_b64_tr_b16 a[112:113], v6 offset:17024
    ds_read_b64_tr_b16 a[114:115], v6 offset:25280
    buffer_load_dwordx4 v1, s[16:19], s31 offen offset:1024 nt lds
    v_mul_f32 v30, s39, v30
    v_exp_f32 v39, v39
    v_mfma_f32_16x16x32_bf16 v[48:51], a[80:83], a[40:43], v[48:51]
    ds_read_b64_tr_b16 a[116:117], v6 offset:17056
    ds_read_b64_tr_b16 a[118:119], v6 offset:25312
    v_mul_f32 v31, s39, v31
    v_mfma_f32_16x16x32_bf16 v[52:55], a[84:87], a[40:43], v[52:55]
    ds_read_b64_tr_b16 a[120:121], v6 offset:17280
    ds_read_b64_tr_b16 a[122:123], v6 offset:25536
    v_cvt_pk_bf16_f32 v67, v38, v39
    v_mfma_f32_16x16x32_bf16 v[48:51], a[88:91], a[44:47], v[48:51]
    ds_read_b64_tr_b16 a[124:125], v6 offset:17312
    ds_read_b64_tr_b16 a[126:127], v6 offset:25568
    v_cvt_pk_bf16_f32 v30, v30, v31
    v_mfma_f32_16x16x32_bf16 v[52:55], a[92:95], a[44:47], v[52:55]
    s_waitcnt lgkmcnt(10)
    v_accvgpr_write_b32 a207, v30
    v_add_f32 v12, v12, v32
    v_mfma_f32_16x16x32_bf16 v[128:131], a[96:99], v[64:67], v[128:131]
    v_add_f32 v12, v12, v33
    v_add_f32 v12, v12, v34
    v_mfma_f32_16x16x32_bf16 v[132:135], a[100:103], v[64:67], v[132:135]
    v_accvgpr_read_b32 v29, a208
    v_add_f32 v12, v12, v35
    v_mfma_f32_16x16x32_bf16 v[136:139], a[104:107], v[64:67], v[136:139]
    s_waitcnt lgkmcnt(4)
    v_exp_f32 v40, v40
    v_mfma_f32_16x16x32_bf16 v[140:143], a[108:111], v[64:67], v[140:143]
    v_lshlrev_b32 v28, 16, v29
    v_add_f32 v12, v12, v36
    v_exp_f32 v41, v41
    v_mfma_f32_16x16x32_bf16 v[144:147], a[112:115], v[64:67], v[144:147]
    v_and_b32 v29, 0xffff0000, v29
    v_add_f32 v12, v12, v37
    v_mfma_f32_16x16x32_bf16 v[148:151], a[116:119], v[64:67], v[148:151]
    s_waitcnt lgkmcnt(0)
    v_cvt_pk_bf16_f32 v68, v40, v41
    v_add_f32 v12, v12, v38
    v_exp_f32 v42, v42
    v_mfma_f32_16x16x32_bf16 v[152:155], a[120:123], v[64:67], v[152:155]
    v_mul_f32 v28, s39, v28
    v_add_f32 v12, v12, v39
    v_exp_f32 v43, v43
    v_mfma_f32_16x16x32_bf16 v[156:159], a[124:127], v[64:67], v[156:159]
    v_mul_f32 v29, s39, v29
    v_cvt_pk_bf16_f32 v69, v42, v43
    v_exp_f32 v44, v44
    v_mfma_f32_16x16x32_bf16 v[56:59], a[64:67], a[48:51], v[92:95]
    s_add_u32 m0, s29, 16512
    ds_read_b128 a[64:67], v4 offset:16512
    v_cvt_pk_bf16_f32 v28, v28, v29
    v_exp_f32 v45, v45
    v_mfma_f32_16x16x32_bf16 v[60:63], a[68:71], a[48:51], v[92:95]
    s_mov_b32 s32, 137216
    v_accvgpr_write_b32 a208, v28
    v_cvt_pk_bf16_f32 v70, v44, v45
    v_mfma_f32_16x16x32_bf16 v[56:59], a[72:75], a[52:55], v[56:59]
    s_mov_b32 s33, 137184
    v_exp_f32 v46, v46
    v_mfma_f32_16x16x32_bf16 v[60:63], a[76:79], a[52:55], v[60:63]
    ds_read_b128 a[68:71], v4 offset:24768
    v_accvgpr_read_b32 v31, a209
    v_exp_f32 v47, v47
    v_mfma_f32_16x16x32_bf16 v[56:59], a[80:83], a[56:59], v[56:59]
    v_lshlrev_b32 v30, 16, v31
    v_cvt_pk_bf16_f32 v71, v46, v47
    v_mfma_f32_16x16x32_bf16 v[60:63], a[84:87], a[56:59], v[60:63]
    ds_read_b128 a[72:75], v4 offset:16768
    ds_read_b128 a[76:79], v4 offset:25024
    v_mfma_f32_16x16x32_bf16 v[56:59], a[88:91], a[60:63], v[56:59]
    ds_read_b128 a[80:83], v4 offset:17024
    v_and_b32 v31, 0xffff0000, v31
    v_mfma_f32_16x16x32_bf16 v[60:63], a[92:95], a[60:63], v[60:63]
    ds_read_b128 a[84:87], v4 offset:25280
    v_mul_f32 v30, s39, v30
    v_mfma_f32_16x16x32_bf16 v[160:163], a[96:99], v[68:71], v[160:163]
    v_exp_f32 v48, v48
    v_mfma_f32_16x16x32_bf16 v[164:167], a[100:103], v[68:71], v[164:167]
    ds_read_b128 a[88:91], v4 offset:17280
    v_mul_f32 v31, s39, v31
    v_mfma_f32_16x16x32_bf16 v[168:171], a[104:107], v[68:71], v[168:171]
    ds_read_b128 a[92:95], v4 offset:25536
    v_cvt_pk_bf16_f32 v30, v30, v31
    v_mfma_f32_16x16x32_bf16 v[172:175], a[108:111], v[68:71], v[172:175]
    v_exp_f32 v49, v49
    v_mfma_f32_16x16x32_bf16 v[176:179], a[112:115], v[68:71], v[176:179]
    v_accvgpr_write_b32 a209, v30
    v_cvt_pk_bf16_f32 v72, v48, v49
    v_mfma_f32_16x16x32_bf16 v[180:183], a[116:119], v[68:71], v[180:183]
    v_accvgpr_read_b32 v29, a210
    v_add_f32 v14, v14, v48
    v_exp_f32 v50, v50
    v_mfma_f32_16x16x32_bf16 v[184:187], a[120:123], v[68:71], v[184:187]
    buffer_load_dwordx4 v1, s[20:23], s32 offen offset:2048 nt lds
    v_exp_f32 v51, v51
    v_mfma_f32_16x16x32_bf16 v[188:191], a[124:127], v[68:71], v[188:191]
    v_lshlrev_b32 v28, 16, v29
    v_cvt_pk_bf16_f32 v73, v50, v51
    v_mfma_f32_16x16x32_bf16 a[136:139], a[128:131], v[68:71], a[136:139]
    s_waitcnt lgkmcnt(0)
    v_and_b32 v29, 0xffff0000, v29
    v_add_f32 v14, v14, v49
    v_exp_f32 v52, v52
    v_mfma_f32_16x16x32_bf16 v[32:35], a[64:67], a[0:3], v[80:83]
    v_exp_f32 v53, v53
    v_mfma_f32_16x16x32_bf16 v[36:39], a[68:71], a[0:3], v[80:83]
    buffer_load_dwordx4 v1, s[20:23], s33 offen offset:3104 nt lds
    v_mul_f32 v28, s39, v28
    v_cvt_pk_bf16_f32 v74, v52, v53
    v_mfma_f32_16x16x32_bf16 v[32:35], a[72:75], a[4:7], v[32:35]
    v_mul_f32 v29, s39, v29
    v_add_f32 v14, v14, v50
    v_exp_f32 v54, v54
    v_mfma_f32_16x16x32_bf16 v[36:39], a[76:79], a[4:7], v[36:39]
    v_exp_f32 v55, v55
    v_mfma_f32_16x16x32_bf16 v[32:35], a[80:83], a[8:11], v[32:35]
    v_cvt_pk_bf16_f32 v28, v28, v29
    v_cvt_pk_bf16_f32 v75, v54, v55
    v_mfma_f32_16x16x32_bf16 v[36:39], a[84:87], a[8:11], v[36:39]
    v_accvgpr_write_b32 a210, v28
    v_add_f32 v14, v14, v51
    v_mfma_f32_16x16x32_bf16 v[32:35], a[88:91], a[12:15], v[32:35]
    v_exp_f32 v56, v56
    v_mfma_f32_16x16x32_bf16 v[36:39], a[92:95], a[12:15], v[36:39]
    v_accvgpr_read_b32 v31, a211
    v_add_f32 v14, v14, v52
    v_mfma_f32_16x16x32_bf16 v[192:195], a[96:99], v[72:75], v[192:195]
    v_lshlrev_b32 v30, 16, v31
    v_add_f32 v14, v14, v53
    v_mfma_f32_16x16x32_bf16 v[196:199], a[100:103], v[72:75], v[196:199]
    v_exp_f32 v57, v57
    v_mfma_f32_16x16x32_bf16 v[200:203], a[104:107], v[72:75], v[200:203]
    v_and_b32 v31, 0xffff0000, v31
    v_cvt_pk_bf16_f32 v76, v56, v57
    v_mfma_f32_16x16x32_bf16 v[204:207], a[108:111], v[72:75], v[204:207]
    v_mul_f32 v30, s39, v30
    v_add_f32 v14, v14, v54
    v_mfma_f32_16x16x32_bf16 v[208:211], a[112:115], v[72:75], v[208:211]
    v_exp_f32 v58, v58
    v_mfma_f32_16x16x32_bf16 v[212:215], a[116:119], v[72:75], v[212:215]
    v_mul_f32 v31, s39, v31
    v_add_f32 v14, v14, v55
    v_mfma_f32_16x16x32_bf16 v[216:219], a[120:123], v[72:75], v[216:219]
    v_cvt_pk_bf16_f32 v30, v30, v31
    v_accvgpr_write_b32 a211, v30
    v_exp_f32 v59, v59
    v_mfma_f32_16x16x32_bf16 v[220:223], a[124:127], v[72:75], v[220:223]
    v_exp_f32 v60, v60
    v_cvt_pk_bf16_f32 v77, v58, v59
    v_mfma_f32_16x16x32_bf16 v[40:43], a[64:67], a[16:19], v[84:87]
    s_waitcnt vmcnt(8) lgkmcnt(0)
    s_barrier
    v_mfma_f32_16x16x32_bf16 v[44:47], a[68:71], a[16:19], v[84:87]
    v_exp_f32 v61, v61
    v_mfma_f32_16x16x32_bf16 v[40:43], a[72:75], a[20:23], v[40:43]
    s_add_u32 m0, s29, 33024
    v_cvt_pk_bf16_f32 v78, v60, v61
    v_exp_f32 v62, v62
    v_mfma_f32_16x16x32_bf16 v[44:47], a[76:79], a[20:23], v[44:47]
    s_mov_b32 s31, 155648
    v_exp_f32 v63, v63
    v_mfma_f32_16x16x32_bf16 v[40:43], a[80:83], a[24:27], v[40:43]
    v_exp_f32 v32, v32
    v_mfma_f32_16x16x32_bf16 v[44:47], a[84:87], a[24:27], v[44:47]
    v_cvt_pk_bf16_f32 v79, v62, v63
    v_add_f32 v12, v12, v32
    v_mfma_f32_16x16x32_bf16 v[40:43], a[88:91], a[28:31], v[40:43]
    v_exp_f32 v33, v33
    v_mfma_f32_16x16x32_bf16 v[44:47], a[92:95], a[28:31], v[44:47]
    v_cvt_pk_bf16_f32 v64, v32, v33
    v_add_f32 v12, v12, v33
    v_mfma_f32_16x16x32_bf16 v[224:227], a[96:99], v[76:79], v[224:227]
    v_exp_f32 v34, v34
    v_mfma_f32_16x16x32_bf16 v[228:231], a[100:103], v[76:79], v[228:231]
    v_exp_f32 v35, v35
    v_mfma_f32_16x16x32_bf16 v[232:235], a[104:107], v[76:79], v[232:235]
    ds_read_b64_tr_b16 a[96:97], v6 offset:33024
    ds_read_b64_tr_b16 a[98:99], v6 offset:41280
    v_mfma_f32_16x16x32_bf16 v[236:239], a[108:111], v[76:79], v[236:239]
    ds_read_b64_tr_b16 a[100:101], v6 offset:33056
    v_cvt_pk_bf16_f32 v65, v34, v35
    v_mfma_f32_16x16x32_bf16 v[240:243], a[112:115], v[76:79], v[240:243]
    v_exp_f32 v36, v36
    v_mfma_f32_16x16x32_bf16 v[244:247], a[116:119], v[76:79], v[244:247]
    ds_read_b64_tr_b16 a[102:103], v6 offset:41312
    ds_read_b64_tr_b16 a[104:105], v6 offset:33280
    v_mfma_f32_16x16x32_bf16 v[248:251], a[120:123], v[76:79], v[248:251]
    v_exp_f32 v37, v37
    v_mfma_f32_16x16x32_bf16 v[252:255], a[124:127], v[76:79], v[252:255]
    ds_read_b64_tr_b16 a[106:107], v6 offset:41536
    v_cvt_pk_bf16_f32 v66, v36, v37
    v_mfma_f32_16x16x32_bf16 a[144:147], a[128:131], v[76:79], a[144:147]
    buffer_load_dwordx4 v1, s[16:19], s31 offen nt lds
    v_mfma_f32_16x16x32_bf16 v[48:51], a[64:67], a[32:35], v[88:91]
    ds_read_b64_tr_b16 a[108:109], v6 offset:33312
    ds_read_b64_tr_b16 a[110:111], v6 offset:41568
    v_mfma_f32_16x16x32_bf16 v[52:55], a[68:71], a[32:35], v[88:91]
    v_exp_f32 v38, v38
    v_mfma_f32_16x16x32_bf16 v[48:51], a[72:75], a[36:39], v[48:51]
    ds_read_b64_tr_b16 a[112:113], v6 offset:33536
    ds_read_b64_tr_b16 a[114:115], v6 offset:41792
    v_mfma_f32_16x16x32_bf16 v[52:55], a[76:79], a[36:39], v[52:55]
    buffer_load_dwordx4 v1, s[16:19], s31 offen offset:1024 nt lds
    v_exp_f32 v39, v39
    v_mfma_f32_16x16x32_bf16 v[48:51], a[80:83], a[40:43], v[48:51]
    ds_read_b64_tr_b16 a[116:117], v6 offset:33568
    ds_read_b64_tr_b16 a[118:119], v6 offset:41824
    v_mfma_f32_16x16x32_bf16 v[52:55], a[84:87], a[40:43], v[52:55]
    ds_read_b64_tr_b16 a[120:121], v6 offset:33792
    ds_read_b64_tr_b16 a[122:123], v6 offset:42048
    v_cvt_pk_bf16_f32 v67, v38, v39
    v_mfma_f32_16x16x32_bf16 v[48:51], a[88:91], a[44:47], v[48:51]
    ds_read_b64_tr_b16 a[124:125], v6 offset:33824
    ds_read_b64_tr_b16 a[126:127], v6 offset:42080
    v_mfma_f32_16x16x32_bf16 v[52:55], a[92:95], a[44:47], v[52:55]
    s_waitcnt lgkmcnt(8)
    v_exp_f32 v40, v40
    v_mfma_f32_16x16x32_bf16 v[128:131], a[96:99], v[64:67], v[128:131]
    v_exp_f32 v41, v41
    v_mfma_f32_16x16x32_bf16 v[132:135], a[100:103], v[64:67], v[132:135]
    v_add_f32 v12, v12, v34
    v_add_f32 v12, v12, v35
    v_mfma_f32_16x16x32_bf16 v[136:139], a[104:107], v[64:67], v[136:139]
    v_add_f32 v12, v12, v36
    v_add_f32 v12, v12, v37
    v_mfma_f32_16x16x32_bf16 v[140:143], a[108:111], v[64:67], v[140:143]
    s_waitcnt lgkmcnt(2)
    v_cvt_pk_bf16_f32 v68, v40, v41
    v_add_f32 v12, v12, v38
    v_mfma_f32_16x16x32_bf16 v[144:147], a[112:115], v[64:67], v[144:147]
    v_exp_f32 v42, v42
    v_mfma_f32_16x16x32_bf16 v[148:151], a[116:119], v[64:67], v[148:151]
    v_exp_f32 v43, v43
    v_mfma_f32_16x16x32_bf16 v[152:155], a[120:123], v[64:67], v[152:155]
    s_waitcnt lgkmcnt(0)
    v_add_f32 v12, v12, v39
    v_cvt_pk_bf16_f32 v69, v42, v43
    v_mfma_f32_16x16x32_bf16 v[156:159], a[124:127], v[64:67], v[156:159]
    v_exp_f32 v44, v44
    v_mfma_f32_16x16x32_bf16 v[56:59], a[64:67], a[48:51], v[92:95]
    s_add_u32 m0, s29, 33024
    v_exp_f32 v45, v45
    v_mfma_f32_16x16x32_bf16 v[60:63], a[68:71], a[48:51], v[92:95]
    s_mov_b32 s32, 145408
    ds_read_b128 a[64:67], v4 offset:33024
    v_cvt_pk_bf16_f32 v70, v44, v45
    v_mfma_f32_16x16x32_bf16 v[56:59], a[72:75], a[52:55], v[56:59]
    s_mov_b32 s33, 145376
    v_exp_f32 v46, v46
    v_mfma_f32_16x16x32_bf16 v[60:63], a[76:79], a[52:55], v[60:63]
    v_exp_f32 v47, v47
    v_mfma_f32_16x16x32_bf16 v[56:59], a[80:83], a[56:59], v[56:59]
    ds_read_b128 a[68:71], v4 offset:41280
    v_cvt_pk_bf16_f32 v71, v46, v47
    v_mfma_f32_16x16x32_bf16 v[60:63], a[84:87], a[56:59], v[60:63]
    v_exp_f32 v48, v48
    v_mfma_f32_16x16x32_bf16 v[56:59], a[88:91], a[60:63], v[56:59]
    ds_read_b128 a[72:75], v4 offset:33280
    ds_read_b128 a[76:79], v4 offset:41536
    v_mfma_f32_16x16x32_bf16 v[60:63], a[92:95], a[60:63], v[60:63]
    v_exp_f32 v49, v49
    v_mfma_f32_16x16x32_bf16 v[160:163], a[96:99], v[68:71], v[160:163]
    ds_read_b128 a[80:83], v4 offset:33536
    v_cvt_pk_bf16_f32 v72, v48, v49
    v_mfma_f32_16x16x32_bf16 v[164:167], a[100:103], v[68:71], v[164:167]
    ds_read_b128 a[84:87], v4 offset:41792
    ds_read_b128 a[88:91], v4 offset:33792
    v_mfma_f32_16x16x32_bf16 v[168:171], a[104:107], v[68:71], v[168:171]
    v_exp_f32 v50, v50
    v_mfma_f32_16x16x32_bf16 v[172:175], a[108:111], v[68:71], v[172:175]
    v_exp_f32 v51, v51
    v_mfma_f32_16x16x32_bf16 v[176:179], a[112:115], v[68:71], v[176:179]
    ds_read_b128 a[92:95], v4 offset:42048
    v_cvt_pk_bf16_f32 v73, v50, v51
    v_mfma_f32_16x16x32_bf16 v[180:183], a[116:119], v[68:71], v[180:183]
    v_exp_f32 v52, v52
    v_mfma_f32_16x16x32_bf16 v[184:187], a[120:123], v[68:71], v[184:187]
    buffer_load_dwordx4 v1, s[20:23], s32 offen offset:2048 nt lds
    v_mfma_f32_16x16x32_bf16 v[188:191], a[124:127], v[68:71], v[188:191]
    v_exp_f32 v53, v53
    v_mfma_f32_16x16x32_bf16 a[136:139], a[128:131], v[68:71], a[136:139]
    s_waitcnt lgkmcnt(1)
    v_cvt_pk_bf16_f32 v74, v52, v53
    v_add_f32 v14, v14, v48
    v_mfma_f32_16x16x32_bf16 v[32:35], a[64:67], a[0:3], v[80:83]
    v_exp_f32 v54, v54
    v_mfma_f32_16x16x32_bf16 v[36:39], a[68:71], a[0:3], v[80:83]
    buffer_load_dwordx4 v1, s[20:23], s33 offen offset:3104 nt lds
    v_mfma_f32_16x16x32_bf16 v[32:35], a[72:75], a[4:7], v[32:35]
    v_exp_f32 v55, v55
    v_mfma_f32_16x16x32_bf16 v[36:39], a[76:79], a[4:7], v[36:39]
    v_add_f32 v14, v14, v49
    v_cvt_pk_bf16_f32 v75, v54, v55
    v_mfma_f32_16x16x32_bf16 v[32:35], a[80:83], a[8:11], v[32:35]
    v_exp_f32 v56, v56
    v_mfma_f32_16x16x32_bf16 v[36:39], a[84:87], a[8:11], v[36:39]
    v_exp_f32 v57, v57
    v_mfma_f32_16x16x32_bf16 v[32:35], a[88:91], a[12:15], v[32:35]
    s_waitcnt lgkmcnt(0)
    v_add_f32 v14, v14, v50
    v_add_f32 v14, v14, v51
    v_mfma_f32_16x16x32_bf16 v[36:39], a[92:95], a[12:15], v[36:39]
    v_add_f32 v14, v14, v52
    v_add_f32 v14, v14, v53
    v_mfma_f32_16x16x32_bf16 v[192:195], a[96:99], v[72:75], v[192:195]
    v_cvt_pk_bf16_f32 v76, v56, v57
    v_add_f32 v14, v14, v54
    v_mfma_f32_16x16x32_bf16 v[196:199], a[100:103], v[72:75], v[196:199]
    v_exp_f32 v58, v58
    v_mfma_f32_16x16x32_bf16 v[200:203], a[104:107], v[72:75], v[200:203]
    v_exp_f32 v59, v59
    v_mfma_f32_16x16x32_bf16 v[204:207], a[108:111], v[72:75], v[204:207]
    v_add_f32 v14, v14, v55
    v_cvt_pk_bf16_f32 v77, v58, v59
    v_mfma_f32_16x16x32_bf16 v[208:211], a[112:115], v[72:75], v[208:211]
    v_exp_f32 v60, v60
    v_mfma_f32_16x16x32_bf16 v[212:215], a[116:119], v[72:75], v[212:215]
    v_exp_f32 v61, v61
    v_mfma_f32_16x16x32_bf16 v[216:219], a[120:123], v[72:75], v[216:219]
    v_exp_f32 v62, v62
    v_mfma_f32_16x16x32_bf16 v[220:223], a[124:127], v[72:75], v[220:223]
    v_exp_f32 v63, v63
    v_mfma_f32_16x16x32_bf16 v[40:43], a[64:67], a[16:19], v[84:87]
    v_cvt_pk_bf16_f32 v78, v60, v61
    v_cvt_pk_bf16_f32 v79, v62, v63
    v_mfma_f32_16x16x32_bf16 v[44:47], a[68:71], a[16:19], v[84:87]
    v_exp_f32 v32, v32
    v_mfma_f32_16x16x32_bf16 v[40:43], a[72:75], a[20:23], v[40:43]
    s_add_u32 m0, s29, 49536
    v_exp_f32 v33, v33
    v_mfma_f32_16x16x32_bf16 v[44:47], a[76:79], a[20:23], v[44:47]
    s_mov_b32 s31, 163840
    v_cvt_pk_bf16_f32 v64, v32, v33
    v_add_f32 v12, v12, v32
    v_mfma_f32_16x16x32_bf16 v[40:43], a[80:83], a[24:27], v[40:43]
    v_exp_f32 v34, v34
    v_mfma_f32_16x16x32_bf16 v[44:47], a[84:87], a[24:27], v[44:47]
    v_exp_f32 v35, v35
    v_mfma_f32_16x16x32_bf16 v[40:43], a[88:91], a[28:31], v[40:43]
    v_cvt_pk_bf16_f32 v65, v34, v35
    v_add_f32 v12, v12, v33
    v_mfma_f32_16x16x32_bf16 v[44:47], a[92:95], a[28:31], v[44:47]
    v_exp_f32 v36, v36
    v_mfma_f32_16x16x32_bf16 v[224:227], a[96:99], v[76:79], v[224:227]
    ds_read_b64_tr_b16 a[96:97], v6 offset:49536
    ds_read_b64_tr_b16 a[98:99], v6 offset:57792
    v_mfma_f32_16x16x32_bf16 v[228:231], a[100:103], v[76:79], v[228:231]
    ds_read_b64_tr_b16 a[100:101], v6 offset:49568
    ds_read_b64_tr_b16 a[102:103], v6 offset:57824
    v_mfma_f32_16x16x32_bf16 v[232:235], a[104:107], v[76:79], v[232:235]
    v_exp_f32 v37, v37
    v_mfma_f32_16x16x32_bf16 v[236:239], a[108:111], v[76:79], v[236:239]
    ds_read_b64_tr_b16 a[104:105], v6 offset:49792
    ds_read_b64_tr_b16 a[106:107], v6 offset:58048
    v_mfma_f32_16x16x32_bf16 v[240:243], a[112:115], v[76:79], v[240:243]
    ds_read_b64_tr_b16 a[108:109], v6 offset:49824
    v_cvt_pk_bf16_f32 v66, v36, v37
    v_mfma_f32_16x16x32_bf16 v[244:247], a[116:119], v[76:79], v[244:247]
    ds_read_b64_tr_b16 a[110:111], v6 offset:58080
    ds_read_b64_tr_b16 a[112:113], v6 offset:50048
    v_mfma_f32_16x16x32_bf16 v[248:251], a[120:123], v[76:79], v[248:251]
    v_exp_f32 v38, v38
    v_mfma_f32_16x16x32_bf16 v[252:255], a[124:127], v[76:79], v[252:255]
    v_exp_f32 v39, v39
    v_mfma_f32_16x16x32_bf16 a[144:147], a[128:131], v[76:79], a[144:147]
    buffer_load_dwordx4 v1, s[16:19], s31 offen nt lds
    v_mfma_f32_16x16x32_bf16 v[48:51], a[64:67], a[32:35], v[88:91]
    ds_read_b64_tr_b16 a[114:115], v6 offset:58304
    ds_read_b64_tr_b16 a[116:117], v6 offset:50080
    v_mfma_f32_16x16x32_bf16 v[52:55], a[68:71], a[32:35], v[88:91]
    ds_read_b64_tr_b16 a[118:119], v6 offset:58336
    v_cvt_pk_bf16_f32 v67, v38, v39
    v_mfma_f32_16x16x32_bf16 v[48:51], a[72:75], a[36:39], v[48:51]
    v_add_f32 v12, v12, v34
    v_add_f32 v12, v12, v35
    v_mfma_f32_16x16x32_bf16 v[52:55], a[76:79], a[36:39], v[52:55]
    buffer_load_dwordx4 v1, s[16:19], s31 offen offset:1024 nt lds
    v_mfma_f32_16x16x32_bf16 v[48:51], a[80:83], a[40:43], v[48:51]
    s_add_u32 m0, s29, 49536
    ds_read_b64_tr_b16 a[120:121], v6 offset:50304
    ds_read_b64_tr_b16 a[122:123], v6 offset:58560
    v_mfma_f32_16x16x32_bf16 v[52:55], a[84:87], a[40:43], v[52:55]
    s_mov_b32 s32, 153600
    ds_read_b64_tr_b16 a[124:125], v6 offset:50336
    ds_read_b64_tr_b16 a[126:127], v6 offset:58592
    v_mfma_f32_16x16x32_bf16 v[48:51], a[88:91], a[44:47], v[48:51]
    s_mov_b32 s33, 153568
    v_exp_f32 v40, v40
    v_mfma_f32_16x16x32_bf16 v[52:55], a[92:95], a[44:47], v[52:55]
    s_waitcnt lgkmcnt(4)
    v_exp_f32 v41, v41
    v_mfma_f32_16x16x32_bf16 v[128:131], a[96:99], v[64:67], v[128:131]
    v_add_f32 v12, v12, v36
    v_add_f32 v12, v12, v37
    v_mfma_f32_16x16x32_bf16 v[132:135], a[100:103], v[64:67], v[132:135]
    v_cvt_pk_bf16_f32 v68, v40, v41
    v_add_f32 v12, v12, v38
    v_mfma_f32_16x16x32_bf16 v[136:139], a[104:107], v[64:67], v[136:139]
    v_exp_f32 v42, v42
    v_mfma_f32_16x16x32_bf16 v[140:143], a[108:111], v[64:67], v[140:143]
    buffer_load_dwordx4 v1, s[20:23], s32 offen offset:2048 nt lds
    v_mfma_f32_16x16x32_bf16 v[144:147], a[112:115], v[64:67], v[144:147]
    v_exp_f32 v43, v43
    v_mfma_f32_16x16x32_bf16 v[148:151], a[116:119], v[64:67], v[148:151]
    s_waitcnt lgkmcnt(0)
    v_add_f32 v12, v12, v39
    v_cvt_pk_bf16_f32 v69, v42, v43
    v_mfma_f32_16x16x32_bf16 v[152:155], a[120:123], v[64:67], v[152:155]
    v_exp_f32 v44, v44
    v_mfma_f32_16x16x32_bf16 v[156:159], a[124:127], v[64:67], v[156:159]
    buffer_load_dwordx4 v1, s[20:23], s33 offen offset:3104 nt lds
    s_add_u32 m0, s29, 66048
    v_mov_b32 v17, v12
    v_mov_b32 v16, v17
    v_mfma_f32_16x16x32_bf16 v[56:59], a[64:67], a[48:51], v[92:95]
    s_mov_b32 s31, 172032
    v_permlane16_swap_b32 v17, v16
    v_add_f32 v17, v17, v16
    v_mov_b32 v16, v17
    v_exp_f32 v45, v45
    v_mfma_f32_16x16x32_bf16 v[60:63], a[68:71], a[48:51], v[92:95]
    v_permlane32_swap_b32 v17, v16
    v_add_f32 v17, v17, v16
    v_mfma_f32_16x16x32_bf16 v[56:59], a[72:75], a[52:55], v[56:59]
    ds_read_b128 a[64:67], v4 offset:49536
    v_cvt_pk_bf16_f32 v70, v44, v45
    v_exp_f32 v46, v46
    v_mfma_f32_16x16x32_bf16 v[60:63], a[76:79], a[52:55], v[60:63]
    v_exp_f32 v47, v47
    v_mfma_f32_16x16x32_bf16 v[56:59], a[80:83], a[56:59], v[56:59]
    ds_read_b128 a[68:71], v4 offset:57792
    v_cvt_pk_bf16_f32 v71, v46, v47
    v_mfma_f32_16x16x32_bf16 v[60:63], a[84:87], a[56:59], v[60:63]
    v_rcp_f32 v16, v17
    v_cmp_nle_f32 s[48:49], v17, s40
    s_or_b64 s[44:45], s[44:45], s[48:49]
    v_mul_f32 v128, v128, v16
    v_mul_f32 v129, v129, v16
    v_mul_f32 v130, v130, v16
    v_mul_f32 v131, v131, v16
    v_cvt_pk_bf16_f32 v96, v128, v129
    v_cvt_pk_bf16_f32 v97, v130, v131
    v_pk_mul_f32 v[132:133], v[132:133], v[16:17] op_sel_hi:[1,0]
    v_pk_mul_f32 v[134:135], v[134:135], v[16:17] op_sel_hi:[1,0]
    v_pk_mul_f32 v[136:137], v[136:137], v[16:17] op_sel_hi:[1,0]
    v_pk_mul_f32 v[138:139], v[138:139], v[16:17] op_sel_hi:[1,0]
    v_pk_mul_f32 v[140:141], v[140:141], v[16:17] op_sel_hi:[1,0]
    v_pk_mul_f32 v[142:143], v[142:143], v[16:17] op_sel_hi:[1,0]
    v_cvt_pk_bf16_f32 v98, v132, v133
    v_cvt_pk_bf16_f32 v99, v134, v135
    v_cvt_pk_bf16_f32 v100, v136, v137
    v_cvt_pk_bf16_f32 v101, v138, v139
    v_cvt_pk_bf16_f32 v102, v140, v141
    v_cvt_pk_bf16_f32 v103, v142, v143
    v_mfma_f32_16x16x32_bf16 v[56:59], a[88:91], a[60:63], v[56:59]
    v_exp_f32 v48, v48
    v_mfma_f32_16x16x32_bf16 v[60:63], a[92:95], a[60:63], v[60:63]
    ds_write2_b64 v9, v[96:97], v[98:99] offset0:0 offset1:4
    buffer_load_dwordx4 v1, s[16:19], s31 offen nt lds
    v_mfma_f32_16x16x32_bf16 v[160:163], a[96:99], v[68:71], v[160:163]
    ds_write2_b64 v9, v[100:101], v[102:103] offset0:8 offset1:12
    v_mfma_f32_16x16x32_bf16 v[164:167], a[100:103], v[68:71], v[164:167]
    ds_read_b128 a[72:75], v4 offset:49792
    ds_read_b128 a[76:79], v4 offset:58048
    v_mfma_f32_16x16x32_bf16 v[168:171], a[104:107], v[68:71], v[168:171]
    v_exp_f32 v49, v49
    v_mfma_f32_16x16x32_bf16 v[172:175], a[108:111], v[68:71], v[172:175]
    buffer_load_dwordx4 v1, s[16:19], s31 offen offset:1024 nt lds
    v_mfma_f32_16x16x32_bf16 v[176:179], a[112:115], v[68:71], v[176:179]
    s_add_u32 m0, s29, 66048
    ds_read_b128 a[80:83], v4 offset:50048
    v_cvt_pk_bf16_f32 v72, v48, v49
    v_mfma_f32_16x16x32_bf16 v[180:183], a[116:119], v[68:71], v[180:183]
    s_mov_b32 s32, 161792
    ds_read_b128 a[84:87], v4 offset:58304
    ds_read_b128 a[88:91], v4 offset:50304
    v_exp_f32 v50, v50
    v_mfma_f32_16x16x32_bf16 v[184:187], a[120:123], v[68:71], v[184:187]
    s_mov_b32 s33, 161760
    v_exp_f32 v51, v51
    v_mfma_f32_16x16x32_bf16 v[188:191], a[124:127], v[68:71], v[188:191]
    ds_read_b128 a[92:95], v4 offset:58560
    v_cvt_pk_bf16_f32 v73, v50, v51
    v_mfma_f32_16x16x32_bf16 a[136:139], a[128:131], v[68:71], a[136:139]
    s_waitcnt lgkmcnt(4)
    v_exp_f32 v52, v52
    v_mfma_f32_16x16x32_bf16 v[32:35], a[64:67], a[148:151], 0
    v_exp_f32 v53, v53
    v_mfma_f32_16x16x32_bf16 v[36:39], a[68:71], a[148:151], 0
    v_cvt_pk_bf16_f32 v74, v52, v53
    v_add_f32 v14, v14, v48
    v_mfma_f32_16x16x32_bf16 v[32:35], a[72:75], a[152:155], v[32:35]
    v_exp_f32 v54, v54
    v_mfma_f32_16x16x32_bf16 v[36:39], a[76:79], a[152:155], v[36:39]
    s_waitcnt lgkmcnt(1)
    buffer_load_dwordx4 v1, s[20:23], s32 offen offset:2048 nt lds
    v_exp_f32 v55, v55
    v_mul_f32 v144, v144, v16
    v_mul_f32 v145, v145, v16
    v_mul_f32 v146, v146, v16
    v_mul_f32 v147, v147, v16
    v_cvt_pk_bf16_f32 v104, v144, v145
    v_cvt_pk_bf16_f32 v105, v146, v147
    v_pk_mul_f32 v[148:149], v[148:149], v[16:17] op_sel_hi:[1,0]
    v_pk_mul_f32 v[150:151], v[150:151], v[16:17] op_sel_hi:[1,0]
    v_pk_mul_f32 v[152:153], v[152:153], v[16:17] op_sel_hi:[1,0]
    v_pk_mul_f32 v[154:155], v[154:155], v[16:17] op_sel_hi:[1,0]
    v_pk_mul_f32 v[156:157], v[156:157], v[16:17] op_sel_hi:[1,0]
    v_pk_mul_f32 v[158:159], v[158:159], v[16:17] op_sel_hi:[1,0]
    v_cvt_pk_bf16_f32 v106, v148, v149
    v_cvt_pk_bf16_f32 v107, v150, v151
    v_cvt_pk_bf16_f32 v108, v152, v153
    v_cvt_pk_bf16_f32 v109, v154, v155
    v_cvt_pk_bf16_f32 v110, v156, v157
    v_cvt_pk_bf16_f32 v111, v158, v159
    v_mfma_f32_16x16x32_bf16 v[32:35], a[80:83], a[156:159], v[32:35]
    v_accvgpr_read_b32 v19, a136
    v_add_f32 v14, v14, v49
    v_mfma_f32_16x16x32_bf16 v[36:39], a[84:87], a[156:159], v[36:39]
    ds_write2_b64 v9, v[104:105], v[106:107] offset0:16 offset1:20
    v_rcp_f32 v18, v19
    v_cmp_nle_f32 s[48:49], v19, s40
    s_or_b64 s[44:45], s[44:45], s[48:49]
    v_cvt_pk_bf16_f32 v75, v54, v55
    v_mfma_f32_16x16x32_bf16 v[32:35], a[88:91], a[160:163], v[32:35]
    s_waitcnt lgkmcnt(1)
    ds_write2_b64 v9, v[108:109], v[110:111] offset0:24 offset1:28
    v_mfma_f32_16x16x32_bf16 v[36:39], a[92:95], a[160:163], v[36:39]
    buffer_load_dwordx4 v1, s[20:23], s33 offen offset:3104 nt lds
    v_mul_f32 v160, v160, v18
    v_mul_f32 v161, v161, v18
    v_mul_f32 v162, v162, v18
    v_mul_f32 v163, v163, v18
    v_cvt_pk_bf16_f32 v96, v160, v161
    v_cvt_pk_bf16_f32 v97, v162, v163
    v_pk_mul_f32 v[164:165], v[164:165], v[18:19] op_sel_hi:[1,0]
    v_pk_mul_f32 v[166:167], v[166:167], v[18:19] op_sel_hi:[1,0]
    v_pk_mul_f32 v[168:169], v[168:169], v[18:19] op_sel_hi:[1,0]
    v_pk_mul_f32 v[170:171], v[170:171], v[18:19] op_sel_hi:[1,0]
    v_pk_mul_f32 v[172:173], v[172:173], v[18:19] op_sel_hi:[1,0]
    v_pk_mul_f32 v[174:175], v[174:175], v[18:19] op_sel_hi:[1,0]
    v_cvt_pk_bf16_f32 v98, v164, v165
    v_cvt_pk_bf16_f32 v99, v166, v167
    v_cvt_pk_bf16_f32 v100, v168, v169
    v_cvt_pk_bf16_f32 v101, v170, v171
    v_cvt_pk_bf16_f32 v102, v172, v173
    v_cvt_pk_bf16_f32 v103, v174, v175
    v_mfma_f32_16x16x32_bf16 v[192:195], a[96:99], v[72:75], v[192:195]
    s_add_u32 m0, s29, 82560
    v_add_f32 v14, v14, v50
    v_add_f32 v14, v14, v51
    v_mfma_f32_16x16x32_bf16 v[196:199], a[100:103], v[72:75], v[196:199]
    s_mov_b32 s31, 180224
    v_exp_f32 v56, v56
    v_mfma_f32_16x16x32_bf16 v[200:203], a[104:107], v[72:75], v[200:203]
    v_exp_f32 v57, v57
    v_mfma_f32_16x16x32_bf16 v[204:207], a[108:111], v[72:75], v[204:207]
    v_add_f32 v14, v14, v52
    v_add_f32 v14, v14, v53
    v_mfma_f32_16x16x32_bf16 v[208:211], a[112:115], v[72:75], v[208:211]
    v_max3_f32 v24, v32, v33, v34
    v_max3_f32 v24, v24, v35, v36
    v_max3_f32 v24, v24, v37, v38
    v_max_f32 v24, v24, v39
    v_mov_b32 v25, v24
    v_mfma_f32_16x16x32_bf16 v[212:215], a[116:119], v[72:75], v[212:215]
    s_nop 0
    v_permlane16_swap_b32 v24, v25
    v_max_f32 v24, v24, v25
    v_mov_b32 v25, v24
    v_cvt_pk_bf16_f32 v76, v56, v57
    v_exp_f32 v58, v58
    v_mfma_f32_16x16x32_bf16 v[216:219], a[120:123], v[72:75], v[216:219]
    v_permlane32_swap_b32 v24, v25
    v_max_f32 v24, v24, v25
    v_exp_f32 v59, v59
    v_mul_f32 v80, -1.0, v24
    v_mfma_f32_16x16x32_bf16 v[220:223], a[124:127], v[72:75], v[220:223]
    v_mul_f32 v81, -1.0, v24
    v_mul_f32 v82, -1.0, v24
    v_add_f32 v14, v14, v54
    buffer_load_dwordx4 v1, s[16:19], s31 offen nt lds
    v_mul_f32 v83, -1.0, v24
    v_add_f32 v14, v14, v55
    v_cvt_pk_bf16_f32 v77, v58, v59
    v_exp_f32 v60, v60
    v_mov_b32 v21, v14
    v_mov_b32 v20, v21
    v_mfma_f32_16x16x32_bf16 v[40:43], a[64:67], a[164:167], 0
    s_waitcnt vmcnt(13) lgkmcnt(0)
    s_barrier
    v_mfma_f32_16x16x32_bf16 v[44:47], a[68:71], a[164:167], 0
    v_permlane16_swap_b32 v21, v20
    v_add_f32 v21, v21, v20
    v_mov_b32 v20, v21
    v_exp_f32 v61, v61
    v_mfma_f32_16x16x32_bf16 v[40:43], a[72:75], a[168:171], v[40:43]
    ds_read_b128 a[0:3], v10 offset:0
    ds_read_b128 a[4:7], v10 offset:1088
    ds_read_b128 a[8:11], v10 offset:2176
    ds_read_b128 a[12:15], v10 offset:3264
    ds_write2_b64 v9, v[96:97], v[98:99] offset0:0 offset1:4
    v_permlane32_swap_b32 v21, v20
    v_add_f32 v21, v21, v20
    v_cvt_pk_bf16_f32 v78, v60, v61
    v_exp_f32 v62, v62
    v_mfma_f32_16x16x32_bf16 v[44:47], a[76:79], a[168:171], v[44:47]
    ds_write2_b64 v9, v[100:101], v[102:103] offset0:8 offset1:12
    buffer_load_dwordx4 v1, s[16:19], s31 offen offset:1024 nt lds
    v_exp_f32 v63, v63
    v_mul_f32 v176, v176, v18
    v_mul_f32 v177, v177, v18
    v_mul_f32 v178, v178, v18
    v_mul_f32 v179, v179, v18
    v_cvt_pk_bf16_f32 v104, v176, v177
    v_cvt_pk_bf16_f32 v105, v178, v179
    v_pk_mul_f32 v[180:181], v[180:181], v[18:19] op_sel_hi:[1,0]
    v_pk_mul_f32 v[182:183], v[182:183], v[18:19] op_sel_hi:[1,0]
    v_pk_mul_f32 v[184:185], v[184:185], v[18:19] op_sel_hi:[1,0]
    v_pk_mul_f32 v[186:187], v[186:187], v[18:19] op_sel_hi:[1,0]
    v_pk_mul_f32 v[188:189], v[188:189], v[18:19] op_sel_hi:[1,0]
    v_pk_mul_f32 v[190:191], v[190:191], v[18:19] op_sel_hi:[1,0]
    v_cvt_pk_bf16_f32 v106, v180, v181
    v_cvt_pk_bf16_f32 v107, v182, v183
    v_cvt_pk_bf16_f32 v108, v184, v185
    v_cvt_pk_bf16_f32 v109, v186, v187
    v_cvt_pk_bf16_f32 v110, v188, v189
    v_cvt_pk_bf16_f32 v111, v190, v191
    v_mfma_f32_16x16x32_bf16 v[40:43], a[80:83], a[172:175], v[40:43]
    s_add_u32 m0, s29, 82560
    v_cvt_pk_bf16_f32 v79, v62, v63
    v_add_f32 v32, v32, v80
    v_mfma_f32_16x16x32_bf16 v[44:47], a[84:87], a[172:175], v[44:47]
    s_mov_b32 s32, 169984
    ds_write2_b64 v9, v[104:105], v[106:107] offset0:16 offset1:20
    v_rcp_f32 v20, v21
    v_cmp_nle_f32 s[48:49], v21, s40
    s_or_b64 s[44:45], s[44:45], s[48:49]
    v_mfma_f32_16x16x32_bf16 v[40:43], a[88:91], a[176:179], v[40:43]
    s_mov_b32 s33, 169952
    ds_write2_b64 v9, v[108:109], v[110:111] offset0:24 offset1:28
    v_mfma_f32_16x16x32_bf16 v[44:47], a[92:95], a[176:179], v[44:47]
    v_mul_f32 v192, v192, v20
    v_mul_f32 v193, v193, v20
    v_mul_f32 v194, v194, v20
    v_mul_f32 v195, v195, v20
    v_cvt_pk_bf16_f32 v96, v192, v193
    v_cvt_pk_bf16_f32 v97, v194, v195
    v_pk_mul_f32 v[196:197], v[196:197], v[20:21] op_sel_hi:[1,0]
    v_pk_mul_f32 v[198:199], v[198:199], v[20:21] op_sel_hi:[1,0]
    v_pk_mul_f32 v[200:201], v[200:201], v[20:21] op_sel_hi:[1,0]
    v_pk_mul_f32 v[202:203], v[202:203], v[20:21] op_sel_hi:[1,0]
    v_pk_mul_f32 v[204:205], v[204:205], v[20:21] op_sel_hi:[1,0]
    v_pk_mul_f32 v[206:207], v[206:207], v[20:21] op_sel_hi:[1,0]
    v_cvt_pk_bf16_f32 v98, v196, v197
    v_cvt_pk_bf16_f32 v99, v198, v199
    v_cvt_pk_bf16_f32 v100, v200, v201
    v_cvt_pk_bf16_f32 v101, v202, v203
    v_cvt_pk_bf16_f32 v102, v204, v205
    v_cvt_pk_bf16_f32 v103, v206, v207
    v_mfma_f32_16x16x32_bf16 v[224:227], a[96:99], v[76:79], v[224:227]
    v_add_f32 v33, v33, v80
    v_add_f32 v34, v34, v80
    v_mfma_f32_16x16x32_bf16 v[228:231], a[100:103], v[76:79], v[228:231]
    v_exp_f32 v32, v32
    v_mfma_f32_16x16x32_bf16 v[232:235], a[104:107], v[76:79], v[232:235]
    v_exp_f32 v33, v33
    v_mfma_f32_16x16x32_bf16 v[236:239], a[108:111], v[76:79], v[236:239]
    v_add_f32 v35, v35, v80
    v_cvt_pk_bf16_f32 v64, v32, v33
    v_mfma_f32_16x16x32_bf16 v[240:243], a[112:115], v[76:79], v[240:243]
    v_max3_f32 v26, v40, v41, v42
    v_max3_f32 v26, v26, v43, v44
    v_max3_f32 v26, v26, v45, v46
    v_max_f32 v26, v26, v47
    v_mov_b32 v27, v26
    v_mfma_f32_16x16x32_bf16 v[244:247], a[116:119], v[76:79], v[244:247]
    s_nop 0
    v_permlane16_swap_b32 v26, v27
    v_max_f32 v26, v26, v27
    v_mov_b32 v27, v26
    v_exp_f32 v34, v34
    v_mfma_f32_16x16x32_bf16 v[248:251], a[120:123], v[76:79], v[248:251]
    v_permlane32_swap_b32 v26, v27
    v_max_f32 v26, v26, v27
    v_exp_f32 v35, v35
    v_mul_f32 v84, -1.0, v26
    v_mfma_f32_16x16x32_bf16 v[252:255], a[124:127], v[76:79], v[252:255]
    v_mul_f32 v85, -1.0, v26
    v_mul_f32 v86, -1.0, v26
    v_add_f32 v36, v36, v80
    v_add_f32 v37, v37, v80
    v_mfma_f32_16x16x32_bf16 a[144:147], a[128:131], v[76:79], a[144:147]
    ds_read_b64_tr_b16 a[96:97], v5 offset:0
    ds_read_b64_tr_b16 a[98:99], v5 offset:8256
    buffer_load_dwordx4 v1, s[20:23], s32 offen offset:2048 nt lds
    v_mul_f32 v87, -1.0, v26
    v_cvt_pk_bf16_f32 v65, v34, v35
    v_exp_f32 v36, v36
    v_mfma_f32_16x16x32_bf16 v[48:51], a[64:67], a[180:183], 0
    ds_read_b64_tr_b16 a[100:101], v5 offset:32
    ds_read_b64_tr_b16 a[102:103], v5 offset:8288
    v_exp_f32 v37, v37
    v_mfma_f32_16x16x32_bf16 v[52:55], a[68:71], a[180:183], 0
    ds_read_b64_tr_b16 a[104:105], v5 offset:256
    ds_read_b64_tr_b16 a[106:107], v5 offset:8512
    v_add_f32 v38, v38, v80
    v_add_f32 v39, v39, v80
    v_mfma_f32_16x16x32_bf16 v[48:51], a[72:75], a[184:187], v[48:51]
    ds_read_b64_tr_b16 a[108:109], v5 offset:288
    ds_read_b64_tr_b16 a[110:111], v5 offset:8544
    ds_read_b128 a[16:19], v10 offset:0
    ds_read_b128 a[20:23], v10 offset:1088
    ds_read_b128 a[24:27], v10 offset:2176
    ds_read_b128 a[28:31], v10 offset:3264
    ds_write2_b64 v9, v[96:97], v[98:99] offset0:0 offset1:4
    v_cvt_pk_bf16_f32 v66, v36, v37
    v_exp_f32 v38, v38
    v_mfma_f32_16x16x32_bf16 v[52:55], a[76:79], a[184:187], v[52:55]
    ds_write2_b64 v9, v[100:101], v[102:103] offset0:8 offset1:12
    ds_read_b64_tr_b16 a[112:113], v5 offset:512
    ds_read_b64_tr_b16 a[114:115], v5 offset:8768
    buffer_load_dwordx4 v1, s[20:23], s33 offen offset:3104 nt lds
    v_exp_f32 v39, v39
    v_mul_f32 v208, v208, v20
    v_mul_f32 v209, v209, v20
    v_mul_f32 v210, v210, v20
    v_mul_f32 v211, v211, v20
    v_cvt_pk_bf16_f32 v104, v208, v209
    v_cvt_pk_bf16_f32 v105, v210, v211
    v_pk_mul_f32 v[212:213], v[212:213], v[20:21] op_sel_hi:[1,0]
    v_pk_mul_f32 v[214:215], v[214:215], v[20:21] op_sel_hi:[1,0]
    v_pk_mul_f32 v[216:217], v[216:217], v[20:21] op_sel_hi:[1,0]
    v_pk_mul_f32 v[218:219], v[218:219], v[20:21] op_sel_hi:[1,0]
    v_pk_mul_f32 v[220:221], v[220:221], v[20:21] op_sel_hi:[1,0]
    v_pk_mul_f32 v[222:223], v[222:223], v[20:21] op_sel_hi:[1,0]
    v_cvt_pk_bf16_f32 v106, v212, v213
    v_cvt_pk_bf16_f32 v107, v214, v215
    v_cvt_pk_bf16_f32 v108, v216, v217
    v_cvt_pk_bf16_f32 v109, v218, v219
    v_cvt_pk_bf16_f32 v110, v220, v221
    v_cvt_pk_bf16_f32 v111, v222, v223
    v_mfma_f32_16x16x32_bf16 v[48:51], a[80:83], a[188:191], v[48:51]
    s_add_u32 m0, s29, 99072
    ds_read_b64_tr_b16 a[116:117], v5 offset:544
    ds_read_b64_tr_b16 a[118:119], v5 offset:8800
    v_accvgpr_read_b32 v23, a144
    v_mfma_f32_16x16x32_bf16 v[52:55], a[84:87], a[188:191], v[52:55]
    s_mov_b32 s31, 188416
    ds_read_b64_tr_b16 a[120:121], v5 offset:768
    ds_read_b64_tr_b16 a[122:123], v5 offset:9024
    ds_write2_b64 v9, v[104:105], v[106:107] offset0:16 offset1:20
    v_rcp_f32 v22, v23
    v_cmp_nle_f32 s[48:49], v23, s40
    s_or_b64 s[44:45], s[44:45], s[48:49]
    v_cvt_pk_bf16_f32 v67, v38, v39
    v_mfma_f32_16x16x32_bf16 v[48:51], a[88:91], a[192:195], v[48:51]
    ds_write2_b64 v9, v[108:109], v[110:111] offset0:24 offset1:28
    ds_read_b64_tr_b16 a[124:125], v5 offset:800
    ds_read_b64_tr_b16 a[126:127], v5 offset:9056
    v_mfma_f32_16x16x32_bf16 v[52:55], a[92:95], a[192:195], v[52:55]
    s_waitcnt lgkmcnt(15)
    v_mul_f32 v224, v224, v22
    v_mul_f32 v225, v225, v22
    v_mul_f32 v226, v226, v22
    v_mul_f32 v227, v227, v22
    v_cvt_pk_bf16_f32 v96, v224, v225
    v_cvt_pk_bf16_f32 v97, v226, v227
    v_pk_mul_f32 v[228:229], v[228:229], v[22:23] op_sel_hi:[1,0]
    v_pk_mul_f32 v[230:231], v[230:231], v[22:23] op_sel_hi:[1,0]
    v_pk_mul_f32 v[232:233], v[232:233], v[22:23] op_sel_hi:[1,0]
    v_pk_mul_f32 v[234:235], v[234:235], v[22:23] op_sel_hi:[1,0]
    v_pk_mul_f32 v[236:237], v[236:237], v[22:23] op_sel_hi:[1,0]
    v_pk_mul_f32 v[238:239], v[238:239], v[22:23] op_sel_hi:[1,0]
    v_cvt_pk_bf16_f32 v98, v228, v229
    v_cvt_pk_bf16_f32 v99, v230, v231
    v_cvt_pk_bf16_f32 v100, v232, v233
    v_cvt_pk_bf16_f32 v101, v234, v235
    v_cvt_pk_bf16_f32 v102, v236, v237
    v_cvt_pk_bf16_f32 v103, v238, v239
    v_mfma_f32_16x16x32_bf16 v[128:131], a[96:99], v[64:67], 0
    v_mov_b32 v12, v32
    v_add_f32 v12, v12, v33
    v_mfma_f32_16x16x32_bf16 v[132:135], a[100:103], v[64:67], 0
    v_add_f32 v40, v40, v84
    v_add_f32 v41, v41, v84
    v_mfma_f32_16x16x32_bf16 v[136:139], a[104:107], v[64:67], 0
    v_exp_f32 v40, v40
    v_mfma_f32_16x16x32_bf16 v[140:143], a[108:111], v[64:67], 0
    s_waitcnt lgkmcnt(3)
    buffer_load_dwordx4 v1, s[16:19], s31 offen nt lds
    v_exp_f32 v41, v41
    v_mfma_f32_16x16x32_bf16 v[144:147], a[112:115], v[64:67], 0
    v_max3_f32 v24, v48, v49, v50
    v_max3_f32 v24, v24, v51, v52
    v_max3_f32 v24, v24, v53, v54
    v_max_f32 v24, v24, v55
    v_mov_b32 v25, v24
    v_add_f32 v42, v42, v84
    v_add_f32 v43, v43, v84
    v_mfma_f32_16x16x32_bf16 v[148:151], a[116:119], v[64:67], 0
    v_permlane16_swap_b32 v24, v25
    v_max_f32 v24, v24, v25
    v_mov_b32 v25, v24
    v_cvt_pk_bf16_f32 v68, v40, v41
    v_exp_f32 v42, v42
    v_mfma_f32_16x16x32_bf16 v[152:155], a[120:123], v[64:67], 0
    s_waitcnt lgkmcnt(0)
    v_permlane32_swap_b32 v24, v25
    v_max_f32 v24, v24, v25
    v_exp_f32 v43, v43
    v_mul_f32 v88, -1.0, v24
    v_mfma_f32_16x16x32_bf16 v[156:159], a[124:127], v[64:67], 0
    buffer_load_dwordx4 v1, s[16:19], s31 offen offset:1024 nt lds
    v_mul_f32 v89, -1.0, v24
    v_mul_f32 v90, -1.0, v24
    v_add_f32 v44, v44, v84
    v_add_f32 v45, v45, v84
    s_add_u32 m0, s29, 99072
    v_mul_f32 v91, -1.0, v24
    v_cvt_pk_bf16_f32 v69, v42, v43
    v_exp_f32 v44, v44
    v_mfma_f32_16x16x32_bf16 v[56:59], a[64:67], a[196:199], 0
    s_mov_b32 s32, 178176
    v_exp_f32 v45, v45
    v_mfma_f32_16x16x32_bf16 v[60:63], a[68:71], a[196:199], 0
    s_mov_b32 s33, 178144
    v_add_f32 v46, v46, v84
    v_add_f32 v47, v47, v84
    v_mfma_f32_16x16x32_bf16 v[56:59], a[72:75], a[200:203], v[56:59]
    ds_read_b128 a[32:35], v10 offset:0
    ds_read_b128 a[36:39], v10 offset:1088
    ds_read_b128 a[40:43], v10 offset:2176
    ds_read_b128 a[44:47], v10 offset:3264
    ds_write2_b64 v9, v[96:97], v[98:99] offset0:0 offset1:4
    v_cvt_pk_bf16_f32 v70, v44, v45
    v_add_f32 v12, v12, v34
    v_exp_f32 v46, v46
    v_mfma_f32_16x16x32_bf16 v[60:63], a[76:79], a[200:203], v[60:63]
    ds_write2_b64 v9, v[100:101], v[102:103] offset0:8 offset1:12
    v_exp_f32 v47, v47
    v_mul_f32 v240, v240, v22
    v_mul_f32 v241, v241, v22
    v_mul_f32 v242, v242, v22
    v_mul_f32 v243, v243, v22
    v_cvt_pk_bf16_f32 v104, v240, v241
    v_cvt_pk_bf16_f32 v105, v242, v243
    v_pk_mul_f32 v[244:245], v[244:245], v[22:23] op_sel_hi:[1,0]
    v_pk_mul_f32 v[246:247], v[246:247], v[22:23] op_sel_hi:[1,0]
    v_pk_mul_f32 v[248:249], v[248:249], v[22:23] op_sel_hi:[1,0]
    v_pk_mul_f32 v[250:251], v[250:251], v[22:23] op_sel_hi:[1,0]
    v_pk_mul_f32 v[252:253], v[252:253], v[22:23] op_sel_hi:[1,0]
    v_pk_mul_f32 v[254:255], v[254:255], v[22:23] op_sel_hi:[1,0]
    v_cvt_pk_bf16_f32 v106, v244, v245
    v_cvt_pk_bf16_f32 v107, v246, v247
    v_cvt_pk_bf16_f32 v108, v248, v249
    v_cvt_pk_bf16_f32 v109, v250, v251
    v_cvt_pk_bf16_f32 v110, v252, v253
    v_cvt_pk_bf16_f32 v111, v254, v255
    v_mfma_f32_16x16x32_bf16 v[56:59], a[80:83], a[204:207], v[56:59]
    v_add_f32 v12, v12, v35
    v_add_f32 v12, v12, v36
    v_mfma_f32_16x16x32_bf16 v[60:63], a[84:87], a[204:207], v[60:63]
    ds_write2_b64 v9, v[104:105], v[106:107] offset0:16 offset1:20
    v_cvt_pk_bf16_f32 v71, v46, v47
    v_add_f32 v12, v12, v37
    v_mfma_f32_16x16x32_bf16 v[56:59], a[88:91], a[208:211], v[56:59]
    ds_write2_b64 v9, v[108:109], v[110:111] offset0:24 offset1:28
    v_mfma_f32_16x16x32_bf16 v[60:63], a[92:95], a[208:211], v[60:63]
    buffer_load_dwordx4 v1, s[20:23], s32 offen offset:2048 nt lds
    v_mfma_f32_16x16x32_bf16 v[160:163], a[96:99], v[68:71], 0
    ds_read_b128 a[64:67], v3 offset:0
    v_add_f32 v12, v12, v38
    v_mfma_f32_16x16x32_bf16 v[164:167], a[100:103], v[68:71], 0
    ds_read_b128 a[68:71], v3 offset:8256
    v_add_f32 v48, v48, v88
    v_add_f32 v49, v49, v88
    v_mfma_f32_16x16x32_bf16 v[168:171], a[104:107], v[68:71], 0
    ds_read_b128 a[72:75], v3 offset:256
    v_add_f32 v12, v12, v39
    v_exp_f32 v48, v48
    v_mfma_f32_16x16x32_bf16 v[172:175], a[108:111], v[68:71], 0
    ds_read_b128 a[76:79], v3 offset:8512
    buffer_load_dwordx4 v1, s[20:23], s33 offen offset:3104 nt lds
    v_add_f32 v50, v50, v88
    v_exp_f32 v49, v49
    v_mfma_f32_16x16x32_bf16 v[176:179], a[112:115], v[68:71], 0
    s_add_u32 m0, s29, 115584
    ds_read_b128 a[80:83], v3 offset:512
    v_max3_f32 v26, v56, v57, v58
    v_max3_f32 v26, v26, v59, v60
    v_max3_f32 v26, v26, v61, v62
    v_max_f32 v26, v26, v63
    v_mov_b32 v27, v26
    v_add_f32 v51, v51, v88
    v_mfma_f32_16x16x32_bf16 v[180:183], a[116:119], v[68:71], 0
    s_mov_b32 s31, 196608
    ds_read_b128 a[84:87], v3 offset:8768
    v_permlane16_swap_b32 v26, v27
    v_max_f32 v26, v26, v27
    v_mov_b32 v27, v26
    v_cvt_pk_bf16_f32 v72, v48, v49
    v_exp_f32 v50, v50
    v_mfma_f32_16x16x32_bf16 v[184:187], a[120:123], v[68:71], 0
    ds_read_b128 a[88:91], v3 offset:768
    v_permlane32_swap_b32 v26, v27
    v_max_f32 v26, v26, v27
    v_exp_f32 v51, v51
    v_mul_f32 v92, -1.0, v26
    v_mfma_f32_16x16x32_bf16 v[188:191], a[124:127], v[68:71], 0
    ds_read_b128 a[92:95], v3 offset:9024
    v_mul_f32 v93, -1.0, v26
    v_mul_f32 v94, -1.0, v26
    v_add_f32 v52, v52, v88
    v_add_f32 v53, v53, v88
    v_mfma_f32_16x16x32_bf16 a[136:139], a[128:131], v[68:71], 0
    s_waitcnt lgkmcnt(5)
    v_mul_f32 v95, -1.0, v26
    v_cvt_pk_bf16_f32 v73, v50, v51
    v_exp_f32 v52, v52
    v_mfma_f32_16x16x32_bf16 v[32:35], a[64:67], a[148:151], v[80:83]
    v_exp_f32 v53, v53
    v_mfma_f32_16x16x32_bf16 v[36:39], a[68:71], a[148:151], v[80:83]
    v_add_f32 v54, v54, v88
    v_add_f32 v55, v55, v88
    v_mfma_f32_16x16x32_bf16 v[32:35], a[72:75], a[152:155], v[32:35]
    s_waitcnt lgkmcnt(2)
    ds_read_b128 a[48:51], v10 offset:0
    ds_read_b128 a[52:55], v10 offset:1088
    ds_read_b128 a[56:59], v10 offset:2176
    ds_read_b128 a[60:63], v10 offset:3264
    v_cvt_pk_bf16_f32 v74, v52, v53
    v_mov_b32 v14, v48
    v_exp_f32 v54, v54
    v_mfma_f32_16x16x32_bf16 v[36:39], a[76:79], a[152:155], v[36:39]
    buffer_load_dwordx4 v1, s[16:19], s31 offen nt lds
    v_exp_f32 v55, v55
    v_mfma_f32_16x16x32_bf16 v[32:35], a[80:83], a[156:159], v[32:35]
    v_add_f32 v14, v14, v49
    v_cvt_pk_bf16_f32 v75, v54, v55
    v_mfma_f32_16x16x32_bf16 v[36:39], a[84:87], a[156:159], v[36:39]
    s_waitcnt lgkmcnt(4)
    v_add_f32 v14, v14, v50
    v_add_f32 v14, v14, v51
    v_mfma_f32_16x16x32_bf16 v[32:35], a[88:91], a[160:163], v[32:35]
    v_add_f32 v56, v56, v92
    v_add_f32 v57, v57, v92
    v_mfma_f32_16x16x32_bf16 v[36:39], a[92:95], a[160:163], v[36:39]
    buffer_load_dwordx4 v1, s[16:19], s31 offen offset:1024 nt lds
    v_mfma_f32_16x16x32_bf16 v[192:195], a[96:99], v[72:75], 0
    s_add_u32 m0, s29, 115584
    v_exp_f32 v56, v56
    v_mfma_f32_16x16x32_bf16 v[196:199], a[100:103], v[72:75], 0
    s_mov_b32 s32, 186368
    v_exp_f32 v57, v57
    v_mfma_f32_16x16x32_bf16 v[200:203], a[104:107], v[72:75], 0
    s_mov_b32 s33, 186336
    v_add_f32 v14, v14, v52
    v_add_f32 v14, v14, v53
    v_mfma_f32_16x16x32_bf16 v[204:207], a[108:111], v[72:75], 0
    v_add_f32 v58, v58, v92
    v_add_f32 v59, v59, v92
    v_mfma_f32_16x16x32_bf16 v[208:211], a[112:115], v[72:75], 0
    v_cvt_pk_bf16_f32 v76, v56, v57
    v_add_f32 v14, v14, v54
    v_mfma_f32_16x16x32_bf16 v[212:215], a[116:119], v[72:75], 0
    v_exp_f32 v58, v58
    v_mfma_f32_16x16x32_bf16 v[216:219], a[120:123], v[72:75], 0
    v_exp_f32 v59, v59
    v_mfma_f32_16x16x32_bf16 v[220:223], a[124:127], v[72:75], 0
    v_add_f32 v60, v60, v92
    v_add_f32 v61, v61, v92
    buffer_load_dwordx4 v1, s[20:23], s32 offen offset:2048 nt lds
    v_cvt_pk_bf16_f32 v77, v58, v59
    v_exp_f32 v60, v60
    v_mfma_f32_16x16x32_bf16 v[40:43], a[64:67], a[164:167], v[84:87]
    v_exp_f32 v61, v61
    v_mfma_f32_16x16x32_bf16 v[44:47], a[68:71], a[164:167], v[84:87]
    v_add_f32 v62, v62, v92
    v_add_f32 v63, v63, v92
    v_mfma_f32_16x16x32_bf16 v[40:43], a[72:75], a[168:171], v[40:43]
    v_cvt_pk_bf16_f32 v78, v60, v61
    v_add_f32 v14, v14, v55
    v_exp_f32 v62, v62
    v_mfma_f32_16x16x32_bf16 v[44:47], a[76:79], a[168:171], v[44:47]
    buffer_load_dwordx4 v1, s[20:23], s33 offen offset:3104 nt lds
    v_exp_f32 v63, v63
    v_mfma_f32_16x16x32_bf16 v[40:43], a[80:83], a[172:175], v[40:43]
    v_exp_f32 v32, v32
    v_mfma_f32_16x16x32_bf16 v[44:47], a[84:87], a[172:175], v[44:47]
    v_cvt_pk_bf16_f32 v79, v62, v63
    v_add_f32 v12, v12, v32
    v_mfma_f32_16x16x32_bf16 v[40:43], a[88:91], a[176:179], v[40:43]
    v_exp_f32 v33, v33
    v_mfma_f32_16x16x32_bf16 v[44:47], a[92:95], a[176:179], v[44:47]
    v_cvt_pk_bf16_f32 v64, v32, v33
    v_add_f32 v12, v12, v33
    v_mfma_f32_16x16x32_bf16 v[224:227], a[96:99], v[76:79], 0
    v_exp_f32 v34, v34
    v_mfma_f32_16x16x32_bf16 v[228:231], a[100:103], v[76:79], 0
    v_exp_f32 v35, v35
    v_mfma_f32_16x16x32_bf16 v[232:235], a[104:107], v[76:79], 0
    ds_read_b64_tr_b16 a[96:97], v5 offset:16512
    ds_read_b64_tr_b16 a[98:99], v5 offset:24768
    v_mfma_f32_16x16x32_bf16 v[236:239], a[108:111], v[76:79], 0
    ds_read_b64_tr_b16 a[100:101], v5 offset:16544
    v_cvt_pk_bf16_f32 v65, v34, v35
    v_mfma_f32_16x16x32_bf16 v[240:243], a[112:115], v[76:79], 0
    v_exp_f32 v36, v36
    v_mfma_f32_16x16x32_bf16 v[244:247], a[116:119], v[76:79], 0
    ds_read_b64_tr_b16 a[102:103], v5 offset:24800
    ds_read_b64_tr_b16 a[104:105], v5 offset:16768
    v_mfma_f32_16x16x32_bf16 v[248:251], a[120:123], v[76:79], 0
    v_exp_f32 v37, v37
    v_mfma_f32_16x16x32_bf16 v[252:255], a[124:127], v[76:79], 0
    ds_read_b64_tr_b16 a[106:107], v5 offset:25024
    v_cvt_pk_bf16_f32 v66, v36, v37
    v_mfma_f32_16x16x32_bf16 a[144:147], a[128:131], v[76:79], 0
    ds_read_b64_tr_b16 a[108:109], v5 offset:16800
    ds_read_b64_tr_b16 a[110:111], v5 offset:25056
    v_mfma_f32_16x16x32_bf16 v[48:51], a[64:67], a[180:183], v[88:91]
    v_exp_f32 v38, v38
    v_mfma_f32_16x16x32_bf16 v[52:55], a[68:71], a[180:183], v[88:91]
    ds_read_b64_tr_b16 a[112:113], v5 offset:17024
    ds_read_b64_tr_b16 a[114:115], v5 offset:25280
    v_mfma_f32_16x16x32_bf16 v[48:51], a[72:75], a[184:187], v[48:51]
    v_exp_f32 v39, v39
    v_mfma_f32_16x16x32_bf16 v[52:55], a[76:79], a[184:187], v[52:55]
    ds_read_b64_tr_b16 a[116:117], v5 offset:17056
    v_cvt_pk_bf16_f32 v67, v38, v39
    v_mfma_f32_16x16x32_bf16 v[48:51], a[80:83], a[188:191], v[48:51]
    ds_read_b64_tr_b16 a[118:119], v5 offset:25312
    v_add_f32 v12, v12, v34
    v_mfma_f32_16x16x32_bf16 v[52:55], a[84:87], a[188:191], v[52:55]
    ds_read_b64_tr_b16 a[120:121], v5 offset:17280
    ds_read_b64_tr_b16 a[122:123], v5 offset:25536
    v_mfma_f32_16x16x32_bf16 v[48:51], a[88:91], a[192:195], v[48:51]
    ds_read_b64_tr_b16 a[124:125], v5 offset:17312
    ds_read_b64_tr_b16 a[126:127], v5 offset:25568
    v_mfma_f32_16x16x32_bf16 v[52:55], a[92:95], a[192:195], v[52:55]
    s_waitcnt lgkmcnt(6)
    v_exp_f32 v40, v40
    v_mfma_f32_16x16x32_bf16 v[128:131], a[96:99], v[64:67], v[128:131]
    v_exp_f32 v41, v41
    v_mfma_f32_16x16x32_bf16 v[132:135], a[100:103], v[64:67], v[132:135]
    v_add_f32 v12, v12, v35
    v_add_f32 v12, v12, v36
    v_mfma_f32_16x16x32_bf16 v[136:139], a[104:107], v[64:67], v[136:139]
    v_add_f32 v12, v12, v37
    v_cvt_pk_bf16_f32 v68, v40, v41
    v_mfma_f32_16x16x32_bf16 v[140:143], a[108:111], v[64:67], v[140:143]
    v_exp_f32 v42, v42
    v_mfma_f32_16x16x32_bf16 v[144:147], a[112:115], v[64:67], v[144:147]
    s_waitcnt lgkmcnt(0)
    v_exp_f32 v43, v43
    v_mfma_f32_16x16x32_bf16 v[148:151], a[116:119], v[64:67], v[148:151]
    v_add_f32 v12, v12, v38
    v_add_f32 v12, v12, v39
    v_mfma_f32_16x16x32_bf16 v[152:155], a[120:123], v[64:67], v[152:155]
    v_exp_f32 v44, v44
    v_mfma_f32_16x16x32_bf16 v[156:159], a[124:127], v[64:67], v[156:159]
    v_exp_f32 v45, v45
    v_cvt_pk_bf16_f32 v69, v42, v43
    v_mfma_f32_16x16x32_bf16 v[56:59], a[64:67], a[196:199], v[92:95]
    ds_read_b128 a[64:67], v3 offset:16512
    v_cvt_pk_bf16_f32 v70, v44, v45
    v_mfma_f32_16x16x32_bf16 v[60:63], a[68:71], a[196:199], v[92:95]
    v_exp_f32 v46, v46
    v_mfma_f32_16x16x32_bf16 v[56:59], a[72:75], a[200:203], v[56:59]
    v_exp_f32 v47, v47
    v_mfma_f32_16x16x32_bf16 v[60:63], a[76:79], a[200:203], v[60:63]
    ds_read_b128 a[68:71], v3 offset:24768
    v_cvt_pk_bf16_f32 v71, v46, v47
    v_mfma_f32_16x16x32_bf16 v[56:59], a[80:83], a[204:207], v[56:59]
    v_exp_f32 v48, v48
    v_mfma_f32_16x16x32_bf16 v[60:63], a[84:87], a[204:207], v[60:63]
    ds_read_b128 a[72:75], v3 offset:16768
    ds_read_b128 a[76:79], v3 offset:25024
    v_mfma_f32_16x16x32_bf16 v[56:59], a[88:91], a[208:211], v[56:59]
    v_exp_f32 v49, v49
    v_mfma_f32_16x16x32_bf16 v[60:63], a[92:95], a[208:211], v[60:63]
    ds_read_b128 a[80:83], v3 offset:17024
    v_cvt_pk_bf16_f32 v72, v48, v49
    v_mfma_f32_16x16x32_bf16 v[160:163], a[96:99], v[68:71], v[160:163]
    ds_read_b128 a[84:87], v3 offset:25280
    ds_read_b128 a[88:91], v3 offset:17280
    v_mfma_f32_16x16x32_bf16 v[164:167], a[100:103], v[68:71], v[164:167]
    v_exp_f32 v50, v50
    v_mfma_f32_16x16x32_bf16 v[168:171], a[104:107], v[68:71], v[168:171]
    v_exp_f32 v51, v51
    v_mfma_f32_16x16x32_bf16 v[172:175], a[108:111], v[68:71], v[172:175]
    ds_read_b128 a[92:95], v3 offset:25536
    v_cvt_pk_bf16_f32 v73, v50, v51
    v_mfma_f32_16x16x32_bf16 v[176:179], a[112:115], v[68:71], v[176:179]
    v_exp_f32 v52, v52
    v_mfma_f32_16x16x32_bf16 v[180:183], a[116:119], v[68:71], v[180:183]
    v_exp_f32 v53, v53
    v_mfma_f32_16x16x32_bf16 v[184:187], a[120:123], v[68:71], v[184:187]
    v_cvt_pk_bf16_f32 v74, v52, v53
    v_add_f32 v14, v14, v48
    v_mfma_f32_16x16x32_bf16 v[188:191], a[124:127], v[68:71], v[188:191]
    v_exp_f32 v54, v54
    v_mfma_f32_16x16x32_bf16 a[136:139], a[128:131], v[68:71], a[136:139]
    s_waitcnt lgkmcnt(1)
    v_exp_f32 v55, v55
    v_mfma_f32_16x16x32_bf16 v[32:35], a[64:67], a[148:151], v[80:83]
    v_add_f32 v14, v14, v49
    v_cvt_pk_bf16_f32 v75, v54, v55
    v_mfma_f32_16x16x32_bf16 v[36:39], a[68:71], a[148:151], v[80:83]
    v_exp_f32 v56, v56
    v_mfma_f32_16x16x32_bf16 v[32:35], a[72:75], a[152:155], v[32:35]
    v_exp_f32 v57, v57
    v_mfma_f32_16x16x32_bf16 v[36:39], a[76:79], a[152:155], v[36:39]
    v_add_f32 v14, v14, v50
    v_add_f32 v14, v14, v51
    v_mfma_f32_16x16x32_bf16 v[32:35], a[80:83], a[156:159], v[32:35]
    v_add_f32 v14, v14, v52
    v_add_f32 v14, v14, v53
    v_mfma_f32_16x16x32_bf16 v[36:39], a[84:87], a[156:159], v[36:39]
    v_cvt_pk_bf16_f32 v76, v56, v57
    v_add_f32 v14, v14, v54
    v_mfma_f32_16x16x32_bf16 v[32:35], a[88:91], a[160:163], v[32:35]
    s_waitcnt lgkmcnt(0)
    v_exp_f32 v58, v58
    v_mfma_f32_16x16x32_bf16 v[36:39], a[92:95], a[160:163], v[36:39]
    v_exp_f32 v59, v59
    v_mfma_f32_16x16x32_bf16 v[192:195], a[96:99], v[72:75], v[192:195]
    v_add_f32 v14, v14, v55
    v_cvt_pk_bf16_f32 v77, v58, v59
    v_mfma_f32_16x16x32_bf16 v[196:199], a[100:103], v[72:75], v[196:199]
    v_exp_f32 v60, v60
    v_mfma_f32_16x16x32_bf16 v[200:203], a[104:107], v[72:75], v[200:203]
    v_exp_f32 v61, v61
    v_mfma_f32_16x16x32_bf16 v[204:207], a[108:111], v[72:75], v[204:207]
    v_exp_f32 v62, v62
    v_mfma_f32_16x16x32_bf16 v[208:211], a[112:115], v[72:75], v[208:211]
    v_exp_f32 v63, v63
    v_mfma_f32_16x16x32_bf16 v[212:215], a[116:119], v[72:75], v[212:215]
    v_cvt_pk_bf16_f32 v78, v60, v61
    v_cvt_pk_bf16_f32 v79, v62, v63
    v_mfma_f32_16x16x32_bf16 v[216:219], a[120:123], v[72:75], v[216:219]
    v_exp_f32 v32, v32
    v_mfma_f32_16x16x32_bf16 v[220:223], a[124:127], v[72:75], v[220:223]
    v_exp_f32 v33, v33
    v_mfma_f32_16x16x32_bf16 v[40:43], a[64:67], a[164:167], v[84:87]
    s_waitcnt vmcnt(16) lgkmcnt(0)
    s_barrier
    v_mfma_f32_16x16x32_bf16 v[44:47], a[68:71], a[164:167], v[84:87]
    v_cvt_pk_bf16_f32 v64, v32, v33
    v_add_f32 v12, v12, v32
    v_mfma_f32_16x16x32_bf16 v[40:43], a[72:75], a[168:171], v[40:43]
    s_add_u32 m0, s29, 0
    v_exp_f32 v34, v34
    v_mfma_f32_16x16x32_bf16 v[44:47], a[76:79], a[168:171], v[44:47]
    s_mov_b32 s31, 204800
    v_exp_f32 v35, v35
    v_mfma_f32_16x16x32_bf16 v[40:43], a[80:83], a[172:175], v[40:43]
    v_cvt_pk_bf16_f32 v65, v34, v35
    v_add_f32 v12, v12, v33
    v_mfma_f32_16x16x32_bf16 v[44:47], a[84:87], a[172:175], v[44:47]
    v_exp_f32 v36, v36
    v_mfma_f32_16x16x32_bf16 v[40:43], a[88:91], a[176:179], v[40:43]
    v_exp_f32 v37, v37
    v_mfma_f32_16x16x32_bf16 v[44:47], a[92:95], a[176:179], v[44:47]
    v_cvt_pk_bf16_f32 v66, v36, v37
    v_add_f32 v12, v12, v34
    v_mfma_f32_16x16x32_bf16 v[224:227], a[96:99], v[76:79], v[224:227]
    ds_read_b64_tr_b16 a[96:97], v5 offset:33024
    ds_read_b64_tr_b16 a[98:99], v5 offset:41280
    v_mfma_f32_16x16x32_bf16 v[228:231], a[100:103], v[76:79], v[228:231]
    ds_read_b64_tr_b16 a[100:101], v5 offset:33056
    ds_read_b64_tr_b16 a[102:103], v5 offset:41312
    v_mfma_f32_16x16x32_bf16 v[232:235], a[104:107], v[76:79], v[232:235]
    ds_read_b64_tr_b16 a[104:105], v5 offset:33280
    ds_read_b64_tr_b16 a[106:107], v5 offset:41536
    v_mfma_f32_16x16x32_bf16 v[236:239], a[108:111], v[76:79], v[236:239]
    ds_read_b64_tr_b16 a[108:109], v5 offset:33312
    ds_read_b64_tr_b16 a[110:111], v5 offset:41568
    v_mfma_f32_16x16x32_bf16 v[240:243], a[112:115], v[76:79], v[240:243]
    v_exp_f32 v38, v38
    v_mfma_f32_16x16x32_bf16 v[244:247], a[116:119], v[76:79], v[244:247]
    ds_read_b64_tr_b16 a[112:113], v5 offset:33536
    ds_read_b64_tr_b16 a[114:115], v5 offset:41792
    v_mfma_f32_16x16x32_bf16 v[248:251], a[120:123], v[76:79], v[248:251]
    v_exp_f32 v39, v39
    v_mfma_f32_16x16x32_bf16 v[252:255], a[124:127], v[76:79], v[252:255]
    ds_read_b64_tr_b16 a[116:117], v5 offset:33568
    v_cvt_pk_bf16_f32 v67, v38, v39
    v_mfma_f32_16x16x32_bf16 a[144:147], a[128:131], v[76:79], a[144:147]
    buffer_load_dwordx4 v1, s[16:19], s31 offen nt lds
    v_mfma_f32_16x16x32_bf16 v[48:51], a[64:67], a[180:183], v[88:91]
    ds_read_b64_tr_b16 a[118:119], v5 offset:41824
    v_add_f32 v12, v12, v35
    v_mfma_f32_16x16x32_bf16 v[52:55], a[68:71], a[180:183], v[88:91]
    ds_read_b64_tr_b16 a[120:121], v5 offset:33792
    ds_read_b64_tr_b16 a[122:123], v5 offset:42048
    v_mfma_f32_16x16x32_bf16 v[48:51], a[72:75], a[184:187], v[48:51]
    ds_read_b64_tr_b16 a[124:125], v5 offset:33824
    ds_read_b64_tr_b16 a[126:127], v5 offset:42080
    v_mfma_f32_16x16x32_bf16 v[52:55], a[76:79], a[184:187], v[52:55]
    buffer_load_dwordx4 v1, s[16:19], s31 offen offset:1024 nt lds
    v_mfma_f32_16x16x32_bf16 v[48:51], a[80:83], a[188:191], v[48:51]
    v_exp_f32 v40, v40
    v_mfma_f32_16x16x32_bf16 v[52:55], a[84:87], a[188:191], v[52:55]
    v_exp_f32 v41, v41
    v_mfma_f32_16x16x32_bf16 v[48:51], a[88:91], a[192:195], v[48:51]
    v_add_f32 v12, v12, v36
    v_add_f32 v12, v12, v37
    v_mfma_f32_16x16x32_bf16 v[52:55], a[92:95], a[192:195], v[52:55]
    s_waitcnt lgkmcnt(2)
    v_cvt_pk_bf16_f32 v68, v40, v41
    v_add_f32 v12, v12, v38
    v_mfma_f32_16x16x32_bf16 v[128:131], a[96:99], v[64:67], v[128:131]
    v_exp_f32 v42, v42
    v_mfma_f32_16x16x32_bf16 v[132:135], a[100:103], v[64:67], v[132:135]
    v_exp_f32 v43, v43
    v_mfma_f32_16x16x32_bf16 v[136:139], a[104:107], v[64:67], v[136:139]
    v_add_f32 v12, v12, v39
    v_cvt_pk_bf16_f32 v69, v42, v43
    v_mfma_f32_16x16x32_bf16 v[140:143], a[108:111], v[64:67], v[140:143]
    v_exp_f32 v44, v44
    v_mfma_f32_16x16x32_bf16 v[144:147], a[112:115], v[64:67], v[144:147]
    v_exp_f32 v45, v45
    v_mfma_f32_16x16x32_bf16 v[148:151], a[116:119], v[64:67], v[148:151]
    v_exp_f32 v46, v46
    v_mfma_f32_16x16x32_bf16 v[152:155], a[120:123], v[64:67], v[152:155]
    s_waitcnt lgkmcnt(0)
    v_exp_f32 v47, v47
    v_mfma_f32_16x16x32_bf16 v[156:159], a[124:127], v[64:67], v[156:159]
    v_cvt_pk_bf16_f32 v70, v44, v45
    v_cvt_pk_bf16_f32 v71, v46, v47
    v_mfma_f32_16x16x32_bf16 v[56:59], a[64:67], a[196:199], v[92:95]
    s_add_u32 m0, s29, 0
    v_exp_f32 v48, v48
    v_mfma_f32_16x16x32_bf16 v[60:63], a[68:71], a[196:199], v[92:95]
    s_mov_b32 s32, 194560
    ds_read_b128 a[64:67], v3 offset:33024
    ds_read_b128 a[68:71], v3 offset:41280
    v_mfma_f32_16x16x32_bf16 v[56:59], a[72:75], a[200:203], v[56:59]
    s_mov_b32 s33, 194528
    ds_read_b128 a[72:75], v3 offset:33280
    v_add_f32 v14, v14, v48
    v_mfma_f32_16x16x32_bf16 v[60:63], a[76:79], a[200:203], v[60:63]
    v_exp_f32 v49, v49
    v_mfma_f32_16x16x32_bf16 v[56:59], a[80:83], a[204:207], v[56:59]
    ds_read_b128 a[76:79], v3 offset:41536
    ds_read_b128 a[80:83], v3 offset:33536
    v_mfma_f32_16x16x32_bf16 v[60:63], a[84:87], a[204:207], v[60:63]
    ds_read_b128 a[84:87], v3 offset:41792
    v_cvt_pk_bf16_f32 v72, v48, v49
    v_mfma_f32_16x16x32_bf16 v[56:59], a[88:91], a[208:211], v[56:59]
    v_exp_f32 v50, v50
    v_mfma_f32_16x16x32_bf16 v[60:63], a[92:95], a[208:211], v[60:63]
    v_exp_f32 v51, v51
    v_mfma_f32_16x16x32_bf16 v[160:163], a[96:99], v[68:71], v[160:163]
    ds_read_b128 a[88:91], v3 offset:33792
    v_cvt_pk_bf16_f32 v73, v50, v51
    v_mfma_f32_16x16x32_bf16 v[164:167], a[100:103], v[68:71], v[164:167]
    ds_read_b128 a[92:95], v3 offset:42048
    v_add_f32 v14, v14, v49
    v_mfma_f32_16x16x32_bf16 v[168:171], a[104:107], v[68:71], v[168:171]
    v_exp_f32 v52, v52
    v_mfma_f32_16x16x32_bf16 v[172:175], a[108:111], v[68:71], v[172:175]
    v_exp_f32 v53, v53
    v_mfma_f32_16x16x32_bf16 v[176:179], a[112:115], v[68:71], v[176:179]
    v_cvt_pk_bf16_f32 v74, v52, v53
    v_add_f32 v14, v14, v50
    v_mfma_f32_16x16x32_bf16 v[180:183], a[116:119], v[68:71], v[180:183]
    v_exp_f32 v54, v54
    v_mfma_f32_16x16x32_bf16 v[184:187], a[120:123], v[68:71], v[184:187]
    buffer_load_dwordx4 v1, s[20:23], s32 offen offset:2048 nt lds
    v_mfma_f32_16x16x32_bf16 v[188:191], a[124:127], v[68:71], v[188:191]
    v_exp_f32 v55, v55
    v_mfma_f32_16x16x32_bf16 a[136:139], a[128:131], v[68:71], a[136:139]
    s_waitcnt lgkmcnt(0)
    v_cvt_pk_bf16_f32 v75, v54, v55
    v_add_f32 v14, v14, v51
    v_mfma_f32_16x16x32_bf16 v[32:35], a[64:67], a[148:151], v[80:83]
    v_exp_f32 v56, v56
    v_mfma_f32_16x16x32_bf16 v[36:39], a[68:71], a[148:151], v[80:83]
    buffer_load_dwordx4 v1, s[20:23], s33 offen offset:3104 nt lds
    v_mfma_f32_16x16x32_bf16 v[32:35], a[72:75], a[152:155], v[32:35]
    v_exp_f32 v57, v57
    v_mfma_f32_16x16x32_bf16 v[36:39], a[76:79], a[152:155], v[36:39]
    v_add_f32 v14, v14, v52
    v_add_f32 v14, v14, v53
    v_mfma_f32_16x16x32_bf16 v[32:35], a[80:83], a[156:159], v[32:35]
    v_cvt_pk_bf16_f32 v76, v56, v57
    v_add_f32 v14, v14, v54
    v_mfma_f32_16x16x32_bf16 v[36:39], a[84:87], a[156:159], v[36:39]
    v_exp_f32 v58, v58
    v_mfma_f32_16x16x32_bf16 v[32:35], a[88:91], a[160:163], v[32:35]
    v_exp_f32 v59, v59
    v_mfma_f32_16x16x32_bf16 v[36:39], a[92:95], a[160:163], v[36:39]
    v_add_f32 v14, v14, v55
    v_cvt_pk_bf16_f32 v77, v58, v59
    v_mfma_f32_16x16x32_bf16 v[192:195], a[96:99], v[72:75], v[192:195]
    v_exp_f32 v60, v60
    v_mfma_f32_16x16x32_bf16 v[196:199], a[100:103], v[72:75], v[196:199]
    v_exp_f32 v61, v61
    v_mfma_f32_16x16x32_bf16 v[200:203], a[104:107], v[72:75], v[200:203]
    v_exp_f32 v62, v62
    v_mfma_f32_16x16x32_bf16 v[204:207], a[108:111], v[72:75], v[204:207]
    v_exp_f32 v63, v63
    v_mfma_f32_16x16x32_bf16 v[208:211], a[112:115], v[72:75], v[208:211]
    v_cvt_pk_bf16_f32 v78, v60, v61
    v_cvt_pk_bf16_f32 v79, v62, v63
    v_mfma_f32_16x16x32_bf16 v[212:215], a[116:119], v[72:75], v[212:215]
    v_exp_f32 v32, v32
    v_mfma_f32_16x16x32_bf16 v[216:219], a[120:123], v[72:75], v[216:219]
    v_exp_f32 v33, v33
    v_mfma_f32_16x16x32_bf16 v[220:223], a[124:127], v[72:75], v[220:223]
    v_cvt_pk_bf16_f32 v64, v32, v33
    v_add_f32 v12, v12, v32
    v_mfma_f32_16x16x32_bf16 v[40:43], a[64:67], a[164:167], v[84:87]
    v_exp_f32 v34, v34
    v_mfma_f32_16x16x32_bf16 v[44:47], a[68:71], a[164:167], v[84:87]
    v_exp_f32 v35, v35
    v_mfma_f32_16x16x32_bf16 v[40:43], a[72:75], a[168:171], v[40:43]
    s_add_u32 m0, s29, 16512
    v_cvt_pk_bf16_f32 v65, v34, v35
    v_add_f32 v12, v12, v33
    v_mfma_f32_16x16x32_bf16 v[44:47], a[76:79], a[168:171], v[44:47]
    s_mov_b32 s31, 212992
    v_exp_f32 v36, v36
    v_mfma_f32_16x16x32_bf16 v[40:43], a[80:83], a[172:175], v[40:43]
    v_exp_f32 v37, v37
    v_mfma_f32_16x16x32_bf16 v[44:47], a[84:87], a[172:175], v[44:47]
    v_cvt_pk_bf16_f32 v66, v36, v37
    v_add_f32 v12, v12, v34
    v_mfma_f32_16x16x32_bf16 v[40:43], a[88:91], a[176:179], v[40:43]
    v_exp_f32 v38, v38
    v_mfma_f32_16x16x32_bf16 v[44:47], a[92:95], a[176:179], v[44:47]
    v_exp_f32 v39, v39
    v_mfma_f32_16x16x32_bf16 v[224:227], a[96:99], v[76:79], v[224:227]
    ds_read_b64_tr_b16 a[96:97], v5 offset:49536
    ds_read_b64_tr_b16 a[98:99], v5 offset:57792
    v_mfma_f32_16x16x32_bf16 v[228:231], a[100:103], v[76:79], v[228:231]
    ds_read_b64_tr_b16 a[100:101], v5 offset:49568
    ds_read_b64_tr_b16 a[102:103], v5 offset:57824
    v_mfma_f32_16x16x32_bf16 v[232:235], a[104:107], v[76:79], v[232:235]
    ds_read_b64_tr_b16 a[104:105], v5 offset:49792
    ds_read_b64_tr_b16 a[106:107], v5 offset:58048
    v_mfma_f32_16x16x32_bf16 v[236:239], a[108:111], v[76:79], v[236:239]
    ds_read_b64_tr_b16 a[108:109], v5 offset:49824
    ds_read_b64_tr_b16 a[110:111], v5 offset:58080
    v_mfma_f32_16x16x32_bf16 v[240:243], a[112:115], v[76:79], v[240:243]
    ds_read_b64_tr_b16 a[112:113], v5 offset:50048
    ds_read_b64_tr_b16 a[114:115], v5 offset:58304
    v_mfma_f32_16x16x32_bf16 v[244:247], a[116:119], v[76:79], v[244:247]
    ds_read_b64_tr_b16 a[116:117], v5 offset:50080
    v_cvt_pk_bf16_f32 v67, v38, v39
    v_mfma_f32_16x16x32_bf16 v[248:251], a[120:123], v[76:79], v[248:251]
    ds_read_b64_tr_b16 a[118:119], v5 offset:58336
    v_add_f32 v12, v12, v35
    v_mfma_f32_16x16x32_bf16 v[252:255], a[124:127], v[76:79], v[252:255]
    ds_read_b64_tr_b16 a[120:121], v5 offset:50304
    ds_read_b64_tr_b16 a[122:123], v5 offset:58560
    v_mfma_f32_16x16x32_bf16 a[144:147], a[128:131], v[76:79], a[144:147]
    buffer_load_dwordx4 v1, s[16:19], s31 offen nt lds
    v_mfma_f32_16x16x32_bf16 v[48:51], a[64:67], a[180:183], v[88:91]
    ds_read_b64_tr_b16 a[124:125], v5 offset:50336
    ds_read_b64_tr_b16 a[126:127], v5 offset:58592
    v_mfma_f32_16x16x32_bf16 v[52:55], a[68:71], a[180:183], v[88:91]
    v_exp_f32 v40, v40
    v_mfma_f32_16x16x32_bf16 v[48:51], a[72:75], a[184:187], v[48:51]
    v_exp_f32 v41, v41
    v_mfma_f32_16x16x32_bf16 v[52:55], a[76:79], a[184:187], v[52:55]
    buffer_load_dwordx4 v1, s[16:19], s31 offen offset:1024 nt lds
    v_mfma_f32_16x16x32_bf16 v[48:51], a[80:83], a[188:191], v[48:51]
    v_add_f32 v12, v12, v36
    v_add_f32 v12, v12, v37
    v_mfma_f32_16x16x32_bf16 v[52:55], a[84:87], a[188:191], v[52:55]
    v_cvt_pk_bf16_f32 v68, v40, v41
    v_add_f32 v12, v12, v38
    v_mfma_f32_16x16x32_bf16 v[48:51], a[88:91], a[192:195], v[48:51]
    v_exp_f32 v42, v42
    v_mfma_f32_16x16x32_bf16 v[52:55], a[92:95], a[192:195], v[52:55]
    s_waitcnt lgkmcnt(0)
    v_exp_f32 v43, v43
    v_mfma_f32_16x16x32_bf16 v[128:131], a[96:99], v[64:67], v[128:131]
    v_add_f32 v12, v12, v39
    v_cvt_pk_bf16_f32 v69, v42, v43
    v_mfma_f32_16x16x32_bf16 v[132:135], a[100:103], v[64:67], v[132:135]
    v_exp_f32 v44, v44
    v_mfma_f32_16x16x32_bf16 v[136:139], a[104:107], v[64:67], v[136:139]
    v_exp_f32 v45, v45
    v_mfma_f32_16x16x32_bf16 v[140:143], a[108:111], v[64:67], v[140:143]
    v_exp_f32 v46, v46
    v_mfma_f32_16x16x32_bf16 v[144:147], a[112:115], v[64:67], v[144:147]
    v_exp_f32 v47, v47
    v_mfma_f32_16x16x32_bf16 v[148:151], a[116:119], v[64:67], v[148:151]
    v_cvt_pk_bf16_f32 v70, v44, v45
    v_cvt_pk_bf16_f32 v71, v46, v47
    v_mfma_f32_16x16x32_bf16 v[152:155], a[120:123], v[64:67], v[152:155]
    v_exp_f32 v48, v48
    v_mfma_f32_16x16x32_bf16 v[156:159], a[124:127], v[64:67], v[156:159]
    v_exp_f32 v49, v49
    v_mfma_f32_16x16x32_bf16 v[56:59], a[64:67], a[196:199], v[92:95]
    ds_read_b128 a[64:67], v3 offset:49536
    v_cvt_pk_bf16_f32 v72, v48, v49
    v_mfma_f32_16x16x32_bf16 v[60:63], a[68:71], a[196:199], v[92:95]
    ds_read_b128 a[68:71], v3 offset:57792
    v_add_f32 v14, v14, v48
    v_mfma_f32_16x16x32_bf16 v[56:59], a[72:75], a[200:203], v[56:59]
    ds_read_b128 a[72:75], v3 offset:49792
    v_add_f32 v14, v14, v49
    v_mfma_f32_16x16x32_bf16 v[60:63], a[76:79], a[200:203], v[60:63]
    v_exp_f32 v50, v50
    v_mfma_f32_16x16x32_bf16 v[56:59], a[80:83], a[204:207], v[56:59]
    ds_read_b128 a[76:79], v3 offset:58048
    ds_read_b128 a[80:83], v3 offset:50048
    v_mfma_f32_16x16x32_bf16 v[60:63], a[84:87], a[204:207], v[60:63]
    ds_read_b128 a[84:87], v3 offset:58304
    v_add_f32 v14, v14, v50
    v_mfma_f32_16x16x32_bf16 v[56:59], a[88:91], a[208:211], v[56:59]
    v_exp_f32 v51, v51
    v_mfma_f32_16x16x32_bf16 v[60:63], a[92:95], a[208:211], v[60:63]
    ds_read_b128 a[88:91], v3 offset:50304
    v_cvt_pk_bf16_f32 v73, v50, v51
    v_mfma_f32_16x16x32_bf16 v[160:163], a[96:99], v[68:71], v[160:163]
    ds_read_b128 a[92:95], v3 offset:58560
    v_add_f32 v14, v14, v51
    v_mfma_f32_16x16x32_bf16 v[164:167], a[100:103], v[68:71], v[164:167]
    v_exp_f32 v52, v52
    v_mfma_f32_16x16x32_bf16 v[168:171], a[104:107], v[68:71], v[168:171]
    v_exp_f32 v53, v53
    v_mfma_f32_16x16x32_bf16 v[172:175], a[108:111], v[68:71], v[172:175]
    v_cvt_pk_bf16_f32 v74, v52, v53
    v_add_f32 v14, v14, v52
    v_mfma_f32_16x16x32_bf16 v[176:179], a[112:115], v[68:71], v[176:179]
    v_exp_f32 v54, v54
    v_mfma_f32_16x16x32_bf16 v[180:183], a[116:119], v[68:71], v[180:183]
    v_exp_f32 v55, v55
    v_mfma_f32_16x16x32_bf16 v[184:187], a[120:123], v[68:71], v[184:187]
    v_cvt_pk_bf16_f32 v75, v54, v55
    v_add_f32 v14, v14, v53
    v_mfma_f32_16x16x32_bf16 v[188:191], a[124:127], v[68:71], v[188:191]
    v_exp_f32 v56, v56
    v_mfma_f32_16x16x32_bf16 a[136:139], a[128:131], v[68:71], a[136:139]
    s_waitcnt lgkmcnt(0)
    v_exp_f32 v57, v57
    v_mfma_f32_16x16x32_bf16 v[32:35], a[64:67], a[148:151], v[80:83]
    v_cvt_pk_bf16_f32 v76, v56, v57
    v_add_f32 v14, v14, v54
    v_mfma_f32_16x16x32_bf16 v[36:39], a[68:71], a[148:151], v[80:83]
    v_exp_f32 v58, v58
    v_mfma_f32_16x16x32_bf16 v[32:35], a[72:75], a[152:155], v[32:35]
    v_exp_f32 v59, v59
    v_mfma_f32_16x16x32_bf16 v[36:39], a[76:79], a[152:155], v[36:39]
    v_add_f32 v14, v14, v55
    v_cvt_pk_bf16_f32 v77, v58, v59
    v_mfma_f32_16x16x32_bf16 v[32:35], a[80:83], a[156:159], v[32:35]
    v_exp_f32 v60, v60
    v_mfma_f32_16x16x32_bf16 v[36:39], a[84:87], a[156:159], v[36:39]
    v_exp_f32 v61, v61
    v_mfma_f32_16x16x32_bf16 v[32:35], a[88:91], a[160:163], v[32:35]
    v_exp_f32 v62, v62
    v_mfma_f32_16x16x32_bf16 v[36:39], a[92:95], a[160:163], v[36:39]
    v_exp_f32 v63, v63
    v_mfma_f32_16x16x32_bf16 v[192:195], a[96:99], v[72:75], v[192:195]
    v_cvt_pk_bf16_f32 v78, v60, v61
    v_cvt_pk_bf16_f32 v79, v62, v63
    v_mfma_f32_16x16x32_bf16 v[196:199], a[100:103], v[72:75], v[196:199]
    v_mfma_f32_16x16x32_bf16 v[200:203], a[104:107], v[72:75], v[200:203]
    v_mfma_f32_16x16x32_bf16 v[204:207], a[108:111], v[72:75], v[204:207]
    v_mfma_f32_16x16x32_bf16 v[208:211], a[112:115], v[72:75], v[208:211]
    v_exp_f32 v32, v32
    v_mfma_f32_16x16x32_bf16 v[212:215], a[116:119], v[72:75], v[212:215]
    v_exp_f32 v33, v33
    v_mfma_f32_16x16x32_bf16 v[216:219], a[120:123], v[72:75], v[216:219]
    v_cvt_pk_bf16_f32 v64, v32, v33
    v_add_f32 v12, v12, v32
    v_mfma_f32_16x16x32_bf16 v[220:223], a[124:127], v[72:75], v[220:223]
    v_exp_f32 v34, v34
    v_mfma_f32_16x16x32_bf16 v[40:43], a[64:67], a[164:167], v[84:87]
    s_waitcnt vmcnt(14) lgkmcnt(0)
    s_barrier
    v_mfma_f32_16x16x32_bf16 v[44:47], a[68:71], a[164:167], v[84:87]
    v_exp_f32 v35, v35
    v_mfma_f32_16x16x32_bf16 v[40:43], a[72:75], a[168:171], v[40:43]
    s_add_u32 m0, s29, 16512
    v_cvt_pk_bf16_f32 v65, v34, v35
    v_add_f32 v12, v12, v33
    v_mfma_f32_16x16x32_bf16 v[44:47], a[76:79], a[168:171], v[44:47]
    s_mov_b32 s32, 202752
    v_exp_f32 v36, v36
    v_mfma_f32_16x16x32_bf16 v[40:43], a[80:83], a[172:175], v[40:43]
    s_mov_b32 s33, 202720
    v_exp_f32 v37, v37
    v_mfma_f32_16x16x32_bf16 v[44:47], a[84:87], a[172:175], v[44:47]
    v_cvt_pk_bf16_f32 v66, v36, v37
    v_add_f32 v12, v12, v34
    v_mfma_f32_16x16x32_bf16 v[40:43], a[88:91], a[176:179], v[40:43]
    v_exp_f32 v38, v38
    v_mfma_f32_16x16x32_bf16 v[44:47], a[92:95], a[176:179], v[44:47]
    v_exp_f32 v39, v39
    v_mfma_f32_16x16x32_bf16 v[224:227], a[96:99], v[76:79], v[224:227]
    ds_read_b64_tr_b16 a[96:97], v6 offset:0
    ds_read_b64_tr_b16 a[98:99], v6 offset:8256
    v_mfma_f32_16x16x32_bf16 v[228:231], a[100:103], v[76:79], v[228:231]
    ds_read_b64_tr_b16 a[100:101], v6 offset:32
    ds_read_b64_tr_b16 a[102:103], v6 offset:8288
    v_mfma_f32_16x16x32_bf16 v[232:235], a[104:107], v[76:79], v[232:235]
    ds_read_b64_tr_b16 a[104:105], v6 offset:256
    ds_read_b64_tr_b16 a[106:107], v6 offset:8512
    v_mfma_f32_16x16x32_bf16 v[236:239], a[108:111], v[76:79], v[236:239]
    ds_read_b64_tr_b16 a[108:109], v6 offset:288
    ds_read_b64_tr_b16 a[110:111], v6 offset:8544
    v_mfma_f32_16x16x32_bf16 v[240:243], a[112:115], v[76:79], v[240:243]
    ds_read_b64_tr_b16 a[112:113], v6 offset:512
    ds_read_b64_tr_b16 a[114:115], v6 offset:8768
    v_mfma_f32_16x16x32_bf16 v[244:247], a[116:119], v[76:79], v[244:247]
    ds_read_b64_tr_b16 a[116:117], v6 offset:544
    v_cvt_pk_bf16_f32 v67, v38, v39
    v_mfma_f32_16x16x32_bf16 v[248:251], a[120:123], v[76:79], v[248:251]
    ds_read_b64_tr_b16 a[118:119], v6 offset:8800
    v_add_f32 v12, v12, v35
    v_mfma_f32_16x16x32_bf16 v[252:255], a[124:127], v[76:79], v[252:255]
    ds_read_b64_tr_b16 a[120:121], v6 offset:768
    ds_read_b64_tr_b16 a[122:123], v6 offset:9024
    v_mfma_f32_16x16x32_bf16 a[144:147], a[128:131], v[76:79], a[144:147]
    buffer_load_dwordx4 v1, s[20:23], s32 offen offset:2048 nt lds
    v_mfma_f32_16x16x32_bf16 v[48:51], a[64:67], a[180:183], v[88:91]
    ds_read_b64_tr_b16 a[124:125], v6 offset:800
    ds_read_b64_tr_b16 a[126:127], v6 offset:9056
    v_mfma_f32_16x16x32_bf16 v[52:55], a[68:71], a[180:183], v[88:91]
    v_exp_f32 v40, v40
    v_mfma_f32_16x16x32_bf16 v[48:51], a[72:75], a[184:187], v[48:51]
    v_exp_f32 v41, v41
    v_mfma_f32_16x16x32_bf16 v[52:55], a[76:79], a[184:187], v[52:55]
    buffer_load_dwordx4 v1, s[20:23], s33 offen offset:3104 nt lds
    v_mfma_f32_16x16x32_bf16 v[48:51], a[80:83], a[188:191], v[48:51]
    v_add_f32 v12, v12, v36
    v_add_f32 v12, v12, v37
    v_mfma_f32_16x16x32_bf16 v[52:55], a[84:87], a[188:191], v[52:55]
    v_cvt_pk_bf16_f32 v68, v40, v41
    v_add_f32 v12, v12, v38
    v_mfma_f32_16x16x32_bf16 v[48:51], a[88:91], a[192:195], v[48:51]
    v_exp_f32 v42, v42
    v_mfma_f32_16x16x32_bf16 v[52:55], a[92:95], a[192:195], v[52:55]
    s_waitcnt lgkmcnt(0)
    v_exp_f32 v43, v43
    v_mfma_f32_16x16x32_bf16 v[128:131], a[96:99], v[64:67], v[128:131]
    v_add_f32 v12, v12, v39
    v_cvt_pk_bf16_f32 v69, v42, v43
    v_mfma_f32_16x16x32_bf16 v[132:135], a[100:103], v[64:67], v[132:135]
    v_exp_f32 v44, v44
    v_mfma_f32_16x16x32_bf16 v[136:139], a[104:107], v[64:67], v[136:139]
    v_exp_f32 v45, v45
    v_mfma_f32_16x16x32_bf16 v[140:143], a[108:111], v[64:67], v[140:143]
    v_exp_f32 v46, v46
    v_mfma_f32_16x16x32_bf16 v[144:147], a[112:115], v[64:67], v[144:147]
    v_exp_f32 v47, v47
    v_mfma_f32_16x16x32_bf16 v[148:151], a[116:119], v[64:67], v[148:151]
    v_cvt_pk_bf16_f32 v70, v44, v45
    v_cvt_pk_bf16_f32 v71, v46, v47
    v_mfma_f32_16x16x32_bf16 v[152:155], a[120:123], v[64:67], v[152:155]
    v_exp_f32 v48, v48
    v_mfma_f32_16x16x32_bf16 v[156:159], a[124:127], v[64:67], v[156:159]
    v_exp_f32 v49, v49
    v_mfma_f32_16x16x32_bf16 v[56:59], a[64:67], a[196:199], v[92:95]
    s_add_u32 m0, s29, 33024
    ds_read_b128 a[64:67], v4 offset:0
    v_cvt_pk_bf16_f32 v72, v48, v49
    v_mfma_f32_16x16x32_bf16 v[60:63], a[68:71], a[196:199], v[92:95]
    s_mov_b32 s31, 221184
    ds_read_b128 a[68:71], v4 offset:8256
    v_add_f32 v14, v14, v48
    v_mfma_f32_16x16x32_bf16 v[56:59], a[72:75], a[200:203], v[56:59]
    ds_read_b128 a[72:75], v4 offset:256
    v_add_f32 v14, v14, v49
    v_mfma_f32_16x16x32_bf16 v[60:63], a[76:79], a[200:203], v[60:63]
    v_exp_f32 v50, v50
    v_mfma_f32_16x16x32_bf16 v[56:59], a[80:83], a[204:207], v[56:59]
    ds_read_b128 a[76:79], v4 offset:8512
    ds_read_b128 a[80:83], v4 offset:512
    v_mfma_f32_16x16x32_bf16 v[60:63], a[84:87], a[204:207], v[60:63]
    ds_read_b128 a[84:87], v4 offset:8768
    v_add_f32 v14, v14, v50
    v_mfma_f32_16x16x32_bf16 v[56:59], a[88:91], a[208:211], v[56:59]
    v_exp_f32 v51, v51
    v_mfma_f32_16x16x32_bf16 v[60:63], a[92:95], a[208:211], v[60:63]
    ds_read_b128 a[88:91], v4 offset:768
    v_cvt_pk_bf16_f32 v73, v50, v51
    v_mfma_f32_16x16x32_bf16 v[160:163], a[96:99], v[68:71], v[160:163]
    ds_read_b128 a[92:95], v4 offset:9024
    v_add_f32 v14, v14, v51
    v_mfma_f32_16x16x32_bf16 v[164:167], a[100:103], v[68:71], v[164:167]
    v_exp_f32 v52, v52
    v_mfma_f32_16x16x32_bf16 v[168:171], a[104:107], v[68:71], v[168:171]
    v_exp_f32 v53, v53
    v_mfma_f32_16x16x32_bf16 v[172:175], a[108:111], v[68:71], v[172:175]
    v_cvt_pk_bf16_f32 v74, v52, v53
    v_add_f32 v14, v14, v52
    v_mfma_f32_16x16x32_bf16 v[176:179], a[112:115], v[68:71], v[176:179]
    v_exp_f32 v54, v54
    v_mfma_f32_16x16x32_bf16 v[180:183], a[116:119], v[68:71], v[180:183]
    v_exp_f32 v55, v55
    v_mfma_f32_16x16x32_bf16 v[184:187], a[120:123], v[68:71], v[184:187]
    buffer_load_dwordx4 v1, s[16:19], s31 offen nt lds
    v_mfma_f32_16x16x32_bf16 v[188:191], a[124:127], v[68:71], v[188:191]
    v_cvt_pk_bf16_f32 v75, v54, v55
    v_add_f32 v14, v14, v53
    v_mfma_f32_16x16x32_bf16 a[136:139], a[128:131], v[68:71], a[136:139]
    s_waitcnt lgkmcnt(0)
    v_exp_f32 v56, v56
    v_mfma_f32_16x16x32_bf16 v[32:35], a[64:67], a[148:151], v[80:83]
    v_exp_f32 v57, v57
    v_mfma_f32_16x16x32_bf16 v[36:39], a[68:71], a[148:151], v[80:83]
    buffer_load_dwordx4 v1, s[16:19], s31 offen offset:1024 nt lds
    v_mfma_f32_16x16x32_bf16 v[32:35], a[72:75], a[152:155], v[32:35]
    v_cvt_pk_bf16_f32 v76, v56, v57
    v_add_f32 v14, v14, v54
    v_mfma_f32_16x16x32_bf16 v[36:39], a[76:79], a[152:155], v[36:39]
    v_exp_f32 v58, v58
    v_mfma_f32_16x16x32_bf16 v[32:35], a[80:83], a[156:159], v[32:35]
    v_exp_f32 v59, v59
    v_mfma_f32_16x16x32_bf16 v[36:39], a[84:87], a[156:159], v[36:39]
    v_add_f32 v14, v14, v55
    v_cvt_pk_bf16_f32 v77, v58, v59
    v_mfma_f32_16x16x32_bf16 v[32:35], a[88:91], a[160:163], v[32:35]
    v_exp_f32 v60, v60
    v_mfma_f32_16x16x32_bf16 v[36:39], a[92:95], a[160:163], v[36:39]
    v_exp_f32 v61, v61
    v_mfma_f32_16x16x32_bf16 v[192:195], a[96:99], v[72:75], v[192:195]
    v_exp_f32 v62, v62
    v_mfma_f32_16x16x32_bf16 v[196:199], a[100:103], v[72:75], v[196:199]
    v_exp_f32 v63, v63
    v_mfma_f32_16x16x32_bf16 v[200:203], a[104:107], v[72:75], v[200:203]
    v_cvt_pk_bf16_f32 v78, v60, v61
    v_cvt_pk_bf16_f32 v79, v62, v63
    v_mfma_f32_16x16x32_bf16 v[204:207], a[108:111], v[72:75], v[204:207]
    v_mfma_f32_16x16x32_bf16 v[208:211], a[112:115], v[72:75], v[208:211]
    v_exp_f32 v32, v32
    v_mfma_f32_16x16x32_bf16 v[212:215], a[116:119], v[72:75], v[212:215]
    v_exp_f32 v33, v33
    v_mfma_f32_16x16x32_bf16 v[216:219], a[120:123], v[72:75], v[216:219]
    v_cvt_pk_bf16_f32 v64, v32, v33
    v_add_f32 v12, v12, v32
    v_mfma_f32_16x16x32_bf16 v[220:223], a[124:127], v[72:75], v[220:223]
    v_exp_f32 v34, v34
    v_mfma_f32_16x16x32_bf16 v[40:43], a[64:67], a[164:167], v[84:87]
    v_exp_f32 v35, v35
    v_mfma_f32_16x16x32_bf16 v[44:47], a[68:71], a[164:167], v[84:87]
    v_cvt_pk_bf16_f32 v65, v34, v35
    v_add_f32 v12, v12, v33
    v_mfma_f32_16x16x32_bf16 v[40:43], a[72:75], a[168:171], v[40:43]
    s_add_u32 m0, s29, 33024
    v_exp_f32 v36, v36
    v_mfma_f32_16x16x32_bf16 v[44:47], a[76:79], a[168:171], v[44:47]
    s_mov_b32 s32, 210944
    v_exp_f32 v37, v37
    v_mfma_f32_16x16x32_bf16 v[40:43], a[80:83], a[172:175], v[40:43]
    s_mov_b32 s33, 210912
    v_cvt_pk_bf16_f32 v66, v36, v37
    v_add_f32 v12, v12, v34
    v_mfma_f32_16x16x32_bf16 v[44:47], a[84:87], a[172:175], v[44:47]
    v_exp_f32 v38, v38
    v_mfma_f32_16x16x32_bf16 v[40:43], a[88:91], a[176:179], v[40:43]
    v_exp_f32 v39, v39
    v_mfma_f32_16x16x32_bf16 v[44:47], a[92:95], a[176:179], v[44:47]
    v_cvt_pk_bf16_f32 v67, v38, v39
    v_add_f32 v12, v12, v35
    v_mfma_f32_16x16x32_bf16 v[224:227], a[96:99], v[76:79], v[224:227]
    ds_read_b64_tr_b16 a[96:97], v6 offset:16512
    ds_read_b64_tr_b16 a[98:99], v6 offset:24768
    v_mfma_f32_16x16x32_bf16 v[228:231], a[100:103], v[76:79], v[228:231]
    ds_read_b64_tr_b16 a[100:101], v6 offset:16544
    ds_read_b64_tr_b16 a[102:103], v6 offset:24800
    v_mfma_f32_16x16x32_bf16 v[232:235], a[104:107], v[76:79], v[232:235]
    ds_read_b64_tr_b16 a[104:105], v6 offset:16768
    ds_read_b64_tr_b16 a[106:107], v6 offset:25024
    v_mfma_f32_16x16x32_bf16 v[236:239], a[108:111], v[76:79], v[236:239]
    ds_read_b64_tr_b16 a[108:109], v6 offset:16800
    ds_read_b64_tr_b16 a[110:111], v6 offset:25056
    v_mfma_f32_16x16x32_bf16 v[240:243], a[112:115], v[76:79], v[240:243]
    ds_read_b64_tr_b16 a[112:113], v6 offset:17024
    ds_read_b64_tr_b16 a[114:115], v6 offset:25280
    v_mfma_f32_16x16x32_bf16 v[244:247], a[116:119], v[76:79], v[244:247]
    ds_read_b64_tr_b16 a[116:117], v6 offset:17056
    ds_read_b64_tr_b16 a[118:119], v6 offset:25312
    v_mfma_f32_16x16x32_bf16 v[248:251], a[120:123], v[76:79], v[248:251]
    ds_read_b64_tr_b16 a[120:121], v6 offset:17280
    ds_read_b64_tr_b16 a[122:123], v6 offset:25536
    v_mfma_f32_16x16x32_bf16 v[252:255], a[124:127], v[76:79], v[252:255]
    ds_read_b64_tr_b16 a[124:125], v6 offset:17312
    ds_read_b64_tr_b16 a[126:127], v6 offset:25568
    v_mfma_f32_16x16x32_bf16 a[144:147], a[128:131], v[76:79], a[144:147]
    buffer_load_dwordx4 v1, s[20:23], s32 offen offset:2048 nt lds
    v_mfma_f32_16x16x32_bf16 v[48:51], a[64:67], a[180:183], v[88:91]
    v_exp_f32 v40, v40
    v_mfma_f32_16x16x32_bf16 v[52:55], a[68:71], a[180:183], v[88:91]
    v_exp_f32 v41, v41
    v_mfma_f32_16x16x32_bf16 v[48:51], a[72:75], a[184:187], v[48:51]
    v_add_f32 v12, v12, v36
    v_add_f32 v12, v12, v37
    v_mfma_f32_16x16x32_bf16 v[52:55], a[76:79], a[184:187], v[52:55]
    buffer_load_dwordx4 v1, s[20:23], s33 offen offset:3104 nt lds
    v_mfma_f32_16x16x32_bf16 v[48:51], a[80:83], a[188:191], v[48:51]
    v_cvt_pk_bf16_f32 v68, v40, v41
    v_add_f32 v12, v12, v38
    v_mfma_f32_16x16x32_bf16 v[52:55], a[84:87], a[188:191], v[52:55]
    v_exp_f32 v42, v42
    v_mfma_f32_16x16x32_bf16 v[48:51], a[88:91], a[192:195], v[48:51]
    v_exp_f32 v43, v43
    v_mfma_f32_16x16x32_bf16 v[52:55], a[92:95], a[192:195], v[52:55]
    s_waitcnt lgkmcnt(0)
    v_add_f32 v12, v12, v39
    v_cvt_pk_bf16_f32 v69, v42, v43
    v_mfma_f32_16x16x32_bf16 v[128:131], a[96:99], v[64:67], v[128:131]
    v_exp_f32 v44, v44
    v_mfma_f32_16x16x32_bf16 v[132:135], a[100:103], v[64:67], v[132:135]
    v_exp_f32 v45, v45
    v_mfma_f32_16x16x32_bf16 v[136:139], a[104:107], v[64:67], v[136:139]
    v_exp_f32 v46, v46
    v_mfma_f32_16x16x32_bf16 v[140:143], a[108:111], v[64:67], v[140:143]
    v_exp_f32 v47, v47
    v_mfma_f32_16x16x32_bf16 v[144:147], a[112:115], v[64:67], v[144:147]
    v_cvt_pk_bf16_f32 v70, v44, v45
    v_cvt_pk_bf16_f32 v71, v46, v47
    v_mfma_f32_16x16x32_bf16 v[148:151], a[116:119], v[64:67], v[148:151]
    v_exp_f32 v48, v48
    v_mfma_f32_16x16x32_bf16 v[152:155], a[120:123], v[64:67], v[152:155]
    v_exp_f32 v49, v49
    v_mfma_f32_16x16x32_bf16 v[156:159], a[124:127], v[64:67], v[156:159]
    v_cvt_pk_bf16_f32 v72, v48, v49
    v_add_f32 v14, v14, v48
    v_mfma_f32_16x16x32_bf16 v[56:59], a[64:67], a[196:199], v[92:95]
    ds_read_b128 a[64:67], v4 offset:16512
    v_add_f32 v14, v14, v49
    v_mfma_f32_16x16x32_bf16 v[60:63], a[68:71], a[196:199], v[92:95]
    v_exp_f32 v50, v50
    v_mfma_f32_16x16x32_bf16 v[56:59], a[72:75], a[200:203], v[56:59]
    ds_read_b128 a[68:71], v4 offset:24768
    ds_read_b128 a[72:75], v4 offset:16768
    v_mfma_f32_16x16x32_bf16 v[60:63], a[76:79], a[200:203], v[60:63]
    ds_read_b128 a[76:79], v4 offset:25024
    v_add_f32 v14, v14, v50
    v_mfma_f32_16x16x32_bf16 v[56:59], a[80:83], a[204:207], v[56:59]
    v_exp_f32 v51, v51
    v_mfma_f32_16x16x32_bf16 v[60:63], a[84:87], a[204:207], v[60:63]
    ds_read_b128 a[80:83], v4 offset:17024
    ds_read_b128 a[84:87], v4 offset:25280
    v_mfma_f32_16x16x32_bf16 v[56:59], a[88:91], a[208:211], v[56:59]
    ds_read_b128 a[88:91], v4 offset:17280
    v_cvt_pk_bf16_f32 v73, v50, v51
    v_mfma_f32_16x16x32_bf16 v[60:63], a[92:95], a[208:211], v[60:63]
    ds_read_b128 a[92:95], v4 offset:25536
    v_add_f32 v14, v14, v51
    v_mfma_f32_16x16x32_bf16 v[160:163], a[96:99], v[68:71], v[160:163]
    v_exp_f32 v52, v52
    v_mfma_f32_16x16x32_bf16 v[164:167], a[100:103], v[68:71], v[164:167]
    v_exp_f32 v53, v53
    v_mfma_f32_16x16x32_bf16 v[168:171], a[104:107], v[68:71], v[168:171]
    v_cvt_pk_bf16_f32 v74, v52, v53
    v_add_f32 v14, v14, v52
    v_mfma_f32_16x16x32_bf16 v[172:175], a[108:111], v[68:71], v[172:175]
    v_exp_f32 v54, v54
    v_mfma_f32_16x16x32_bf16 v[176:179], a[112:115], v[68:71], v[176:179]
    v_exp_f32 v55, v55
    v_mfma_f32_16x16x32_bf16 v[180:183], a[116:119], v[68:71], v[180:183]
    v_cvt_pk_bf16_f32 v75, v54, v55
    v_add_f32 v14, v14, v53
    v_mfma_f32_16x16x32_bf16 v[184:187], a[120:123], v[68:71], v[184:187]
    v_exp_f32 v56, v56
    v_mfma_f32_16x16x32_bf16 v[188:191], a[124:127], v[68:71], v[188:191]
    v_exp_f32 v57, v57
    v_mfma_f32_16x16x32_bf16 a[136:139], a[128:131], v[68:71], a[136:139]
    s_waitcnt lgkmcnt(0)
    v_cvt_pk_bf16_f32 v76, v56, v57
    v_add_f32 v14, v14, v54
    v_mfma_f32_16x16x32_bf16 v[32:35], a[64:67], a[148:151], v[80:83]
    v_exp_f32 v58, v58
    v_mfma_f32_16x16x32_bf16 v[36:39], a[68:71], a[148:151], v[80:83]
    v_exp_f32 v59, v59
    v_mfma_f32_16x16x32_bf16 v[32:35], a[72:75], a[152:155], v[32:35]
    v_add_f32 v14, v14, v55
    v_cvt_pk_bf16_f32 v77, v58, v59
    v_mfma_f32_16x16x32_bf16 v[36:39], a[76:79], a[152:155], v[36:39]
    v_exp_f32 v60, v60
    v_mfma_f32_16x16x32_bf16 v[32:35], a[80:83], a[156:159], v[32:35]
    v_exp_f32 v61, v61
    v_mfma_f32_16x16x32_bf16 v[36:39], a[84:87], a[156:159], v[36:39]
    v_exp_f32 v62, v62
    v_mfma_f32_16x16x32_bf16 v[32:35], a[88:91], a[160:163], v[32:35]
    v_exp_f32 v63, v63
    v_mfma_f32_16x16x32_bf16 v[36:39], a[92:95], a[160:163], v[36:39]
    v_cvt_pk_bf16_f32 v78, v60, v61
    v_cvt_pk_bf16_f32 v79, v62, v63
    v_mfma_f32_16x16x32_bf16 v[192:195], a[96:99], v[72:75], v[192:195]
    v_mfma_f32_16x16x32_bf16 v[196:199], a[100:103], v[72:75], v[196:199]
    v_mfma_f32_16x16x32_bf16 v[200:203], a[104:107], v[72:75], v[200:203]
    v_mfma_f32_16x16x32_bf16 v[204:207], a[108:111], v[72:75], v[204:207]
    v_mfma_f32_16x16x32_bf16 v[208:211], a[112:115], v[72:75], v[208:211]
    v_exp_f32 v32, v32
    v_mfma_f32_16x16x32_bf16 v[212:215], a[116:119], v[72:75], v[212:215]
    v_exp_f32 v33, v33
    v_mfma_f32_16x16x32_bf16 v[216:219], a[120:123], v[72:75], v[216:219]
    v_cvt_pk_bf16_f32 v64, v32, v33
    v_add_f32 v12, v12, v32
    v_mfma_f32_16x16x32_bf16 v[220:223], a[124:127], v[72:75], v[220:223]
    v_exp_f32 v34, v34
    v_mfma_f32_16x16x32_bf16 v[40:43], a[64:67], a[164:167], v[84:87]
    s_waitcnt vmcnt(12) lgkmcnt(0)
    s_barrier
    v_mfma_f32_16x16x32_bf16 v[44:47], a[68:71], a[164:167], v[84:87]
    v_exp_f32 v35, v35
    v_mfma_f32_16x16x32_bf16 v[40:43], a[72:75], a[168:171], v[40:43]
    s_add_u32 m0, s29, 49536
    v_cvt_pk_bf16_f32 v65, v34, v35
    v_add_f32 v12, v12, v33
    v_mfma_f32_16x16x32_bf16 v[44:47], a[76:79], a[168:171], v[44:47]
    s_mov_b32 s31, 229376
    v_exp_f32 v36, v36
    v_mfma_f32_16x16x32_bf16 v[40:43], a[80:83], a[172:175], v[40:43]
    v_exp_f32 v37, v37
    v_mfma_f32_16x16x32_bf16 v[44:47], a[84:87], a[172:175], v[44:47]
    v_cvt_pk_bf16_f32 v66, v36, v37
    v_add_f32 v12, v12, v34
    v_mfma_f32_16x16x32_bf16 v[40:43], a[88:91], a[176:179], v[40:43]
    v_exp_f32 v38, v38
    v_mfma_f32_16x16x32_bf16 v[44:47], a[92:95], a[176:179], v[44:47]
    v_exp_f32 v39, v39
    v_mfma_f32_16x16x32_bf16 v[224:227], a[96:99], v[76:79], v[224:227]
    ds_read_b64_tr_b16 a[96:97], v6 offset:33024
    ds_read_b64_tr_b16 a[98:99], v6 offset:41280
    v_mfma_f32_16x16x32_bf16 v[228:231], a[100:103], v[76:79], v[228:231]
    ds_read_b64_tr_b16 a[100:101], v6 offset:33056
    ds_read_b64_tr_b16 a[102:103], v6 offset:41312
    v_mfma_f32_16x16x32_bf16 v[232:235], a[104:107], v[76:79], v[232:235]
    ds_read_b64_tr_b16 a[104:105], v6 offset:33280
    ds_read_b64_tr_b16 a[106:107], v6 offset:41536
    v_mfma_f32_16x16x32_bf16 v[236:239], a[108:111], v[76:79], v[236:239]
    ds_read_b64_tr_b16 a[108:109], v6 offset:33312
    ds_read_b64_tr_b16 a[110:111], v6 offset:41568
    v_mfma_f32_16x16x32_bf16 v[240:243], a[112:115], v[76:79], v[240:243]
    ds_read_b64_tr_b16 a[112:113], v6 offset:33536
    ds_read_b64_tr_b16 a[114:115], v6 offset:41792
    v_mfma_f32_16x16x32_bf16 v[244:247], a[116:119], v[76:79], v[244:247]
    ds_read_b64_tr_b16 a[116:117], v6 offset:33568
    v_cvt_pk_bf16_f32 v67, v38, v39
    v_mfma_f32_16x16x32_bf16 v[248:251], a[120:123], v[76:79], v[248:251]
    ds_read_b64_tr_b16 a[118:119], v6 offset:41824
    v_add_f32 v12, v12, v35
    v_mfma_f32_16x16x32_bf16 v[252:255], a[124:127], v[76:79], v[252:255]
    ds_read_b64_tr_b16 a[120:121], v6 offset:33792
    ds_read_b64_tr_b16 a[122:123], v6 offset:42048
    v_mfma_f32_16x16x32_bf16 a[144:147], a[128:131], v[76:79], a[144:147]
    buffer_load_dwordx4 v1, s[16:19], s31 offen nt lds
    v_mfma_f32_16x16x32_bf16 v[48:51], a[64:67], a[180:183], v[88:91]
    ds_read_b64_tr_b16 a[124:125], v6 offset:33824
    ds_read_b64_tr_b16 a[126:127], v6 offset:42080
    v_mfma_f32_16x16x32_bf16 v[52:55], a[68:71], a[180:183], v[88:91]
    v_exp_f32 v40, v40
    v_mfma_f32_16x16x32_bf16 v[48:51], a[72:75], a[184:187], v[48:51]
    v_exp_f32 v41, v41
    v_mfma_f32_16x16x32_bf16 v[52:55], a[76:79], a[184:187], v[52:55]
    buffer_load_dwordx4 v1, s[16:19], s31 offen offset:1024 nt lds
    v_mfma_f32_16x16x32_bf16 v[48:51], a[80:83], a[188:191], v[48:51]
    v_add_f32 v12, v12, v36
    v_add_f32 v12, v12, v37
    v_mfma_f32_16x16x32_bf16 v[52:55], a[84:87], a[188:191], v[52:55]
    v_cvt_pk_bf16_f32 v68, v40, v41
    v_add_f32 v12, v12, v38
    v_mfma_f32_16x16x32_bf16 v[48:51], a[88:91], a[192:195], v[48:51]
    v_exp_f32 v42, v42
    v_mfma_f32_16x16x32_bf16 v[52:55], a[92:95], a[192:195], v[52:55]
    s_waitcnt lgkmcnt(0)
    v_exp_f32 v43, v43
    v_mfma_f32_16x16x32_bf16 v[128:131], a[96:99], v[64:67], v[128:131]
    v_add_f32 v12, v12, v39
    v_cvt_pk_bf16_f32 v69, v42, v43
    v_mfma_f32_16x16x32_bf16 v[132:135], a[100:103], v[64:67], v[132:135]
    v_exp_f32 v44, v44
    v_mfma_f32_16x16x32_bf16 v[136:139], a[104:107], v[64:67], v[136:139]
    v_exp_f32 v45, v45
    v_mfma_f32_16x16x32_bf16 v[140:143], a[108:111], v[64:67], v[140:143]
    v_exp_f32 v46, v46
    v_mfma_f32_16x16x32_bf16 v[144:147], a[112:115], v[64:67], v[144:147]
    v_exp_f32 v47, v47
    v_mfma_f32_16x16x32_bf16 v[148:151], a[116:119], v[64:67], v[148:151]
    v_cvt_pk_bf16_f32 v70, v44, v45
    v_cvt_pk_bf16_f32 v71, v46, v47
    v_mfma_f32_16x16x32_bf16 v[152:155], a[120:123], v[64:67], v[152:155]
    v_exp_f32 v48, v48
    v_mfma_f32_16x16x32_bf16 v[156:159], a[124:127], v[64:67], v[156:159]
    v_exp_f32 v49, v49
    v_mfma_f32_16x16x32_bf16 v[56:59], a[64:67], a[196:199], v[92:95]
    s_add_u32 m0, s29, 49536
    ds_read_b128 a[64:67], v4 offset:33024
    v_cvt_pk_bf16_f32 v72, v48, v49
    v_mfma_f32_16x16x32_bf16 v[60:63], a[68:71], a[196:199], v[92:95]
    s_mov_b32 s32, 219136
    ds_read_b128 a[68:71], v4 offset:41280
    v_add_f32 v14, v14, v48
    v_mfma_f32_16x16x32_bf16 v[56:59], a[72:75], a[200:203], v[56:59]
    s_mov_b32 s33, 219104
    ds_read_b128 a[72:75], v4 offset:33280
    v_add_f32 v14, v14, v49
    v_mfma_f32_16x16x32_bf16 v[60:63], a[76:79], a[200:203], v[60:63]
    v_exp_f32 v50, v50
    v_mfma_f32_16x16x32_bf16 v[56:59], a[80:83], a[204:207], v[56:59]
    ds_read_b128 a[76:79], v4 offset:41536
    ds_read_b128 a[80:83], v4 offset:33536
    v_mfma_f32_16x16x32_bf16 v[60:63], a[84:87], a[204:207], v[60:63]
    ds_read_b128 a[84:87], v4 offset:41792
    v_add_f32 v14, v14, v50
    v_mfma_f32_16x16x32_bf16 v[56:59], a[88:91], a[208:211], v[56:59]
    v_exp_f32 v51, v51
    v_mfma_f32_16x16x32_bf16 v[60:63], a[92:95], a[208:211], v[60:63]
    ds_read_b128 a[88:91], v4 offset:33792
    v_cvt_pk_bf16_f32 v73, v50, v51
    v_mfma_f32_16x16x32_bf16 v[160:163], a[96:99], v[68:71], v[160:163]
    ds_read_b128 a[92:95], v4 offset:42048
    v_add_f32 v14, v14, v51
    v_mfma_f32_16x16x32_bf16 v[164:167], a[100:103], v[68:71], v[164:167]
    v_exp_f32 v52, v52
    v_mfma_f32_16x16x32_bf16 v[168:171], a[104:107], v[68:71], v[168:171]
    v_exp_f32 v53, v53
    v_mfma_f32_16x16x32_bf16 v[172:175], a[108:111], v[68:71], v[172:175]
    v_cvt_pk_bf16_f32 v74, v52, v53
    v_add_f32 v14, v14, v52
    v_mfma_f32_16x16x32_bf16 v[176:179], a[112:115], v[68:71], v[176:179]
    v_exp_f32 v54, v54
    v_mfma_f32_16x16x32_bf16 v[180:183], a[116:119], v[68:71], v[180:183]
    v_exp_f32 v55, v55
    v_mfma_f32_16x16x32_bf16 v[184:187], a[120:123], v[68:71], v[184:187]
    buffer_load_dwordx4 v1, s[20:23], s32 offen offset:2048 nt lds
    v_mfma_f32_16x16x32_bf16 v[188:191], a[124:127], v[68:71], v[188:191]
    v_cvt_pk_bf16_f32 v75, v54, v55
    v_add_f32 v14, v14, v53
    v_mfma_f32_16x16x32_bf16 a[136:139], a[128:131], v[68:71], a[136:139]
    s_waitcnt lgkmcnt(0)
    v_exp_f32 v56, v56
    v_mfma_f32_16x16x32_bf16 v[32:35], a[64:67], a[148:151], v[80:83]
    v_exp_f32 v57, v57
    v_mfma_f32_16x16x32_bf16 v[36:39], a[68:71], a[148:151], v[80:83]
    buffer_load_dwordx4 v1, s[20:23], s33 offen offset:3104 nt lds
    v_mfma_f32_16x16x32_bf16 v[32:35], a[72:75], a[152:155], v[32:35]
    v_cvt_pk_bf16_f32 v76, v56, v57
    v_add_f32 v14, v14, v54
    v_mfma_f32_16x16x32_bf16 v[36:39], a[76:79], a[152:155], v[36:39]
    v_exp_f32 v58, v58
    v_mfma_f32_16x16x32_bf16 v[32:35], a[80:83], a[156:159], v[32:35]
    v_exp_f32 v59, v59
    v_mfma_f32_16x16x32_bf16 v[36:39], a[84:87], a[156:159], v[36:39]
    v_add_f32 v14, v14, v55
    v_cvt_pk_bf16_f32 v77, v58, v59
    v_mfma_f32_16x16x32_bf16 v[32:35], a[88:91], a[160:163], v[32:35]
    v_exp_f32 v60, v60
    v_mfma_f32_16x16x32_bf16 v[36:39], a[92:95], a[160:163], v[36:39]
    v_exp_f32 v61, v61
    v_mfma_f32_16x16x32_bf16 v[192:195], a[96:99], v[72:75], v[192:195]
    v_exp_f32 v62, v62
    v_mfma_f32_16x16x32_bf16 v[196:199], a[100:103], v[72:75], v[196:199]
    v_exp_f32 v63, v63
    v_mfma_f32_16x16x32_bf16 v[200:203], a[104:107], v[72:75], v[200:203]
    v_cvt_pk_bf16_f32 v78, v60, v61
    v_cvt_pk_bf16_f32 v79, v62, v63
    v_mfma_f32_16x16x32_bf16 v[204:207], a[108:111], v[72:75], v[204:207]
    v_mfma_f32_16x16x32_bf16 v[208:211], a[112:115], v[72:75], v[208:211]
    v_exp_f32 v32, v32
    v_mfma_f32_16x16x32_bf16 v[212:215], a[116:119], v[72:75], v[212:215]
    v_exp_f32 v33, v33
    v_mfma_f32_16x16x32_bf16 v[216:219], a[120:123], v[72:75], v[216:219]
    v_cvt_pk_bf16_f32 v64, v32, v33
    v_add_f32 v12, v12, v32
    v_mfma_f32_16x16x32_bf16 v[220:223], a[124:127], v[72:75], v[220:223]
    v_exp_f32 v34, v34
    v_mfma_f32_16x16x32_bf16 v[40:43], a[64:67], a[164:167], v[84:87]
    v_exp_f32 v35, v35
    v_mfma_f32_16x16x32_bf16 v[44:47], a[68:71], a[164:167], v[84:87]
    v_cvt_pk_bf16_f32 v65, v34, v35
    v_add_f32 v12, v12, v33
    v_mfma_f32_16x16x32_bf16 v[40:43], a[72:75], a[168:171], v[40:43]
    s_add_u32 m0, s29, 66048
    v_exp_f32 v36, v36
    v_mfma_f32_16x16x32_bf16 v[44:47], a[76:79], a[168:171], v[44:47]
    s_mov_b32 s31, 237568
    v_exp_f32 v37, v37
    v_mfma_f32_16x16x32_bf16 v[40:43], a[80:83], a[172:175], v[40:43]
    v_cvt_pk_bf16_f32 v66, v36, v37
    v_add_f32 v12, v12, v34
    v_mfma_f32_16x16x32_bf16 v[44:47], a[84:87], a[172:175], v[44:47]
    v_exp_f32 v38, v38
    v_mfma_f32_16x16x32_bf16 v[40:43], a[88:91], a[176:179], v[40:43]
    v_exp_f32 v39, v39
    v_mfma_f32_16x16x32_bf16 v[44:47], a[92:95], a[176:179], v[44:47]
    v_cvt_pk_bf16_f32 v67, v38, v39
    v_add_f32 v12, v12, v35
    v_mfma_f32_16x16x32_bf16 v[224:227], a[96:99], v[76:79], v[224:227]
    ds_read_b64_tr_b16 a[96:97], v6 offset:49536
    ds_read_b64_tr_b16 a[98:99], v6 offset:57792
    v_mfma_f32_16x16x32_bf16 v[228:231], a[100:103], v[76:79], v[228:231]
    ds_read_b64_tr_b16 a[100:101], v6 offset:49568
    ds_read_b64_tr_b16 a[102:103], v6 offset:57824
    v_mfma_f32_16x16x32_bf16 v[232:235], a[104:107], v[76:79], v[232:235]
    ds_read_b64_tr_b16 a[104:105], v6 offset:49792
    ds_read_b64_tr_b16 a[106:107], v6 offset:58048
    v_mfma_f32_16x16x32_bf16 v[236:239], a[108:111], v[76:79], v[236:239]
    ds_read_b64_tr_b16 a[108:109], v6 offset:49824
    ds_read_b64_tr_b16 a[110:111], v6 offset:58080
    v_mfma_f32_16x16x32_bf16 v[240:243], a[112:115], v[76:79], v[240:243]
    ds_read_b64_tr_b16 a[112:113], v6 offset:50048
    ds_read_b64_tr_b16 a[114:115], v6 offset:58304
    v_mfma_f32_16x16x32_bf16 v[244:247], a[116:119], v[76:79], v[244:247]
    ds_read_b64_tr_b16 a[116:117], v6 offset:50080
    ds_read_b64_tr_b16 a[118:119], v6 offset:58336
    v_mfma_f32_16x16x32_bf16 v[248:251], a[120:123], v[76:79], v[248:251]
    ds_read_b64_tr_b16 a[120:121], v6 offset:50304
    ds_read_b64_tr_b16 a[122:123], v6 offset:58560
    v_mfma_f32_16x16x32_bf16 v[252:255], a[124:127], v[76:79], v[252:255]
    ds_read_b64_tr_b16 a[124:125], v6 offset:50336
    ds_read_b64_tr_b16 a[126:127], v6 offset:58592
    v_mfma_f32_16x16x32_bf16 a[144:147], a[128:131], v[76:79], a[144:147]
    buffer_load_dwordx4 v1, s[16:19], s31 offen nt lds
    v_mfma_f32_16x16x32_bf16 v[48:51], a[64:67], a[180:183], v[88:91]
    v_exp_f32 v40, v40
    v_mfma_f32_16x16x32_bf16 v[52:55], a[68:71], a[180:183], v[88:91]
    v_exp_f32 v41, v41
    v_mfma_f32_16x16x32_bf16 v[48:51], a[72:75], a[184:187], v[48:51]
    v_add_f32 v12, v12, v36
    v_add_f32 v12, v12, v37
    v_mfma_f32_16x16x32_bf16 v[52:55], a[76:79], a[184:187], v[52:55]
    buffer_load_dwordx4 v1, s[16:19], s31 offen offset:1024 nt lds
    v_mfma_f32_16x16x32_bf16 v[48:51], a[80:83], a[188:191], v[48:51]
    v_cvt_pk_bf16_f32 v68, v40, v41
    v_add_f32 v12, v12, v38
    v_mfma_f32_16x16x32_bf16 v[52:55], a[84:87], a[188:191], v[52:55]
    v_exp_f32 v42, v42
    v_mfma_f32_16x16x32_bf16 v[48:51], a[88:91], a[192:195], v[48:51]
    v_exp_f32 v43, v43
    v_mfma_f32_16x16x32_bf16 v[52:55], a[92:95], a[192:195], v[52:55]
    s_waitcnt lgkmcnt(0)
    v_add_f32 v12, v12, v39
    v_cvt_pk_bf16_f32 v69, v42, v43
    v_mfma_f32_16x16x32_bf16 v[128:131], a[96:99], v[64:67], v[128:131]
    v_exp_f32 v44, v44
    v_mfma_f32_16x16x32_bf16 v[132:135], a[100:103], v[64:67], v[132:135]
    v_exp_f32 v45, v45
    v_mfma_f32_16x16x32_bf16 v[136:139], a[104:107], v[64:67], v[136:139]
    v_exp_f32 v46, v46
    v_mfma_f32_16x16x32_bf16 v[140:143], a[108:111], v[64:67], v[140:143]
    v_exp_f32 v47, v47
    v_mfma_f32_16x16x32_bf16 v[144:147], a[112:115], v[64:67], v[144:147]
    v_cvt_pk_bf16_f32 v70, v44, v45
    v_cvt_pk_bf16_f32 v71, v46, v47
    v_mfma_f32_16x16x32_bf16 v[148:151], a[116:119], v[64:67], v[148:151]
    v_exp_f32 v48, v48
    v_mfma_f32_16x16x32_bf16 v[152:155], a[120:123], v[64:67], v[152:155]
    v_exp_f32 v49, v49
    v_mfma_f32_16x16x32_bf16 v[156:159], a[124:127], v[64:67], v[156:159]
    v_cvt_pk_bf16_f32 v72, v48, v49
    v_add_f32 v14, v14, v48
    v_mfma_f32_16x16x32_bf16 v[56:59], a[64:67], a[196:199], v[92:95]
    ds_read_b128 a[64:67], v4 offset:49536
    v_add_f32 v14, v14, v49
    v_mfma_f32_16x16x32_bf16 v[60:63], a[68:71], a[196:199], v[92:95]
    v_exp_f32 v50, v50
    v_mfma_f32_16x16x32_bf16 v[56:59], a[72:75], a[200:203], v[56:59]
    ds_read_b128 a[68:71], v4 offset:57792
    ds_read_b128 a[72:75], v4 offset:49792
    v_mfma_f32_16x16x32_bf16 v[60:63], a[76:79], a[200:203], v[60:63]
    ds_read_b128 a[76:79], v4 offset:58048
    v_add_f32 v14, v14, v50
    v_mfma_f32_16x16x32_bf16 v[56:59], a[80:83], a[204:207], v[56:59]
    v_exp_f32 v51, v51
    v_mfma_f32_16x16x32_bf16 v[60:63], a[84:87], a[204:207], v[60:63]
    ds_read_b128 a[80:83], v4 offset:50048
    ds_read_b128 a[84:87], v4 offset:58304
    v_mfma_f32_16x16x32_bf16 v[56:59], a[88:91], a[208:211], v[56:59]
    ds_read_b128 a[88:91], v4 offset:50304
    v_cvt_pk_bf16_f32 v73, v50, v51
    v_mfma_f32_16x16x32_bf16 v[60:63], a[92:95], a[208:211], v[60:63]
    ds_read_b128 a[92:95], v4 offset:58560
    v_add_f32 v14, v14, v51
    v_mfma_f32_16x16x32_bf16 v[160:163], a[96:99], v[68:71], v[160:163]
    v_exp_f32 v52, v52
    v_mfma_f32_16x16x32_bf16 v[164:167], a[100:103], v[68:71], v[164:167]
    v_exp_f32 v53, v53
    v_mfma_f32_16x16x32_bf16 v[168:171], a[104:107], v[68:71], v[168:171]
    v_cvt_pk_bf16_f32 v74, v52, v53
    v_add_f32 v14, v14, v52
    v_mfma_f32_16x16x32_bf16 v[172:175], a[108:111], v[68:71], v[172:175]
    v_exp_f32 v54, v54
    v_mfma_f32_16x16x32_bf16 v[176:179], a[112:115], v[68:71], v[176:179]
    v_exp_f32 v55, v55
    v_mfma_f32_16x16x32_bf16 v[180:183], a[116:119], v[68:71], v[180:183]
    v_cvt_pk_bf16_f32 v75, v54, v55
    v_add_f32 v14, v14, v53
    v_mfma_f32_16x16x32_bf16 v[184:187], a[120:123], v[68:71], v[184:187]
    v_exp_f32 v56, v56
    v_mfma_f32_16x16x32_bf16 v[188:191], a[124:127], v[68:71], v[188:191]
    v_exp_f32 v57, v57
    v_mfma_f32_16x16x32_bf16 a[136:139], a[128:131], v[68:71], a[136:139]
    s_waitcnt lgkmcnt(0)
    v_cvt_pk_bf16_f32 v76, v56, v57
    v_add_f32 v14, v14, v54
    v_mfma_f32_16x16x32_bf16 v[32:35], a[64:67], a[148:151], v[80:83]
    v_exp_f32 v58, v58
    v_mfma_f32_16x16x32_bf16 v[36:39], a[68:71], a[148:151], v[80:83]
    v_exp_f32 v59, v59
    v_mfma_f32_16x16x32_bf16 v[32:35], a[72:75], a[152:155], v[32:35]
    v_add_f32 v14, v14, v55
    v_cvt_pk_bf16_f32 v77, v58, v59
    v_mfma_f32_16x16x32_bf16 v[36:39], a[76:79], a[152:155], v[36:39]
    v_exp_f32 v60, v60
    v_mfma_f32_16x16x32_bf16 v[32:35], a[80:83], a[156:159], v[32:35]
    v_exp_f32 v61, v61
    v_mfma_f32_16x16x32_bf16 v[36:39], a[84:87], a[156:159], v[36:39]
    v_exp_f32 v62, v62
    v_mfma_f32_16x16x32_bf16 v[32:35], a[88:91], a[160:163], v[32:35]
    v_exp_f32 v63, v63
    v_mfma_f32_16x16x32_bf16 v[36:39], a[92:95], a[160:163], v[36:39]
    v_cvt_pk_bf16_f32 v78, v60, v61
    v_cvt_pk_bf16_f32 v79, v62, v63
    v_mfma_f32_16x16x32_bf16 v[192:195], a[96:99], v[72:75], v[192:195]
    v_mfma_f32_16x16x32_bf16 v[196:199], a[100:103], v[72:75], v[196:199]
    v_mfma_f32_16x16x32_bf16 v[200:203], a[104:107], v[72:75], v[200:203]
    v_mfma_f32_16x16x32_bf16 v[204:207], a[108:111], v[72:75], v[204:207]
    v_mfma_f32_16x16x32_bf16 v[208:211], a[112:115], v[72:75], v[208:211]
    v_exp_f32 v32, v32
    v_mfma_f32_16x16x32_bf16 v[212:215], a[116:119], v[72:75], v[212:215]
    v_exp_f32 v33, v33
    v_mfma_f32_16x16x32_bf16 v[216:219], a[120:123], v[72:75], v[216:219]
    v_cvt_pk_bf16_f32 v64, v32, v33
    v_add_f32 v12, v12, v32
    v_mfma_f32_16x16x32_bf16 v[220:223], a[124:127], v[72:75], v[220:223]
    v_exp_f32 v34, v34
    v_mfma_f32_16x16x32_bf16 v[40:43], a[64:67], a[164:167], v[84:87]
    s_waitcnt vmcnt(10) lgkmcnt(0)
    s_barrier
    v_mfma_f32_16x16x32_bf16 v[44:47], a[68:71], a[164:167], v[84:87]
    v_exp_f32 v35, v35
    v_mfma_f32_16x16x32_bf16 v[40:43], a[72:75], a[168:171], v[40:43]
    s_add_u32 m0, s29, 66048
    v_cvt_pk_bf16_f32 v65, v34, v35
    v_add_f32 v12, v12, v33
    v_mfma_f32_16x16x32_bf16 v[44:47], a[76:79], a[168:171], v[44:47]
    s_mov_b32 s32, 227328
    v_exp_f32 v36, v36
    v_mfma_f32_16x16x32_bf16 v[40:43], a[80:83], a[172:175], v[40:43]
    s_mov_b32 s33, 227296
    v_exp_f32 v37, v37
    v_mfma_f32_16x16x32_bf16 v[44:47], a[84:87], a[172:175], v[44:47]
    v_cvt_pk_bf16_f32 v66, v36, v37
    v_add_f32 v12, v12, v34
    v_mfma_f32_16x16x32_bf16 v[40:43], a[88:91], a[176:179], v[40:43]
    v_exp_f32 v38, v38
    v_mfma_f32_16x16x32_bf16 v[44:47], a[92:95], a[176:179], v[44:47]
    v_exp_f32 v39, v39
    v_mfma_f32_16x16x32_bf16 v[224:227], a[96:99], v[76:79], v[224:227]
    ds_read_b64_tr_b16 a[96:97], v5 offset:0
    ds_read_b64_tr_b16 a[98:99], v5 offset:8256
    v_mfma_f32_16x16x32_bf16 v[228:231], a[100:103], v[76:79], v[228:231]
    ds_read_b64_tr_b16 a[100:101], v5 offset:32
    ds_read_b64_tr_b16 a[102:103], v5 offset:8288
    v_mfma_f32_16x16x32_bf16 v[232:235], a[104:107], v[76:79], v[232:235]
    ds_read_b64_tr_b16 a[104:105], v5 offset:256
    ds_read_b64_tr_b16 a[106:107], v5 offset:8512
    v_mfma_f32_16x16x32_bf16 v[236:239], a[108:111], v[76:79], v[236:239]
    ds_read_b64_tr_b16 a[108:109], v5 offset:288
    ds_read_b64_tr_b16 a[110:111], v5 offset:8544
    v_mfma_f32_16x16x32_bf16 v[240:243], a[112:115], v[76:79], v[240:243]
    ds_read_b64_tr_b16 a[112:113], v5 offset:512
    ds_read_b64_tr_b16 a[114:115], v5 offset:8768
    v_mfma_f32_16x16x32_bf16 v[244:247], a[116:119], v[76:79], v[244:247]
    ds_read_b64_tr_b16 a[116:117], v5 offset:544
    v_cvt_pk_bf16_f32 v67, v38, v39
    v_mfma_f32_16x16x32_bf16 v[248:251], a[120:123], v[76:79], v[248:251]
    ds_read_b64_tr_b16 a[118:119], v5 offset:8800
    v_add_f32 v12, v12, v35
    v_mfma_f32_16x16x32_bf16 v[252:255], a[124:127], v[76:79], v[252:255]
    ds_read_b64_tr_b16 a[120:121], v5 offset:768
    ds_read_b64_tr_b16 a[122:123], v5 offset:9024
    v_mfma_f32_16x16x32_bf16 a[144:147], a[128:131], v[76:79], a[144:147]
    buffer_load_dwordx4 v1, s[20:23], s32 offen offset:2048 nt lds
    v_mfma_f32_16x16x32_bf16 v[48:51], a[64:67], a[180:183], v[88:91]
    ds_read_b64_tr_b16 a[124:125], v5 offset:800
    ds_read_b64_tr_b16 a[126:127], v5 offset:9056
    v_mfma_f32_16x16x32_bf16 v[52:55], a[68:71], a[180:183], v[88:91]
    v_exp_f32 v40, v40
    v_mfma_f32_16x16x32_bf16 v[48:51], a[72:75], a[184:187], v[48:51]
    v_exp_f32 v41, v41
    v_mfma_f32_16x16x32_bf16 v[52:55], a[76:79], a[184:187], v[52:55]
    buffer_load_dwordx4 v1, s[20:23], s33 offen offset:3104 nt lds
    v_mfma_f32_16x16x32_bf16 v[48:51], a[80:83], a[188:191], v[48:51]
    v_add_f32 v12, v12, v36
    v_add_f32 v12, v12, v37
    v_mfma_f32_16x16x32_bf16 v[52:55], a[84:87], a[188:191], v[52:55]
    v_cvt_pk_bf16_f32 v68, v40, v41
    v_add_f32 v12, v12, v38
    v_mfma_f32_16x16x32_bf16 v[48:51], a[88:91], a[192:195], v[48:51]
    v_exp_f32 v42, v42
    v_mfma_f32_16x16x32_bf16 v[52:55], a[92:95], a[192:195], v[52:55]
    s_waitcnt lgkmcnt(0)
    v_exp_f32 v43, v43
    v_mfma_f32_16x16x32_bf16 v[128:131], a[96:99], v[64:67], v[128:131]
    v_add_f32 v12, v12, v39
    v_cvt_pk_bf16_f32 v69, v42, v43
    v_mfma_f32_16x16x32_bf16 v[132:135], a[100:103], v[64:67], v[132:135]
    v_exp_f32 v44, v44
    v_mfma_f32_16x16x32_bf16 v[136:139], a[104:107], v[64:67], v[136:139]
    v_exp_f32 v45, v45
    v_mfma_f32_16x16x32_bf16 v[140:143], a[108:111], v[64:67], v[140:143]
    v_exp_f32 v46, v46
    v_mfma_f32_16x16x32_bf16 v[144:147], a[112:115], v[64:67], v[144:147]
    v_exp_f32 v47, v47
    v_mfma_f32_16x16x32_bf16 v[148:151], a[116:119], v[64:67], v[148:151]
    v_cvt_pk_bf16_f32 v70, v44, v45
    v_cvt_pk_bf16_f32 v71, v46, v47
    v_mfma_f32_16x16x32_bf16 v[152:155], a[120:123], v[64:67], v[152:155]
    v_exp_f32 v48, v48
    v_mfma_f32_16x16x32_bf16 v[156:159], a[124:127], v[64:67], v[156:159]
    v_exp_f32 v49, v49
    v_mfma_f32_16x16x32_bf16 v[56:59], a[64:67], a[196:199], v[92:95]
    s_add_u32 m0, s29, 82560
    ds_read_b128 a[64:67], v3 offset:0
    v_cvt_pk_bf16_f32 v72, v48, v49
    v_mfma_f32_16x16x32_bf16 v[60:63], a[68:71], a[196:199], v[92:95]
    s_mov_b32 s31, 245760
    ds_read_b128 a[68:71], v3 offset:8256
    v_add_f32 v14, v14, v48
    v_mfma_f32_16x16x32_bf16 v[56:59], a[72:75], a[200:203], v[56:59]
    ds_read_b128 a[72:75], v3 offset:256
    v_add_f32 v14, v14, v49
    v_mfma_f32_16x16x32_bf16 v[60:63], a[76:79], a[200:203], v[60:63]
    v_exp_f32 v50, v50
    v_mfma_f32_16x16x32_bf16 v[56:59], a[80:83], a[204:207], v[56:59]
    ds_read_b128 a[76:79], v3 offset:8512
    ds_read_b128 a[80:83], v3 offset:512
    v_mfma_f32_16x16x32_bf16 v[60:63], a[84:87], a[204:207], v[60:63]
    ds_read_b128 a[84:87], v3 offset:8768
    v_add_f32 v14, v14, v50
    v_mfma_f32_16x16x32_bf16 v[56:59], a[88:91], a[208:211], v[56:59]
    v_exp_f32 v51, v51
    v_mfma_f32_16x16x32_bf16 v[60:63], a[92:95], a[208:211], v[60:63]
    ds_read_b128 a[88:91], v3 offset:768
    v_cvt_pk_bf16_f32 v73, v50, v51
    v_mfma_f32_16x16x32_bf16 v[160:163], a[96:99], v[68:71], v[160:163]
    ds_read_b128 a[92:95], v3 offset:9024
    v_add_f32 v14, v14, v51
    v_mfma_f32_16x16x32_bf16 v[164:167], a[100:103], v[68:71], v[164:167]
    v_exp_f32 v52, v52
    v_mfma_f32_16x16x32_bf16 v[168:171], a[104:107], v[68:71], v[168:171]
    v_exp_f32 v53, v53
    v_mfma_f32_16x16x32_bf16 v[172:175], a[108:111], v[68:71], v[172:175]
    v_cvt_pk_bf16_f32 v74, v52, v53
    v_add_f32 v14, v14, v52
    v_mfma_f32_16x16x32_bf16 v[176:179], a[112:115], v[68:71], v[176:179]
    v_exp_f32 v54, v54
    v_mfma_f32_16x16x32_bf16 v[180:183], a[116:119], v[68:71], v[180:183]
    v_exp_f32 v55, v55
    v_mfma_f32_16x16x32_bf16 v[184:187], a[120:123], v[68:71], v[184:187]
    buffer_load_dwordx4 v1, s[16:19], s31 offen nt lds
    v_mfma_f32_16x16x32_bf16 v[188:191], a[124:127], v[68:71], v[188:191]
    v_cvt_pk_bf16_f32 v75, v54, v55
    v_add_f32 v14, v14, v53
    v_mfma_f32_16x16x32_bf16 a[136:139], a[128:131], v[68:71], a[136:139]
    s_waitcnt lgkmcnt(0)
    v_exp_f32 v56, v56
    v_mfma_f32_16x16x32_bf16 v[32:35], a[64:67], a[148:151], v[80:83]
    v_exp_f32 v57, v57
    v_mfma_f32_16x16x32_bf16 v[36:39], a[68:71], a[148:151], v[80:83]
    buffer_load_dwordx4 v1, s[16:19], s31 offen offset:1024 nt lds
    v_mfma_f32_16x16x32_bf16 v[32:35], a[72:75], a[152:155], v[32:35]
    v_cvt_pk_bf16_f32 v76, v56, v57
    v_add_f32 v14, v14, v54
    v_mfma_f32_16x16x32_bf16 v[36:39], a[76:79], a[152:155], v[36:39]
    v_exp_f32 v58, v58
    v_mfma_f32_16x16x32_bf16 v[32:35], a[80:83], a[156:159], v[32:35]
    v_exp_f32 v59, v59
    v_mfma_f32_16x16x32_bf16 v[36:39], a[84:87], a[156:159], v[36:39]
    v_add_f32 v14, v14, v55
    v_cvt_pk_bf16_f32 v77, v58, v59
    v_mfma_f32_16x16x32_bf16 v[32:35], a[88:91], a[160:163], v[32:35]
    v_exp_f32 v60, v60
    v_mfma_f32_16x16x32_bf16 v[36:39], a[92:95], a[160:163], v[36:39]
    v_exp_f32 v61, v61
    v_mfma_f32_16x16x32_bf16 v[192:195], a[96:99], v[72:75], v[192:195]
    v_exp_f32 v62, v62
    v_mfma_f32_16x16x32_bf16 v[196:199], a[100:103], v[72:75], v[196:199]
    v_exp_f32 v63, v63
    v_mfma_f32_16x16x32_bf16 v[200:203], a[104:107], v[72:75], v[200:203]
    v_cvt_pk_bf16_f32 v78, v60, v61
    v_cvt_pk_bf16_f32 v79, v62, v63
    v_mfma_f32_16x16x32_bf16 v[204:207], a[108:111], v[72:75], v[204:207]
    v_mfma_f32_16x16x32_bf16 v[208:211], a[112:115], v[72:75], v[208:211]
    v_exp_f32 v32, v32
    v_mfma_f32_16x16x32_bf16 v[212:215], a[116:119], v[72:75], v[212:215]
    v_exp_f32 v33, v33
    v_mfma_f32_16x16x32_bf16 v[216:219], a[120:123], v[72:75], v[216:219]
    v_cvt_pk_bf16_f32 v64, v32, v33
    v_add_f32 v12, v12, v32
    v_mfma_f32_16x16x32_bf16 v[220:223], a[124:127], v[72:75], v[220:223]
    v_exp_f32 v34, v34
    v_mfma_f32_16x16x32_bf16 v[40:43], a[64:67], a[164:167], v[84:87]
    v_exp_f32 v35, v35
    v_mfma_f32_16x16x32_bf16 v[44:47], a[68:71], a[164:167], v[84:87]
    v_cvt_pk_bf16_f32 v65, v34, v35
    v_add_f32 v12, v12, v33
    v_mfma_f32_16x16x32_bf16 v[40:43], a[72:75], a[168:171], v[40:43]
    s_add_u32 m0, s29, 82560
    v_exp_f32 v36, v36
    v_mfma_f32_16x16x32_bf16 v[44:47], a[76:79], a[168:171], v[44:47]
    s_mov_b32 s32, 235520
    v_exp_f32 v37, v37
    v_mfma_f32_16x16x32_bf16 v[40:43], a[80:83], a[172:175], v[40:43]
    s_mov_b32 s33, 235488
    v_cvt_pk_bf16_f32 v66, v36, v37
    v_add_f32 v12, v12, v34
    v_mfma_f32_16x16x32_bf16 v[44:47], a[84:87], a[172:175], v[44:47]
    v_exp_f32 v38, v38
    v_mfma_f32_16x16x32_bf16 v[40:43], a[88:91], a[176:179], v[40:43]
    v_exp_f32 v39, v39
    v_mfma_f32_16x16x32_bf16 v[44:47], a[92:95], a[176:179], v[44:47]
    v_cvt_pk_bf16_f32 v67, v38, v39
    v_add_f32 v12, v12, v35
    v_mfma_f32_16x16x32_bf16 v[224:227], a[96:99], v[76:79], v[224:227]
    ds_read_b64_tr_b16 a[96:97], v5 offset:16512
    ds_read_b64_tr_b16 a[98:99], v5 offset:24768
    v_mfma_f32_16x16x32_bf16 v[228:231], a[100:103], v[76:79], v[228:231]
    ds_read_b64_tr_b16 a[100:101], v5 offset:16544
    ds_read_b64_tr_b16 a[102:103], v5 offset:24800
    v_mfma_f32_16x16x32_bf16 v[232:235], a[104:107], v[76:79], v[232:235]
    ds_read_b64_tr_b16 a[104:105], v5 offset:16768
    ds_read_b64_tr_b16 a[106:107], v5 offset:25024
    v_mfma_f32_16x16x32_bf16 v[236:239], a[108:111], v[76:79], v[236:239]
    ds_read_b64_tr_b16 a[108:109], v5 offset:16800
    ds_read_b64_tr_b16 a[110:111], v5 offset:25056
    v_mfma_f32_16x16x32_bf16 v[240:243], a[112:115], v[76:79], v[240:243]
    ds_read_b64_tr_b16 a[112:113], v5 offset:17024
    ds_read_b64_tr_b16 a[114:115], v5 offset:25280
    v_mfma_f32_16x16x32_bf16 v[244:247], a[116:119], v[76:79], v[244:247]
    ds_read_b64_tr_b16 a[116:117], v5 offset:17056
    ds_read_b64_tr_b16 a[118:119], v5 offset:25312
    v_mfma_f32_16x16x32_bf16 v[248:251], a[120:123], v[76:79], v[248:251]
    ds_read_b64_tr_b16 a[120:121], v5 offset:17280
    ds_read_b64_tr_b16 a[122:123], v5 offset:25536
    v_mfma_f32_16x16x32_bf16 v[252:255], a[124:127], v[76:79], v[252:255]
    ds_read_b64_tr_b16 a[124:125], v5 offset:17312
    ds_read_b64_tr_b16 a[126:127], v5 offset:25568
    v_mfma_f32_16x16x32_bf16 a[144:147], a[128:131], v[76:79], a[144:147]
    buffer_load_dwordx4 v1, s[20:23], s32 offen offset:2048 nt lds
    v_mfma_f32_16x16x32_bf16 v[48:51], a[64:67], a[180:183], v[88:91]
    v_exp_f32 v40, v40
    v_mfma_f32_16x16x32_bf16 v[52:55], a[68:71], a[180:183], v[88:91]
    v_exp_f32 v41, v41
    v_mfma_f32_16x16x32_bf16 v[48:51], a[72:75], a[184:187], v[48:51]
    v_add_f32 v12, v12, v36
    v_add_f32 v12, v12, v37
    v_mfma_f32_16x16x32_bf16 v[52:55], a[76:79], a[184:187], v[52:55]
    buffer_load_dwordx4 v1, s[20:23], s33 offen offset:3104 nt lds
    v_mfma_f32_16x16x32_bf16 v[48:51], a[80:83], a[188:191], v[48:51]
    v_cvt_pk_bf16_f32 v68, v40, v41
    v_add_f32 v12, v12, v38
    v_mfma_f32_16x16x32_bf16 v[52:55], a[84:87], a[188:191], v[52:55]
    v_exp_f32 v42, v42
    v_mfma_f32_16x16x32_bf16 v[48:51], a[88:91], a[192:195], v[48:51]
    v_exp_f32 v43, v43
    v_mfma_f32_16x16x32_bf16 v[52:55], a[92:95], a[192:195], v[52:55]
    s_waitcnt lgkmcnt(0)
    v_add_f32 v12, v12, v39
    v_cvt_pk_bf16_f32 v69, v42, v43
    v_mfma_f32_16x16x32_bf16 v[128:131], a[96:99], v[64:67], v[128:131]
    v_exp_f32 v44, v44
    v_mfma_f32_16x16x32_bf16 v[132:135], a[100:103], v[64:67], v[132:135]
    v_exp_f32 v45, v45
    v_mfma_f32_16x16x32_bf16 v[136:139], a[104:107], v[64:67], v[136:139]
    v_exp_f32 v46, v46
    v_mfma_f32_16x16x32_bf16 v[140:143], a[108:111], v[64:67], v[140:143]
    v_exp_f32 v47, v47
    v_mfma_f32_16x16x32_bf16 v[144:147], a[112:115], v[64:67], v[144:147]
    v_cvt_pk_bf16_f32 v70, v44, v45
    v_cvt_pk_bf16_f32 v71, v46, v47
    v_mfma_f32_16x16x32_bf16 v[148:151], a[116:119], v[64:67], v[148:151]
    v_exp_f32 v48, v48
    v_mfma_f32_16x16x32_bf16 v[152:155], a[120:123], v[64:67], v[152:155]
    v_exp_f32 v49, v49
    v_mfma_f32_16x16x32_bf16 v[156:159], a[124:127], v[64:67], v[156:159]
    v_cvt_pk_bf16_f32 v72, v48, v49
    v_add_f32 v14, v14, v48
    v_mfma_f32_16x16x32_bf16 v[56:59], a[64:67], a[196:199], v[92:95]
    ds_read_b128 a[64:67], v3 offset:16512
    v_add_f32 v14, v14, v49
    v_mfma_f32_16x16x32_bf16 v[60:63], a[68:71], a[196:199], v[92:95]
    v_exp_f32 v50, v50
    v_mfma_f32_16x16x32_bf16 v[56:59], a[72:75], a[200:203], v[56:59]
    ds_read_b128 a[68:71], v3 offset:24768
    ds_read_b128 a[72:75], v3 offset:16768
    v_mfma_f32_16x16x32_bf16 v[60:63], a[76:79], a[200:203], v[60:63]
    ds_read_b128 a[76:79], v3 offset:25024
    v_add_f32 v14, v14, v50
    v_mfma_f32_16x16x32_bf16 v[56:59], a[80:83], a[204:207], v[56:59]
    v_exp_f32 v51, v51
    v_mfma_f32_16x16x32_bf16 v[60:63], a[84:87], a[204:207], v[60:63]
    ds_read_b128 a[80:83], v3 offset:17024
    ds_read_b128 a[84:87], v3 offset:25280
    v_mfma_f32_16x16x32_bf16 v[56:59], a[88:91], a[208:211], v[56:59]
    ds_read_b128 a[88:91], v3 offset:17280
    v_cvt_pk_bf16_f32 v73, v50, v51
    v_mfma_f32_16x16x32_bf16 v[60:63], a[92:95], a[208:211], v[60:63]
    ds_read_b128 a[92:95], v3 offset:25536
    v_add_f32 v14, v14, v51
    v_mfma_f32_16x16x32_bf16 v[160:163], a[96:99], v[68:71], v[160:163]
    v_exp_f32 v52, v52
    v_mfma_f32_16x16x32_bf16 v[164:167], a[100:103], v[68:71], v[164:167]
    v_exp_f32 v53, v53
    v_mfma_f32_16x16x32_bf16 v[168:171], a[104:107], v[68:71], v[168:171]
    v_cvt_pk_bf16_f32 v74, v52, v53
    v_add_f32 v14, v14, v52
    v_mfma_f32_16x16x32_bf16 v[172:175], a[108:111], v[68:71], v[172:175]
    v_exp_f32 v54, v54
    v_mfma_f32_16x16x32_bf16 v[176:179], a[112:115], v[68:71], v[176:179]
    v_exp_f32 v55, v55
    v_mfma_f32_16x16x32_bf16 v[180:183], a[116:119], v[68:71], v[180:183]
    v_cvt_pk_bf16_f32 v75, v54, v55
    v_add_f32 v14, v14, v53
    v_mfma_f32_16x16x32_bf16 v[184:187], a[120:123], v[68:71], v[184:187]
    v_exp_f32 v56, v56
    v_mfma_f32_16x16x32_bf16 v[188:191], a[124:127], v[68:71], v[188:191]
    v_exp_f32 v57, v57
    v_mfma_f32_16x16x32_bf16 a[136:139], a[128:131], v[68:71], a[136:139]
    s_waitcnt lgkmcnt(0)
    v_cvt_pk_bf16_f32 v76, v56, v57
    v_add_f32 v14, v14, v54
    v_mfma_f32_16x16x32_bf16 v[32:35], a[64:67], a[148:151], v[80:83]
    v_exp_f32 v58, v58
    v_mfma_f32_16x16x32_bf16 v[36:39], a[68:71], a[148:151], v[80:83]
    v_exp_f32 v59, v59
    v_mfma_f32_16x16x32_bf16 v[32:35], a[72:75], a[152:155], v[32:35]
    v_add_f32 v14, v14, v55
    v_cvt_pk_bf16_f32 v77, v58, v59
    v_mfma_f32_16x16x32_bf16 v[36:39], a[76:79], a[152:155], v[36:39]
    v_exp_f32 v60, v60
    v_mfma_f32_16x16x32_bf16 v[32:35], a[80:83], a[156:159], v[32:35]
    v_exp_f32 v61, v61
    v_mfma_f32_16x16x32_bf16 v[36:39], a[84:87], a[156:159], v[36:39]
    v_exp_f32 v62, v62
    v_mfma_f32_16x16x32_bf16 v[32:35], a[88:91], a[160:163], v[32:35]
    v_exp_f32 v63, v63
    v_mfma_f32_16x16x32_bf16 v[36:39], a[92:95], a[160:163], v[36:39]
    v_cvt_pk_bf16_f32 v78, v60, v61
    v_cvt_pk_bf16_f32 v79, v62, v63
    v_mfma_f32_16x16x32_bf16 v[192:195], a[96:99], v[72:75], v[192:195]
    v_mfma_f32_16x16x32_bf16 v[196:199], a[100:103], v[72:75], v[196:199]
    v_mfma_f32_16x16x32_bf16 v[200:203], a[104:107], v[72:75], v[200:203]
    v_mfma_f32_16x16x32_bf16 v[204:207], a[108:111], v[72:75], v[204:207]
    v_mfma_f32_16x16x32_bf16 v[208:211], a[112:115], v[72:75], v[208:211]
    v_exp_f32 v32, v32
    v_mfma_f32_16x16x32_bf16 v[212:215], a[116:119], v[72:75], v[212:215]
    v_exp_f32 v33, v33
    v_mfma_f32_16x16x32_bf16 v[216:219], a[120:123], v[72:75], v[216:219]
    v_cvt_pk_bf16_f32 v64, v32, v33
    v_add_f32 v12, v12, v32
    v_mfma_f32_16x16x32_bf16 v[220:223], a[124:127], v[72:75], v[220:223]
    v_exp_f32 v34, v34
    v_mfma_f32_16x16x32_bf16 v[40:43], a[64:67], a[164:167], v[84:87]
    s_waitcnt vmcnt(8) lgkmcnt(0)
    s_barrier
    v_mfma_f32_16x16x32_bf16 v[44:47], a[68:71], a[164:167], v[84:87]
    v_exp_f32 v35, v35
    v_mfma_f32_16x16x32_bf16 v[40:43], a[72:75], a[168:171], v[40:43]
    s_add_u32 m0, s29, 99072
    v_cvt_pk_bf16_f32 v65, v34, v35
    v_add_f32 v12, v12, v33
    v_mfma_f32_16x16x32_bf16 v[44:47], a[76:79], a[168:171], v[44:47]
    s_mov_b32 s31, 253952
    v_exp_f32 v36, v36
    v_mfma_f32_16x16x32_bf16 v[40:43], a[80:83], a[172:175], v[40:43]
    v_exp_f32 v37, v37
    v_mfma_f32_16x16x32_bf16 v[44:47], a[84:87], a[172:175], v[44:47]
    v_cvt_pk_bf16_f32 v66, v36, v37
    v_add_f32 v12, v12, v34
    v_mfma_f32_16x16x32_bf16 v[40:43], a[88:91], a[176:179], v[40:43]
    v_exp_f32 v38, v38
    v_mfma_f32_16x16x32_bf16 v[44:47], a[92:95], a[176:179], v[44:47]
    v_exp_f32 v39, v39
    v_mfma_f32_16x16x32_bf16 v[224:227], a[96:99], v[76:79], v[224:227]
    ds_read_b64_tr_b16 a[96:97], v5 offset:33024
    ds_read_b64_tr_b16 a[98:99], v5 offset:41280
    v_mfma_f32_16x16x32_bf16 v[228:231], a[100:103], v[76:79], v[228:231]
    ds_read_b64_tr_b16 a[100:101], v5 offset:33056
    ds_read_b64_tr_b16 a[102:103], v5 offset:41312
    v_mfma_f32_16x16x32_bf16 v[232:235], a[104:107], v[76:79], v[232:235]
    ds_read_b64_tr_b16 a[104:105], v5 offset:33280
    ds_read_b64_tr_b16 a[106:107], v5 offset:41536
    v_mfma_f32_16x16x32_bf16 v[236:239], a[108:111], v[76:79], v[236:239]
    ds_read_b64_tr_b16 a[108:109], v5 offset:33312
    ds_read_b64_tr_b16 a[110:111], v5 offset:41568
    v_mfma_f32_16x16x32_bf16 v[240:243], a[112:115], v[76:79], v[240:243]
    ds_read_b64_tr_b16 a[112:113], v5 offset:33536
    ds_read_b64_tr_b16 a[114:115], v5 offset:41792
    v_mfma_f32_16x16x32_bf16 v[244:247], a[116:119], v[76:79], v[244:247]
    ds_read_b64_tr_b16 a[116:117], v5 offset:33568
    v_cvt_pk_bf16_f32 v67, v38, v39
    v_mfma_f32_16x16x32_bf16 v[248:251], a[120:123], v[76:79], v[248:251]
    ds_read_b64_tr_b16 a[118:119], v5 offset:41824
    v_add_f32 v12, v12, v35
    v_mfma_f32_16x16x32_bf16 v[252:255], a[124:127], v[76:79], v[252:255]
    ds_read_b64_tr_b16 a[120:121], v5 offset:33792
    ds_read_b64_tr_b16 a[122:123], v5 offset:42048
    v_mfma_f32_16x16x32_bf16 a[144:147], a[128:131], v[76:79], a[144:147]
    buffer_load_dwordx4 v1, s[16:19], s31 offen nt lds
    v_mfma_f32_16x16x32_bf16 v[48:51], a[64:67], a[180:183], v[88:91]
    ds_read_b64_tr_b16 a[124:125], v5 offset:33824
    ds_read_b64_tr_b16 a[126:127], v5 offset:42080
    v_mfma_f32_16x16x32_bf16 v[52:55], a[68:71], a[180:183], v[88:91]
    v_exp_f32 v40, v40
    v_mfma_f32_16x16x32_bf16 v[48:51], a[72:75], a[184:187], v[48:51]
    v_exp_f32 v41, v41
    v_mfma_f32_16x16x32_bf16 v[52:55], a[76:79], a[184:187], v[52:55]
    buffer_load_dwordx4 v1, s[16:19], s31 offen offset:1024 nt lds
    v_mfma_f32_16x16x32_bf16 v[48:51], a[80:83], a[188:191], v[48:51]
    v_add_f32 v12, v12, v36
    v_add_f32 v12, v12, v37
    v_mfma_f32_16x16x32_bf16 v[52:55], a[84:87], a[188:191], v[52:55]
    v_cvt_pk_bf16_f32 v68, v40, v41
    v_add_f32 v12, v12, v38
    v_mfma_f32_16x16x32_bf16 v[48:51], a[88:91], a[192:195], v[48:51]
    v_exp_f32 v42, v42
    v_mfma_f32_16x16x32_bf16 v[52:55], a[92:95], a[192:195], v[52:55]
    s_waitcnt lgkmcnt(0)
    v_exp_f32 v43, v43
    v_mfma_f32_16x16x32_bf16 v[128:131], a[96:99], v[64:67], v[128:131]
    v_add_f32 v12, v12, v39
    v_cvt_pk_bf16_f32 v69, v42, v43
    v_mfma_f32_16x16x32_bf16 v[132:135], a[100:103], v[64:67], v[132:135]
    v_exp_f32 v44, v44
    v_mfma_f32_16x16x32_bf16 v[136:139], a[104:107], v[64:67], v[136:139]
    v_exp_f32 v45, v45
    v_mfma_f32_16x16x32_bf16 v[140:143], a[108:111], v[64:67], v[140:143]
    v_exp_f32 v46, v46
    v_mfma_f32_16x16x32_bf16 v[144:147], a[112:115], v[64:67], v[144:147]
    v_exp_f32 v47, v47
    v_mfma_f32_16x16x32_bf16 v[148:151], a[116:119], v[64:67], v[148:151]
    v_cvt_pk_bf16_f32 v70, v44, v45
    v_cvt_pk_bf16_f32 v71, v46, v47
    v_mfma_f32_16x16x32_bf16 v[152:155], a[120:123], v[64:67], v[152:155]
    v_exp_f32 v48, v48
    v_mfma_f32_16x16x32_bf16 v[156:159], a[124:127], v[64:67], v[156:159]
    v_exp_f32 v49, v49
    v_mfma_f32_16x16x32_bf16 v[56:59], a[64:67], a[196:199], v[92:95]
    s_add_u32 m0, s29, 99072
    ds_read_b128 a[64:67], v3 offset:33024
    v_cvt_pk_bf16_f32 v72, v48, v49
    v_mfma_f32_16x16x32_bf16 v[60:63], a[68:71], a[196:199], v[92:95]
    s_mov_b32 s32, 243712
    ds_read_b128 a[68:71], v3 offset:41280
    v_add_f32 v14, v14, v48
    v_mfma_f32_16x16x32_bf16 v[56:59], a[72:75], a[200:203], v[56:59]
    s_mov_b32 s33, 243680
    ds_read_b128 a[72:75], v3 offset:33280
    v_add_f32 v14, v14, v49
    v_mfma_f32_16x16x32_bf16 v[60:63], a[76:79], a[200:203], v[60:63]
    v_exp_f32 v50, v50
    v_mfma_f32_16x16x32_bf16 v[56:59], a[80:83], a[204:207], v[56:59]
    ds_read_b128 a[76:79], v3 offset:41536
    ds_read_b128 a[80:83], v3 offset:33536
    v_mfma_f32_16x16x32_bf16 v[60:63], a[84:87], a[204:207], v[60:63]
    ds_read_b128 a[84:87], v3 offset:41792
    v_add_f32 v14, v14, v50
    v_mfma_f32_16x16x32_bf16 v[56:59], a[88:91], a[208:211], v[56:59]
    v_exp_f32 v51, v51
    v_mfma_f32_16x16x32_bf16 v[60:63], a[92:95], a[208:211], v[60:63]
    ds_read_b128 a[88:91], v3 offset:33792
    v_cvt_pk_bf16_f32 v73, v50, v51
    v_mfma_f32_16x16x32_bf16 v[160:163], a[96:99], v[68:71], v[160:163]
    ds_read_b128 a[92:95], v3 offset:42048
    v_add_f32 v14, v14, v51
    v_mfma_f32_16x16x32_bf16 v[164:167], a[100:103], v[68:71], v[164:167]
    v_exp_f32 v52, v52
    v_mfma_f32_16x16x32_bf16 v[168:171], a[104:107], v[68:71], v[168:171]
    v_exp_f32 v53, v53
    v_mfma_f32_16x16x32_bf16 v[172:175], a[108:111], v[68:71], v[172:175]
    v_cvt_pk_bf16_f32 v74, v52, v53
    v_add_f32 v14, v14, v52
    v_mfma_f32_16x16x32_bf16 v[176:179], a[112:115], v[68:71], v[176:179]
    v_exp_f32 v54, v54
    v_mfma_f32_16x16x32_bf16 v[180:183], a[116:119], v[68:71], v[180:183]
    v_exp_f32 v55, v55
    v_mfma_f32_16x16x32_bf16 v[184:187], a[120:123], v[68:71], v[184:187]
    buffer_load_dwordx4 v1, s[20:23], s32 offen offset:2048 nt lds
    v_mfma_f32_16x16x32_bf16 v[188:191], a[124:127], v[68:71], v[188:191]
    v_cvt_pk_bf16_f32 v75, v54, v55
    v_add_f32 v14, v14, v53
    v_mfma_f32_16x16x32_bf16 a[136:139], a[128:131], v[68:71], a[136:139]
    s_waitcnt lgkmcnt(0)
    v_exp_f32 v56, v56
    v_mfma_f32_16x16x32_bf16 v[32:35], a[64:67], a[148:151], v[80:83]
    v_exp_f32 v57, v57
    v_mfma_f32_16x16x32_bf16 v[36:39], a[68:71], a[148:151], v[80:83]
    buffer_load_dwordx4 v1, s[20:23], s33 offen offset:3104 nt lds
    v_mfma_f32_16x16x32_bf16 v[32:35], a[72:75], a[152:155], v[32:35]
    v_cvt_pk_bf16_f32 v76, v56, v57
    v_add_f32 v14, v14, v54
    v_mfma_f32_16x16x32_bf16 v[36:39], a[76:79], a[152:155], v[36:39]
    v_exp_f32 v58, v58
    v_mfma_f32_16x16x32_bf16 v[32:35], a[80:83], a[156:159], v[32:35]
    v_exp_f32 v59, v59
    v_mfma_f32_16x16x32_bf16 v[36:39], a[84:87], a[156:159], v[36:39]
    v_add_f32 v14, v14, v55
    v_cvt_pk_bf16_f32 v77, v58, v59
    v_mfma_f32_16x16x32_bf16 v[32:35], a[88:91], a[160:163], v[32:35]
    v_exp_f32 v60, v60
    v_mfma_f32_16x16x32_bf16 v[36:39], a[92:95], a[160:163], v[36:39]
    v_exp_f32 v61, v61
    v_mfma_f32_16x16x32_bf16 v[192:195], a[96:99], v[72:75], v[192:195]
    v_exp_f32 v62, v62
    v_mfma_f32_16x16x32_bf16 v[196:199], a[100:103], v[72:75], v[196:199]
    v_exp_f32 v63, v63
    v_mfma_f32_16x16x32_bf16 v[200:203], a[104:107], v[72:75], v[200:203]
    v_cvt_pk_bf16_f32 v78, v60, v61
    v_cvt_pk_bf16_f32 v79, v62, v63
    v_mfma_f32_16x16x32_bf16 v[204:207], a[108:111], v[72:75], v[204:207]
    v_mfma_f32_16x16x32_bf16 v[208:211], a[112:115], v[72:75], v[208:211]
    v_exp_f32 v32, v32
    v_mfma_f32_16x16x32_bf16 v[212:215], a[116:119], v[72:75], v[212:215]
    v_exp_f32 v33, v33
    v_mfma_f32_16x16x32_bf16 v[216:219], a[120:123], v[72:75], v[216:219]
    v_cvt_pk_bf16_f32 v64, v32, v33
    v_add_f32 v12, v12, v32
    v_mfma_f32_16x16x32_bf16 v[220:223], a[124:127], v[72:75], v[220:223]
    v_exp_f32 v34, v34
    v_mfma_f32_16x16x32_bf16 v[40:43], a[64:67], a[164:167], v[84:87]
    v_exp_f32 v35, v35
    v_mfma_f32_16x16x32_bf16 v[44:47], a[68:71], a[164:167], v[84:87]
    v_cvt_pk_bf16_f32 v65, v34, v35
    v_add_f32 v12, v12, v33
    v_mfma_f32_16x16x32_bf16 v[40:43], a[72:75], a[168:171], v[40:43]
    s_add_u32 m0, s29, 115584
    v_exp_f32 v36, v36
    v_mfma_f32_16x16x32_bf16 v[44:47], a[76:79], a[168:171], v[44:47]
    s_mov_b32 s32, 251904
    v_exp_f32 v37, v37
    v_mfma_f32_16x16x32_bf16 v[40:43], a[80:83], a[172:175], v[40:43]
    s_mov_b32 s33, 251872
    v_cvt_pk_bf16_f32 v66, v36, v37
    v_add_f32 v12, v12, v34
    v_mfma_f32_16x16x32_bf16 v[44:47], a[84:87], a[172:175], v[44:47]
    v_exp_f32 v38, v38
    v_mfma_f32_16x16x32_bf16 v[40:43], a[88:91], a[176:179], v[40:43]
    v_exp_f32 v39, v39
    v_mfma_f32_16x16x32_bf16 v[44:47], a[92:95], a[176:179], v[44:47]
    v_cvt_pk_bf16_f32 v67, v38, v39
    v_add_f32 v12, v12, v35
    v_mfma_f32_16x16x32_bf16 v[224:227], a[96:99], v[76:79], v[224:227]
    ds_read_b64_tr_b16 a[96:97], v5 offset:49536
    ds_read_b64_tr_b16 a[98:99], v5 offset:57792
    v_mfma_f32_16x16x32_bf16 v[228:231], a[100:103], v[76:79], v[228:231]
    ds_read_b64_tr_b16 a[100:101], v5 offset:49568
    ds_read_b64_tr_b16 a[102:103], v5 offset:57824
    v_mfma_f32_16x16x32_bf16 v[232:235], a[104:107], v[76:79], v[232:235]
    ds_read_b64_tr_b16 a[104:105], v5 offset:49792
    ds_read_b64_tr_b16 a[106:107], v5 offset:58048
    v_mfma_f32_16x16x32_bf16 v[236:239], a[108:111], v[76:79], v[236:239]
    ds_read_b64_tr_b16 a[108:109], v5 offset:49824
    ds_read_b64_tr_b16 a[110:111], v5 offset:58080
    v_mfma_f32_16x16x32_bf16 v[240:243], a[112:115], v[76:79], v[240:243]
    ds_read_b64_tr_b16 a[112:113], v5 offset:50048
    ds_read_b64_tr_b16 a[114:115], v5 offset:58304
    v_mfma_f32_16x16x32_bf16 v[244:247], a[116:119], v[76:79], v[244:247]
    ds_read_b64_tr_b16 a[116:117], v5 offset:50080
    ds_read_b64_tr_b16 a[118:119], v5 offset:58336
    v_mfma_f32_16x16x32_bf16 v[248:251], a[120:123], v[76:79], v[248:251]
    ds_read_b64_tr_b16 a[120:121], v5 offset:50304
    ds_read_b64_tr_b16 a[122:123], v5 offset:58560
    v_mfma_f32_16x16x32_bf16 v[252:255], a[124:127], v[76:79], v[252:255]
    ds_read_b64_tr_b16 a[124:125], v5 offset:50336
    ds_read_b64_tr_b16 a[126:127], v5 offset:58592
    v_mfma_f32_16x16x32_bf16 a[144:147], a[128:131], v[76:79], a[144:147]
    buffer_load_dwordx4 v1, s[20:23], s32 offen offset:2048 nt lds
    v_mfma_f32_16x16x32_bf16 v[48:51], a[64:67], a[180:183], v[88:91]
    v_exp_f32 v40, v40
    v_mfma_f32_16x16x32_bf16 v[52:55], a[68:71], a[180:183], v[88:91]
    v_exp_f32 v41, v41
    v_mfma_f32_16x16x32_bf16 v[48:51], a[72:75], a[184:187], v[48:51]
    v_add_f32 v12, v12, v36
    v_add_f32 v12, v12, v37
    v_mfma_f32_16x16x32_bf16 v[52:55], a[76:79], a[184:187], v[52:55]
    buffer_load_dwordx4 v1, s[20:23], s33 offen offset:3104 nt lds
    v_mfma_f32_16x16x32_bf16 v[48:51], a[80:83], a[188:191], v[48:51]
    v_cvt_pk_bf16_f32 v68, v40, v41
    v_add_f32 v12, v12, v38
    v_mfma_f32_16x16x32_bf16 v[52:55], a[84:87], a[188:191], v[52:55]
    v_exp_f32 v42, v42
    v_mfma_f32_16x16x32_bf16 v[48:51], a[88:91], a[192:195], v[48:51]
    v_exp_f32 v43, v43
    v_mfma_f32_16x16x32_bf16 v[52:55], a[92:95], a[192:195], v[52:55]
    s_waitcnt lgkmcnt(0)
    v_add_f32 v12, v12, v39
    v_cvt_pk_bf16_f32 v69, v42, v43
    v_mfma_f32_16x16x32_bf16 v[128:131], a[96:99], v[64:67], v[128:131]
    v_exp_f32 v44, v44
    v_mfma_f32_16x16x32_bf16 v[132:135], a[100:103], v[64:67], v[132:135]
    v_exp_f32 v45, v45
    v_mfma_f32_16x16x32_bf16 v[136:139], a[104:107], v[64:67], v[136:139]
    v_exp_f32 v46, v46
    v_mfma_f32_16x16x32_bf16 v[140:143], a[108:111], v[64:67], v[140:143]
    v_exp_f32 v47, v47
    v_mfma_f32_16x16x32_bf16 v[144:147], a[112:115], v[64:67], v[144:147]
    v_cvt_pk_bf16_f32 v70, v44, v45
    v_cvt_pk_bf16_f32 v71, v46, v47
    v_mfma_f32_16x16x32_bf16 v[148:151], a[116:119], v[64:67], v[148:151]
    v_exp_f32 v48, v48
    v_mfma_f32_16x16x32_bf16 v[152:155], a[120:123], v[64:67], v[152:155]
    v_exp_f32 v49, v49
    v_mfma_f32_16x16x32_bf16 v[156:159], a[124:127], v[64:67], v[156:159]
    v_cvt_pk_bf16_f32 v72, v48, v49
    v_add_f32 v14, v14, v48
    v_mfma_f32_16x16x32_bf16 v[56:59], a[64:67], a[196:199], v[92:95]
    ds_read_b128 a[64:67], v3 offset:49536
    v_add_f32 v14, v14, v49
    v_mfma_f32_16x16x32_bf16 v[60:63], a[68:71], a[196:199], v[92:95]
    v_exp_f32 v50, v50
    v_mfma_f32_16x16x32_bf16 v[56:59], a[72:75], a[200:203], v[56:59]
    ds_read_b128 a[68:71], v3 offset:57792
    ds_read_b128 a[72:75], v3 offset:49792
    v_mfma_f32_16x16x32_bf16 v[60:63], a[76:79], a[200:203], v[60:63]
    ds_read_b128 a[76:79], v3 offset:58048
    v_add_f32 v14, v14, v50
    v_mfma_f32_16x16x32_bf16 v[56:59], a[80:83], a[204:207], v[56:59]
    v_exp_f32 v51, v51
    v_mfma_f32_16x16x32_bf16 v[60:63], a[84:87], a[204:207], v[60:63]
    ds_read_b128 a[80:83], v3 offset:50048
    ds_read_b128 a[84:87], v3 offset:58304
    v_mfma_f32_16x16x32_bf16 v[56:59], a[88:91], a[208:211], v[56:59]
    ds_read_b128 a[88:91], v3 offset:50304
    v_cvt_pk_bf16_f32 v73, v50, v51
    v_mfma_f32_16x16x32_bf16 v[60:63], a[92:95], a[208:211], v[60:63]
    ds_read_b128 a[92:95], v3 offset:58560
    v_add_f32 v14, v14, v51
    v_mfma_f32_16x16x32_bf16 v[160:163], a[96:99], v[68:71], v[160:163]
    v_exp_f32 v52, v52
    v_mfma_f32_16x16x32_bf16 v[164:167], a[100:103], v[68:71], v[164:167]
    v_exp_f32 v53, v53
    v_mfma_f32_16x16x32_bf16 v[168:171], a[104:107], v[68:71], v[168:171]
    v_cvt_pk_bf16_f32 v74, v52, v53
    v_add_f32 v14, v14, v52
    v_mfma_f32_16x16x32_bf16 v[172:175], a[108:111], v[68:71], v[172:175]
    v_exp_f32 v54, v54
    v_mfma_f32_16x16x32_bf16 v[176:179], a[112:115], v[68:71], v[176:179]
    v_exp_f32 v55, v55
    v_mfma_f32_16x16x32_bf16 v[180:183], a[116:119], v[68:71], v[180:183]
    v_cvt_pk_bf16_f32 v75, v54, v55
    v_add_f32 v14, v14, v53
    v_mfma_f32_16x16x32_bf16 v[184:187], a[120:123], v[68:71], v[184:187]
    v_exp_f32 v56, v56
    v_mfma_f32_16x16x32_bf16 v[188:191], a[124:127], v[68:71], v[188:191]
    v_exp_f32 v57, v57
    v_mfma_f32_16x16x32_bf16 a[136:139], a[128:131], v[68:71], a[136:139]
    s_waitcnt lgkmcnt(0)
    v_cvt_pk_bf16_f32 v76, v56, v57
    v_add_f32 v14, v14, v54
    v_mfma_f32_16x16x32_bf16 v[32:35], a[64:67], a[148:151], v[80:83]
    v_exp_f32 v58, v58
    v_mfma_f32_16x16x32_bf16 v[36:39], a[68:71], a[148:151], v[80:83]
    v_exp_f32 v59, v59
    v_mfma_f32_16x16x32_bf16 v[32:35], a[72:75], a[152:155], v[32:35]
    v_add_f32 v14, v14, v55
    v_cvt_pk_bf16_f32 v77, v58, v59
    v_mfma_f32_16x16x32_bf16 v[36:39], a[76:79], a[152:155], v[36:39]
    v_exp_f32 v60, v60
    v_mfma_f32_16x16x32_bf16 v[32:35], a[80:83], a[156:159], v[32:35]
    v_exp_f32 v61, v61
    v_mfma_f32_16x16x32_bf16 v[36:39], a[84:87], a[156:159], v[36:39]
    v_exp_f32 v62, v62
    v_mfma_f32_16x16x32_bf16 v[32:35], a[88:91], a[160:163], v[32:35]
    v_exp_f32 v63, v63
    v_mfma_f32_16x16x32_bf16 v[36:39], a[92:95], a[160:163], v[36:39]
    v_cvt_pk_bf16_f32 v78, v60, v61
    v_cvt_pk_bf16_f32 v79, v62, v63
    v_mfma_f32_16x16x32_bf16 v[192:195], a[96:99], v[72:75], v[192:195]
    v_mfma_f32_16x16x32_bf16 v[196:199], a[100:103], v[72:75], v[196:199]
    v_mfma_f32_16x16x32_bf16 v[200:203], a[104:107], v[72:75], v[200:203]
    v_mfma_f32_16x16x32_bf16 v[204:207], a[108:111], v[72:75], v[204:207]
    v_mfma_f32_16x16x32_bf16 v[208:211], a[112:115], v[72:75], v[208:211]
    v_exp_f32 v32, v32
    v_mfma_f32_16x16x32_bf16 v[212:215], a[116:119], v[72:75], v[212:215]
    v_exp_f32 v33, v33
    v_mfma_f32_16x16x32_bf16 v[216:219], a[120:123], v[72:75], v[216:219]
    v_cvt_pk_bf16_f32 v64, v32, v33
    v_add_f32 v12, v12, v32
    v_mfma_f32_16x16x32_bf16 v[220:223], a[124:127], v[72:75], v[220:223]
    v_exp_f32 v34, v34
    v_mfma_f32_16x16x32_bf16 v[40:43], a[64:67], a[164:167], v[84:87]
    s_waitcnt vmcnt(6) lgkmcnt(0)
    s_barrier
    v_mfma_f32_16x16x32_bf16 v[44:47], a[68:71], a[164:167], v[84:87]
    v_exp_f32 v35, v35
    v_mfma_f32_16x16x32_bf16 v[40:43], a[72:75], a[168:171], v[40:43]
    v_cvt_pk_bf16_f32 v65, v34, v35
    v_add_f32 v12, v12, v33
    v_mfma_f32_16x16x32_bf16 v[44:47], a[76:79], a[168:171], v[44:47]
    v_exp_f32 v36, v36
    v_mfma_f32_16x16x32_bf16 v[40:43], a[80:83], a[172:175], v[40:43]
    s_mov_b32 s41, 0
    v_exp_f32 v37, v37
    v_mfma_f32_16x16x32_bf16 v[44:47], a[84:87], a[172:175], v[44:47]
    buffer_store_dwordx4 a[0:3], v11, s[24:27], s41 offen offset:0 nt
    v_mfma_f32_16x16x32_bf16 v[40:43], a[88:91], a[176:179], v[40:43]
    v_cvt_pk_bf16_f32 v66, v36, v37
    v_add_f32 v12, v12, v34
    v_mfma_f32_16x16x32_bf16 v[44:47], a[92:95], a[176:179], v[44:47]
    v_exp_f32 v38, v38
    v_mfma_f32_16x16x32_bf16 v[224:227], a[96:99], v[76:79], v[224:227]
    ds_read_b64_tr_b16 a[96:97], v6 offset:0
    ds_read_b64_tr_b16 a[98:99], v6 offset:8256
    v_mfma_f32_16x16x32_bf16 v[228:231], a[100:103], v[76:79], v[228:231]
    ds_read_b64_tr_b16 a[100:101], v6 offset:32
    ds_read_b64_tr_b16 a[102:103], v6 offset:8288
    v_mfma_f32_16x16x32_bf16 v[232:235], a[104:107], v[76:79], v[232:235]
    ds_read_b64_tr_b16 a[104:105], v6 offset:256
    ds_read_b64_tr_b16 a[106:107], v6 offset:8512
    v_mfma_f32_16x16x32_bf16 v[236:239], a[108:111], v[76:79], v[236:239]
    ds_read_b64_tr_b16 a[108:109], v6 offset:288
    ds_read_b64_tr_b16 a[110:111], v6 offset:8544
    v_mfma_f32_16x16x32_bf16 v[240:243], a[112:115], v[76:79], v[240:243]
    ds_read_b64_tr_b16 a[112:113], v6 offset:512
    ds_read_b64_tr_b16 a[114:115], v6 offset:8768
    v_mfma_f32_16x16x32_bf16 v[244:247], a[116:119], v[76:79], v[244:247]
    v_exp_f32 v39, v39
    v_mfma_f32_16x16x32_bf16 v[248:251], a[120:123], v[76:79], v[248:251]
    ds_read_b64_tr_b16 a[116:117], v6 offset:544
    v_cvt_pk_bf16_f32 v67, v38, v39
    v_mfma_f32_16x16x32_bf16 v[252:255], a[124:127], v[76:79], v[252:255]
    ds_read_b64_tr_b16 a[118:119], v6 offset:8800
    v_add_f32 v12, v12, v35
    v_mfma_f32_16x16x32_bf16 a[144:147], a[128:131], v[76:79], a[144:147]
    ds_read_b64_tr_b16 a[120:121], v6 offset:768
    ds_read_b64_tr_b16 a[122:123], v6 offset:9024
    v_mfma_f32_16x16x32_bf16 v[48:51], a[64:67], a[180:183], v[88:91]
    ds_read_b64_tr_b16 a[124:125], v6 offset:800
    ds_read_b64_tr_b16 a[126:127], v6 offset:9056
    v_mfma_f32_16x16x32_bf16 v[52:55], a[68:71], a[180:183], v[88:91]
    buffer_store_dwordx4 a[4:7], v11, s[24:27], s41 offen offset:1024 nt
    v_mfma_f32_16x16x32_bf16 v[48:51], a[72:75], a[184:187], v[48:51]
    v_exp_f32 v40, v40
    v_mfma_f32_16x16x32_bf16 v[52:55], a[76:79], a[184:187], v[52:55]
    v_exp_f32 v41, v41
    v_mfma_f32_16x16x32_bf16 v[48:51], a[80:83], a[188:191], v[48:51]
    v_add_f32 v12, v12, v36
    v_add_f32 v12, v12, v37
    v_mfma_f32_16x16x32_bf16 v[52:55], a[84:87], a[188:191], v[52:55]
    v_cvt_pk_bf16_f32 v68, v40, v41
    v_add_f32 v12, v12, v38
    v_mfma_f32_16x16x32_bf16 v[48:51], a[88:91], a[192:195], v[48:51]
    v_exp_f32 v42, v42
    v_mfma_f32_16x16x32_bf16 v[52:55], a[92:95], a[192:195], v[52:55]
    s_waitcnt lgkmcnt(0)
    v_exp_f32 v43, v43
    v_mfma_f32_16x16x32_bf16 v[128:131], a[96:99], v[64:67], v[128:131]
    v_add_f32 v12, v12, v39
    v_cvt_pk_bf16_f32 v69, v42, v43
    v_mfma_f32_16x16x32_bf16 v[132:135], a[100:103], v[64:67], v[132:135]
    v_exp_f32 v44, v44
    v_mfma_f32_16x16x32_bf16 v[136:139], a[104:107], v[64:67], v[136:139]
    v_exp_f32 v45, v45
    v_mfma_f32_16x16x32_bf16 v[140:143], a[108:111], v[64:67], v[140:143]
    v_exp_f32 v46, v46
    v_mfma_f32_16x16x32_bf16 v[144:147], a[112:115], v[64:67], v[144:147]
    v_exp_f32 v47, v47
    v_mfma_f32_16x16x32_bf16 v[148:151], a[116:119], v[64:67], v[148:151]
    v_cvt_pk_bf16_f32 v70, v44, v45
    v_cvt_pk_bf16_f32 v71, v46, v47
    v_mfma_f32_16x16x32_bf16 v[152:155], a[120:123], v[64:67], v[152:155]
    v_exp_f32 v48, v48
    v_mfma_f32_16x16x32_bf16 v[156:159], a[124:127], v[64:67], v[156:159]
    buffer_store_dwordx4 a[8:11], v11, s[24:27], s41 offen offset:2048 nt
    v_mfma_f32_16x16x32_bf16 v[56:59], a[64:67], a[196:199], v[92:95]
    ds_read_b128 a[64:67], v4 offset:0
    v_add_f32 v14, v14, v48
    v_mfma_f32_16x16x32_bf16 v[60:63], a[68:71], a[196:199], v[92:95]
    v_exp_f32 v49, v49
    v_mfma_f32_16x16x32_bf16 v[56:59], a[72:75], a[200:203], v[56:59]
    ds_read_b128 a[68:71], v4 offset:8256
    ds_read_b128 a[72:75], v4 offset:256
    v_mfma_f32_16x16x32_bf16 v[60:63], a[76:79], a[200:203], v[60:63]
    ds_read_b128 a[76:79], v4 offset:8512
    v_cvt_pk_bf16_f32 v72, v48, v49
    v_mfma_f32_16x16x32_bf16 v[56:59], a[80:83], a[204:207], v[56:59]
    ds_read_b128 a[80:83], v4 offset:512
    v_add_f32 v14, v14, v49
    v_mfma_f32_16x16x32_bf16 v[60:63], a[84:87], a[204:207], v[60:63]
    v_exp_f32 v50, v50
    v_mfma_f32_16x16x32_bf16 v[56:59], a[88:91], a[208:211], v[56:59]
    ds_read_b128 a[84:87], v4 offset:8768
    ds_read_b128 a[88:91], v4 offset:768
    v_mfma_f32_16x16x32_bf16 v[60:63], a[92:95], a[208:211], v[60:63]
    v_exp_f32 v51, v51
    v_mfma_f32_16x16x32_bf16 v[160:163], a[96:99], v[68:71], v[160:163]
    ds_read_b128 a[92:95], v4 offset:9024
    v_cvt_pk_bf16_f32 v73, v50, v51
    v_mfma_f32_16x16x32_bf16 v[164:167], a[100:103], v[68:71], v[164:167]
    v_exp_f32 v52, v52
    v_mfma_f32_16x16x32_bf16 v[168:171], a[104:107], v[68:71], v[168:171]
    v_exp_f32 v53, v53
    v_mfma_f32_16x16x32_bf16 v[172:175], a[108:111], v[68:71], v[172:175]
    v_cvt_pk_bf16_f32 v74, v52, v53
    v_add_f32 v14, v14, v50
    v_mfma_f32_16x16x32_bf16 v[176:179], a[112:115], v[68:71], v[176:179]
    buffer_store_dwordx4 a[12:15], v11, s[24:27], s41 offen offset:3072 nt
    v_mfma_f32_16x16x32_bf16 v[180:183], a[116:119], v[68:71], v[180:183]
    v_exp_f32 v54, v54
    v_mfma_f32_16x16x32_bf16 v[184:187], a[120:123], v[68:71], v[184:187]
    v_exp_f32 v55, v55
    v_mfma_f32_16x16x32_bf16 v[188:191], a[124:127], v[68:71], v[188:191]
    v_cvt_pk_bf16_f32 v75, v54, v55
    v_add_f32 v14, v14, v51
    v_mfma_f32_16x16x32_bf16 a[136:139], a[128:131], v[68:71], a[136:139]
    s_waitcnt lgkmcnt(0)
    v_exp_f32 v56, v56
    v_mfma_f32_16x16x32_bf16 v[32:35], a[64:67], a[148:151], v[80:83]
    v_exp_f32 v57, v57
    v_mfma_f32_16x16x32_bf16 v[36:39], a[68:71], a[148:151], v[80:83]
    v_add_f32 v14, v14, v52
    v_add_f32 v14, v14, v53
    v_mfma_f32_16x16x32_bf16 v[32:35], a[72:75], a[152:155], v[32:35]
    v_cvt_pk_bf16_f32 v76, v56, v57
    v_add_f32 v14, v14, v54
    v_mfma_f32_16x16x32_bf16 v[36:39], a[76:79], a[152:155], v[36:39]
    v_exp_f32 v58, v58
    v_mfma_f32_16x16x32_bf16 v[32:35], a[80:83], a[156:159], v[32:35]
    v_exp_f32 v59, v59
    v_mfma_f32_16x16x32_bf16 v[36:39], a[84:87], a[156:159], v[36:39]
    v_add_f32 v14, v14, v55
    v_cvt_pk_bf16_f32 v77, v58, v59
    v_mfma_f32_16x16x32_bf16 v[32:35], a[88:91], a[160:163], v[32:35]
    v_exp_f32 v60, v60
    v_mfma_f32_16x16x32_bf16 v[36:39], a[92:95], a[160:163], v[36:39]
    v_exp_f32 v61, v61
    v_mfma_f32_16x16x32_bf16 v[192:195], a[96:99], v[72:75], v[192:195]
    v_exp_f32 v62, v62
    v_mfma_f32_16x16x32_bf16 v[196:199], a[100:103], v[72:75], v[196:199]
    v_exp_f32 v63, v63
    v_mfma_f32_16x16x32_bf16 v[200:203], a[104:107], v[72:75], v[200:203]
    v_cvt_pk_bf16_f32 v78, v60, v61
    v_cvt_pk_bf16_f32 v79, v62, v63
    v_mfma_f32_16x16x32_bf16 v[204:207], a[108:111], v[72:75], v[204:207]
    v_mfma_f32_16x16x32_bf16 v[208:211], a[112:115], v[72:75], v[208:211]
    v_exp_f32 v32, v32
    v_mfma_f32_16x16x32_bf16 v[212:215], a[116:119], v[72:75], v[212:215]
    v_exp_f32 v33, v33
    v_mfma_f32_16x16x32_bf16 v[216:219], a[120:123], v[72:75], v[216:219]
    v_cvt_pk_bf16_f32 v64, v32, v33
    v_add_f32 v12, v12, v32
    v_mfma_f32_16x16x32_bf16 v[220:223], a[124:127], v[72:75], v[220:223]
    v_exp_f32 v34, v34
    v_mfma_f32_16x16x32_bf16 v[40:43], a[64:67], a[164:167], v[84:87]
    v_exp_f32 v35, v35
    v_mfma_f32_16x16x32_bf16 v[44:47], a[68:71], a[164:167], v[84:87]
    v_cvt_pk_bf16_f32 v65, v34, v35
    v_add_f32 v12, v12, v33
    v_mfma_f32_16x16x32_bf16 v[40:43], a[72:75], a[168:171], v[40:43]
    v_exp_f32 v36, v36
    v_mfma_f32_16x16x32_bf16 v[44:47], a[76:79], a[168:171], v[44:47]
    v_exp_f32 v37, v37
    v_mfma_f32_16x16x32_bf16 v[40:43], a[80:83], a[172:175], v[40:43]
    s_mov_b32 s41, 4096
    v_cvt_pk_bf16_f32 v66, v36, v37
    v_add_f32 v12, v12, v34
    v_mfma_f32_16x16x32_bf16 v[44:47], a[84:87], a[172:175], v[44:47]
    buffer_store_dwordx4 a[16:19], v11, s[24:27], s41 offen offset:0 nt
    v_mfma_f32_16x16x32_bf16 v[40:43], a[88:91], a[176:179], v[40:43]
    v_exp_f32 v38, v38
    v_mfma_f32_16x16x32_bf16 v[44:47], a[92:95], a[176:179], v[44:47]
    v_exp_f32 v39, v39
    v_mfma_f32_16x16x32_bf16 v[224:227], a[96:99], v[76:79], v[224:227]
    ds_read_b64_tr_b16 a[96:97], v6 offset:16512
    ds_read_b64_tr_b16 a[98:99], v6 offset:24768
    v_mfma_f32_16x16x32_bf16 v[228:231], a[100:103], v[76:79], v[228:231]
    ds_read_b64_tr_b16 a[100:101], v6 offset:16544
    ds_read_b64_tr_b16 a[102:103], v6 offset:24800
    v_mfma_f32_16x16x32_bf16 v[232:235], a[104:107], v[76:79], v[232:235]
    ds_read_b64_tr_b16 a[104:105], v6 offset:16768
    ds_read_b64_tr_b16 a[106:107], v6 offset:25024
    v_mfma_f32_16x16x32_bf16 v[236:239], a[108:111], v[76:79], v[236:239]
    ds_read_b64_tr_b16 a[108:109], v6 offset:16800
    ds_read_b64_tr_b16 a[110:111], v6 offset:25056
    v_mfma_f32_16x16x32_bf16 v[240:243], a[112:115], v[76:79], v[240:243]
    ds_read_b64_tr_b16 a[112:113], v6 offset:17024
    ds_read_b64_tr_b16 a[114:115], v6 offset:25280
    v_mfma_f32_16x16x32_bf16 v[244:247], a[116:119], v[76:79], v[244:247]
    ds_read_b64_tr_b16 a[116:117], v6 offset:17056
    v_cvt_pk_bf16_f32 v67, v38, v39
    v_mfma_f32_16x16x32_bf16 v[248:251], a[120:123], v[76:79], v[248:251]
    ds_read_b64_tr_b16 a[118:119], v6 offset:25312
    v_add_f32 v12, v12, v35
    v_mfma_f32_16x16x32_bf16 v[252:255], a[124:127], v[76:79], v[252:255]
    ds_read_b64_tr_b16 a[120:121], v6 offset:17280
    ds_read_b64_tr_b16 a[122:123], v6 offset:25536
    v_mfma_f32_16x16x32_bf16 a[144:147], a[128:131], v[76:79], a[144:147]
    ds_read_b64_tr_b16 a[124:125], v6 offset:17312
    ds_read_b64_tr_b16 a[126:127], v6 offset:25568
    v_mfma_f32_16x16x32_bf16 v[48:51], a[64:67], a[180:183], v[88:91]
    v_exp_f32 v40, v40
    v_mfma_f32_16x16x32_bf16 v[52:55], a[68:71], a[180:183], v[88:91]
    buffer_store_dwordx4 a[20:23], v11, s[24:27], s41 offen offset:1024 nt
    v_mfma_f32_16x16x32_bf16 v[48:51], a[72:75], a[184:187], v[48:51]
    v_exp_f32 v41, v41
    v_mfma_f32_16x16x32_bf16 v[52:55], a[76:79], a[184:187], v[52:55]
    v_add_f32 v12, v12, v36
    v_add_f32 v12, v12, v37
    v_mfma_f32_16x16x32_bf16 v[48:51], a[80:83], a[188:191], v[48:51]
    v_cvt_pk_bf16_f32 v68, v40, v41
    v_add_f32 v12, v12, v38
    v_mfma_f32_16x16x32_bf16 v[52:55], a[84:87], a[188:191], v[52:55]
    v_exp_f32 v42, v42
    v_mfma_f32_16x16x32_bf16 v[48:51], a[88:91], a[192:195], v[48:51]
    v_exp_f32 v43, v43
    v_mfma_f32_16x16x32_bf16 v[52:55], a[92:95], a[192:195], v[52:55]
    s_waitcnt lgkmcnt(0)
    v_add_f32 v12, v12, v39
    v_cvt_pk_bf16_f32 v69, v42, v43
    v_mfma_f32_16x16x32_bf16 v[128:131], a[96:99], v[64:67], v[128:131]
    v_exp_f32 v44, v44
    v_mfma_f32_16x16x32_bf16 v[132:135], a[100:103], v[64:67], v[132:135]
    v_exp_f32 v45, v45
    v_mfma_f32_16x16x32_bf16 v[136:139], a[104:107], v[64:67], v[136:139]
    v_exp_f32 v46, v46
    v_mfma_f32_16x16x32_bf16 v[140:143], a[108:111], v[64:67], v[140:143]
    v_exp_f32 v47, v47
    v_mfma_f32_16x16x32_bf16 v[144:147], a[112:115], v[64:67], v[144:147]
    v_cvt_pk_bf16_f32 v70, v44, v45
    v_cvt_pk_bf16_f32 v71, v46, v47
    v_mfma_f32_16x16x32_bf16 v[148:151], a[116:119], v[64:67], v[148:151]
    v_exp_f32 v48, v48
    v_mfma_f32_16x16x32_bf16 v[152:155], a[120:123], v[64:67], v[152:155]
    v_exp_f32 v49, v49
    v_mfma_f32_16x16x32_bf16 v[156:159], a[124:127], v[64:67], v[156:159]
    buffer_store_dwordx4 a[24:27], v11, s[24:27], s41 offen offset:2048 nt
    v_mfma_f32_16x16x32_bf16 v[56:59], a[64:67], a[196:199], v[92:95]
    ds_read_b128 a[64:67], v4 offset:16512
    v_cvt_pk_bf16_f32 v72, v48, v49
    v_mfma_f32_16x16x32_bf16 v[60:63], a[68:71], a[196:199], v[92:95]
    ds_read_b128 a[68:71], v4 offset:24768
    v_add_f32 v14, v14, v48
    v_mfma_f32_16x16x32_bf16 v[56:59], a[72:75], a[200:203], v[56:59]
    ds_read_b128 a[72:75], v4 offset:16768
    v_add_f32 v14, v14, v49
    v_mfma_f32_16x16x32_bf16 v[60:63], a[76:79], a[200:203], v[60:63]
    v_exp_f32 v50, v50
    v_mfma_f32_16x16x32_bf16 v[56:59], a[80:83], a[204:207], v[56:59]
    ds_read_b128 a[76:79], v4 offset:25024
    ds_read_b128 a[80:83], v4 offset:17024
    v_mfma_f32_16x16x32_bf16 v[60:63], a[84:87], a[204:207], v[60:63]
    ds_read_b128 a[84:87], v4 offset:25280
    v_add_f32 v14, v14, v50
    v_mfma_f32_16x16x32_bf16 v[56:59], a[88:91], a[208:211], v[56:59]
    v_exp_f32 v51, v51
    v_mfma_f32_16x16x32_bf16 v[60:63], a[92:95], a[208:211], v[60:63]
    ds_read_b128 a[88:91], v4 offset:17280
    v_cvt_pk_bf16_f32 v73, v50, v51
    v_mfma_f32_16x16x32_bf16 v[160:163], a[96:99], v[68:71], v[160:163]
    ds_read_b128 a[92:95], v4 offset:25536
    v_add_f32 v14, v14, v51
    v_mfma_f32_16x16x32_bf16 v[164:167], a[100:103], v[68:71], v[164:167]
    v_exp_f32 v52, v52
    v_mfma_f32_16x16x32_bf16 v[168:171], a[104:107], v[68:71], v[168:171]
    v_exp_f32 v53, v53
    v_mfma_f32_16x16x32_bf16 v[172:175], a[108:111], v[68:71], v[172:175]
    v_cvt_pk_bf16_f32 v74, v52, v53
    v_add_f32 v14, v14, v52
    v_mfma_f32_16x16x32_bf16 v[176:179], a[112:115], v[68:71], v[176:179]
    buffer_store_dwordx4 a[28:31], v11, s[24:27], s41 offen offset:3072 nt
    v_mfma_f32_16x16x32_bf16 v[180:183], a[116:119], v[68:71], v[180:183]
    v_exp_f32 v54, v54
    v_mfma_f32_16x16x32_bf16 v[184:187], a[120:123], v[68:71], v[184:187]
    v_exp_f32 v55, v55
    v_mfma_f32_16x16x32_bf16 v[188:191], a[124:127], v[68:71], v[188:191]
    v_cvt_pk_bf16_f32 v75, v54, v55
    v_add_f32 v14, v14, v53
    v_mfma_f32_16x16x32_bf16 a[136:139], a[128:131], v[68:71], a[136:139]
    s_waitcnt lgkmcnt(0)
    v_exp_f32 v56, v56
    v_mfma_f32_16x16x32_bf16 v[32:35], a[64:67], a[148:151], v[80:83]
    v_exp_f32 v57, v57
    v_mfma_f32_16x16x32_bf16 v[36:39], a[68:71], a[148:151], v[80:83]
    v_cvt_pk_bf16_f32 v76, v56, v57
    v_add_f32 v14, v14, v54
    v_mfma_f32_16x16x32_bf16 v[32:35], a[72:75], a[152:155], v[32:35]
    v_exp_f32 v58, v58
    v_mfma_f32_16x16x32_bf16 v[36:39], a[76:79], a[152:155], v[36:39]
    v_exp_f32 v59, v59
    v_mfma_f32_16x16x32_bf16 v[32:35], a[80:83], a[156:159], v[32:35]
    v_add_f32 v14, v14, v55
    v_cvt_pk_bf16_f32 v77, v58, v59
    v_mfma_f32_16x16x32_bf16 v[36:39], a[84:87], a[156:159], v[36:39]
    v_exp_f32 v60, v60
    v_mfma_f32_16x16x32_bf16 v[32:35], a[88:91], a[160:163], v[32:35]
    v_exp_f32 v61, v61
    v_mfma_f32_16x16x32_bf16 v[36:39], a[92:95], a[160:163], v[36:39]
    v_exp_f32 v62, v62
    v_mfma_f32_16x16x32_bf16 v[192:195], a[96:99], v[72:75], v[192:195]
    v_exp_f32 v63, v63
    v_mfma_f32_16x16x32_bf16 v[196:199], a[100:103], v[72:75], v[196:199]
    v_cvt_pk_bf16_f32 v78, v60, v61
    v_cvt_pk_bf16_f32 v79, v62, v63
    v_mfma_f32_16x16x32_bf16 v[200:203], a[104:107], v[72:75], v[200:203]
    v_mfma_f32_16x16x32_bf16 v[204:207], a[108:111], v[72:75], v[204:207]
    v_mfma_f32_16x16x32_bf16 v[208:211], a[112:115], v[72:75], v[208:211]
    v_exp_f32 v32, v32
    v_mfma_f32_16x16x32_bf16 v[212:215], a[116:119], v[72:75], v[212:215]
    v_exp_f32 v33, v33
    v_mfma_f32_16x16x32_bf16 v[216:219], a[120:123], v[72:75], v[216:219]
    v_cvt_pk_bf16_f32 v64, v32, v33
    v_add_f32 v12, v12, v32
    v_mfma_f32_16x16x32_bf16 v[220:223], a[124:127], v[72:75], v[220:223]
    v_exp_f32 v34, v34
    v_mfma_f32_16x16x32_bf16 v[40:43], a[64:67], a[164:167], v[84:87]
    s_waitcnt vmcnt(8) lgkmcnt(0)
    s_barrier
    v_mfma_f32_16x16x32_bf16 v[44:47], a[68:71], a[164:167], v[84:87]
    v_exp_f32 v35, v35
    v_mfma_f32_16x16x32_bf16 v[40:43], a[72:75], a[168:171], v[40:43]
    v_cvt_pk_bf16_f32 v65, v34, v35
    v_add_f32 v12, v12, v33
    v_mfma_f32_16x16x32_bf16 v[44:47], a[76:79], a[168:171], v[44:47]
    v_exp_f32 v36, v36
    v_mfma_f32_16x16x32_bf16 v[40:43], a[80:83], a[172:175], v[40:43]
    s_mov_b32 s41, 8192
    v_exp_f32 v37, v37
    v_mfma_f32_16x16x32_bf16 v[44:47], a[84:87], a[172:175], v[44:47]
    buffer_store_dwordx4 a[32:35], v11, s[24:27], s41 offen offset:0 nt
    v_mfma_f32_16x16x32_bf16 v[40:43], a[88:91], a[176:179], v[40:43]
    v_cvt_pk_bf16_f32 v66, v36, v37
    v_add_f32 v12, v12, v34
    v_mfma_f32_16x16x32_bf16 v[44:47], a[92:95], a[176:179], v[44:47]
    v_exp_f32 v38, v38
    v_mfma_f32_16x16x32_bf16 v[224:227], a[96:99], v[76:79], v[224:227]
    ds_read_b64_tr_b16 a[96:97], v6 offset:33024
    ds_read_b64_tr_b16 a[98:99], v6 offset:41280
    v_mfma_f32_16x16x32_bf16 v[228:231], a[100:103], v[76:79], v[228:231]
    ds_read_b64_tr_b16 a[100:101], v6 offset:33056
    ds_read_b64_tr_b16 a[102:103], v6 offset:41312
    v_mfma_f32_16x16x32_bf16 v[232:235], a[104:107], v[76:79], v[232:235]
    ds_read_b64_tr_b16 a[104:105], v6 offset:33280
    ds_read_b64_tr_b16 a[106:107], v6 offset:41536
    v_mfma_f32_16x16x32_bf16 v[236:239], a[108:111], v[76:79], v[236:239]
    ds_read_b64_tr_b16 a[108:109], v6 offset:33312
    ds_read_b64_tr_b16 a[110:111], v6 offset:41568
    v_mfma_f32_16x16x32_bf16 v[240:243], a[112:115], v[76:79], v[240:243]
    ds_read_b64_tr_b16 a[112:113], v6 offset:33536
    ds_read_b64_tr_b16 a[114:115], v6 offset:41792
    v_mfma_f32_16x16x32_bf16 v[244:247], a[116:119], v[76:79], v[244:247]
    v_exp_f32 v39, v39
    v_mfma_f32_16x16x32_bf16 v[248:251], a[120:123], v[76:79], v[248:251]
    ds_read_b64_tr_b16 a[116:117], v6 offset:33568
    v_cvt_pk_bf16_f32 v67, v38, v39
    v_mfma_f32_16x16x32_bf16 v[252:255], a[124:127], v[76:79], v[252:255]
    ds_read_b64_tr_b16 a[118:119], v6 offset:41824
    v_add_f32 v12, v12, v35
    v_mfma_f32_16x16x32_bf16 a[144:147], a[128:131], v[76:79], a[144:147]
    ds_read_b64_tr_b16 a[120:121], v6 offset:33792
    ds_read_b64_tr_b16 a[122:123], v6 offset:42048
    v_mfma_f32_16x16x32_bf16 v[48:51], a[64:67], a[180:183], v[88:91]
    ds_read_b64_tr_b16 a[124:125], v6 offset:33824
    ds_read_b64_tr_b16 a[126:127], v6 offset:42080
    v_mfma_f32_16x16x32_bf16 v[52:55], a[68:71], a[180:183], v[88:91]
    buffer_store_dwordx4 a[36:39], v11, s[24:27], s41 offen offset:1024 nt
    v_mfma_f32_16x16x32_bf16 v[48:51], a[72:75], a[184:187], v[48:51]
    v_exp_f32 v40, v40
    v_mfma_f32_16x16x32_bf16 v[52:55], a[76:79], a[184:187], v[52:55]
    v_exp_f32 v41, v41
    v_mfma_f32_16x16x32_bf16 v[48:51], a[80:83], a[188:191], v[48:51]
    v_add_f32 v12, v12, v36
    v_add_f32 v12, v12, v37
    v_mfma_f32_16x16x32_bf16 v[52:55], a[84:87], a[188:191], v[52:55]
    v_cvt_pk_bf16_f32 v68, v40, v41
    v_add_f32 v12, v12, v38
    v_mfma_f32_16x16x32_bf16 v[48:51], a[88:91], a[192:195], v[48:51]
    v_exp_f32 v42, v42
    v_mfma_f32_16x16x32_bf16 v[52:55], a[92:95], a[192:195], v[52:55]
    s_waitcnt lgkmcnt(0)
    v_exp_f32 v43, v43
    v_mfma_f32_16x16x32_bf16 v[128:131], a[96:99], v[64:67], v[128:131]
    v_add_f32 v12, v12, v39
    v_cvt_pk_bf16_f32 v69, v42, v43
    v_mfma_f32_16x16x32_bf16 v[132:135], a[100:103], v[64:67], v[132:135]
    v_exp_f32 v44, v44
    v_mfma_f32_16x16x32_bf16 v[136:139], a[104:107], v[64:67], v[136:139]
    v_exp_f32 v45, v45
    v_mfma_f32_16x16x32_bf16 v[140:143], a[108:111], v[64:67], v[140:143]
    v_exp_f32 v46, v46
    v_mfma_f32_16x16x32_bf16 v[144:147], a[112:115], v[64:67], v[144:147]
    v_exp_f32 v47, v47
    v_mfma_f32_16x16x32_bf16 v[148:151], a[116:119], v[64:67], v[148:151]
    v_cvt_pk_bf16_f32 v70, v44, v45
    v_cvt_pk_bf16_f32 v71, v46, v47
    v_mfma_f32_16x16x32_bf16 v[152:155], a[120:123], v[64:67], v[152:155]
    v_exp_f32 v48, v48
    v_mfma_f32_16x16x32_bf16 v[156:159], a[124:127], v[64:67], v[156:159]
    buffer_store_dwordx4 a[40:43], v11, s[24:27], s41 offen offset:2048 nt
    v_mfma_f32_16x16x32_bf16 v[56:59], a[64:67], a[196:199], v[92:95]
    ds_read_b128 a[64:67], v4 offset:33024
    v_add_f32 v14, v14, v48
    v_mfma_f32_16x16x32_bf16 v[60:63], a[68:71], a[196:199], v[92:95]
    v_exp_f32 v49, v49
    v_mfma_f32_16x16x32_bf16 v[56:59], a[72:75], a[200:203], v[56:59]
    ds_read_b128 a[68:71], v4 offset:41280
    ds_read_b128 a[72:75], v4 offset:33280
    v_mfma_f32_16x16x32_bf16 v[60:63], a[76:79], a[200:203], v[60:63]
    ds_read_b128 a[76:79], v4 offset:41536
    v_cvt_pk_bf16_f32 v72, v48, v49
    v_mfma_f32_16x16x32_bf16 v[56:59], a[80:83], a[204:207], v[56:59]
    ds_read_b128 a[80:83], v4 offset:33536
    v_add_f32 v14, v14, v49
    v_mfma_f32_16x16x32_bf16 v[60:63], a[84:87], a[204:207], v[60:63]
    v_exp_f32 v50, v50
    v_mfma_f32_16x16x32_bf16 v[56:59], a[88:91], a[208:211], v[56:59]
    ds_read_b128 a[84:87], v4 offset:41792
    ds_read_b128 a[88:91], v4 offset:33792
    v_mfma_f32_16x16x32_bf16 v[60:63], a[92:95], a[208:211], v[60:63]
    v_exp_f32 v51, v51
    v_mfma_f32_16x16x32_bf16 v[160:163], a[96:99], v[68:71], v[160:163]
    ds_read_b128 a[92:95], v4 offset:42048
    v_cvt_pk_bf16_f32 v73, v50, v51
    v_mfma_f32_16x16x32_bf16 v[164:167], a[100:103], v[68:71], v[164:167]
    v_exp_f32 v52, v52
    v_mfma_f32_16x16x32_bf16 v[168:171], a[104:107], v[68:71], v[168:171]
    v_exp_f32 v53, v53
    v_mfma_f32_16x16x32_bf16 v[172:175], a[108:111], v[68:71], v[172:175]
    v_cvt_pk_bf16_f32 v74, v52, v53
    v_add_f32 v14, v14, v50
    v_mfma_f32_16x16x32_bf16 v[176:179], a[112:115], v[68:71], v[176:179]
    buffer_store_dwordx4 a[44:47], v11, s[24:27], s41 offen offset:3072 nt
    v_mfma_f32_16x16x32_bf16 v[180:183], a[116:119], v[68:71], v[180:183]
    s_mov_b32 s41, 12288
    v_exp_f32 v54, v54
    v_mfma_f32_16x16x32_bf16 v[184:187], a[120:123], v[68:71], v[184:187]
    buffer_store_dwordx4 a[48:51], v11, s[24:27], s41 offen offset:0 nt
    v_mfma_f32_16x16x32_bf16 v[188:191], a[124:127], v[68:71], v[188:191]
    buffer_store_dwordx4 a[52:55], v11, s[24:27], s41 offen offset:1024 nt
    v_mfma_f32_16x16x32_bf16 a[136:139], a[128:131], v[68:71], a[136:139]
    s_waitcnt lgkmcnt(0)
    buffer_store_dwordx4 a[56:59], v11, s[24:27], s41 offen offset:2048 nt
    v_mfma_f32_16x16x32_bf16 v[32:35], a[64:67], a[148:151], v[80:83]
    buffer_store_dwordx4 a[60:63], v11, s[24:27], s41 offen offset:3072 nt
    v_mfma_f32_16x16x32_bf16 v[36:39], a[68:71], a[148:151], v[80:83]
    v_exp_f32 v55, v55
    v_mfma_f32_16x16x32_bf16 v[32:35], a[72:75], a[152:155], v[32:35]
    v_cvt_pk_bf16_f32 v75, v54, v55
    v_add_f32 v14, v14, v51
    v_mfma_f32_16x16x32_bf16 v[36:39], a[76:79], a[152:155], v[36:39]
    v_exp_f32 v56, v56
    v_mfma_f32_16x16x32_bf16 v[32:35], a[80:83], a[156:159], v[32:35]
    v_exp_f32 v57, v57
    v_mfma_f32_16x16x32_bf16 v[36:39], a[84:87], a[156:159], v[36:39]
    v_add_f32 v14, v14, v52
    v_add_f32 v14, v14, v53
    v_mfma_f32_16x16x32_bf16 v[32:35], a[88:91], a[160:163], v[32:35]
    v_cvt_pk_bf16_f32 v76, v56, v57
    v_add_f32 v14, v14, v54
    v_mfma_f32_16x16x32_bf16 v[36:39], a[92:95], a[160:163], v[36:39]
    v_exp_f32 v58, v58
    v_mfma_f32_16x16x32_bf16 v[192:195], a[96:99], v[72:75], v[192:195]
    v_exp_f32 v59, v59
    v_mfma_f32_16x16x32_bf16 v[196:199], a[100:103], v[72:75], v[196:199]
    v_add_f32 v14, v14, v55
    v_cvt_pk_bf16_f32 v77, v58, v59
    v_mfma_f32_16x16x32_bf16 v[200:203], a[104:107], v[72:75], v[200:203]
    v_exp_f32 v60, v60
    v_mfma_f32_16x16x32_bf16 v[204:207], a[108:111], v[72:75], v[204:207]
    v_exp_f32 v61, v61
    v_mfma_f32_16x16x32_bf16 v[208:211], a[112:115], v[72:75], v[208:211]
    v_exp_f32 v62, v62
    v_mfma_f32_16x16x32_bf16 v[212:215], a[116:119], v[72:75], v[212:215]
    v_exp_f32 v63, v63
    v_mfma_f32_16x16x32_bf16 v[216:219], a[120:123], v[72:75], v[216:219]
    v_cvt_pk_bf16_f32 v78, v60, v61
    v_cvt_pk_bf16_f32 v79, v62, v63
    v_mfma_f32_16x16x32_bf16 v[220:223], a[124:127], v[72:75], v[220:223]
    v_exp_f32 v32, v32
    v_mfma_f32_16x16x32_bf16 v[40:43], a[64:67], a[164:167], v[84:87]
    v_exp_f32 v33, v33
    v_mfma_f32_16x16x32_bf16 v[44:47], a[68:71], a[164:167], v[84:87]
    v_cvt_pk_bf16_f32 v64, v32, v33
    v_add_f32 v12, v12, v32
    v_mfma_f32_16x16x32_bf16 v[40:43], a[72:75], a[168:171], v[40:43]
    v_exp_f32 v34, v34
    v_mfma_f32_16x16x32_bf16 v[44:47], a[76:79], a[168:171], v[44:47]
    v_exp_f32 v35, v35
    v_mfma_f32_16x16x32_bf16 v[40:43], a[80:83], a[172:175], v[40:43]
    v_cvt_pk_bf16_f32 v65, v34, v35
    v_add_f32 v12, v12, v33
    v_mfma_f32_16x16x32_bf16 v[44:47], a[84:87], a[172:175], v[44:47]
    v_exp_f32 v36, v36
    v_mfma_f32_16x16x32_bf16 v[40:43], a[88:91], a[176:179], v[40:43]
    v_exp_f32 v37, v37
    v_mfma_f32_16x16x32_bf16 v[44:47], a[92:95], a[176:179], v[44:47]
    v_cvt_pk_bf16_f32 v66, v36, v37
    v_add_f32 v12, v12, v34
    v_mfma_f32_16x16x32_bf16 v[224:227], a[96:99], v[76:79], v[224:227]
    ds_read_b64_tr_b16 a[96:97], v6 offset:49536
    ds_read_b64_tr_b16 a[98:99], v6 offset:57792
    v_mfma_f32_16x16x32_bf16 v[228:231], a[100:103], v[76:79], v[228:231]
    ds_read_b64_tr_b16 a[100:101], v6 offset:49568
    ds_read_b64_tr_b16 a[102:103], v6 offset:57824
    v_mfma_f32_16x16x32_bf16 v[232:235], a[104:107], v[76:79], v[232:235]
    ds_read_b64_tr_b16 a[104:105], v6 offset:49792
    ds_read_b64_tr_b16 a[106:107], v6 offset:58048
    v_mfma_f32_16x16x32_bf16 v[236:239], a[108:111], v[76:79], v[236:239]
    ds_read_b64_tr_b16 a[108:109], v6 offset:49824
    ds_read_b64_tr_b16 a[110:111], v6 offset:58080
    v_mfma_f32_16x16x32_bf16 v[240:243], a[112:115], v[76:79], v[240:243]
    v_exp_f32 v38, v38
    v_mfma_f32_16x16x32_bf16 v[244:247], a[116:119], v[76:79], v[244:247]
    ds_read_b64_tr_b16 a[112:113], v6 offset:50048
    ds_read_b64_tr_b16 a[114:115], v6 offset:58304
    v_mfma_f32_16x16x32_bf16 v[248:251], a[120:123], v[76:79], v[248:251]
    v_exp_f32 v39, v39
    v_mfma_f32_16x16x32_bf16 v[252:255], a[124:127], v[76:79], v[252:255]
    ds_read_b64_tr_b16 a[116:117], v6 offset:50080
    v_cvt_pk_bf16_f32 v67, v38, v39
    v_mfma_f32_16x16x32_bf16 a[144:147], a[128:131], v[76:79], a[144:147]
    ds_read_b64_tr_b16 a[118:119], v6 offset:58336
    v_add_f32 v12, v12, v35
    v_mfma_f32_16x16x32_bf16 v[48:51], a[64:67], a[180:183], v[88:91]
    ds_read_b64_tr_b16 a[120:121], v6 offset:50304
    ds_read_b64_tr_b16 a[122:123], v6 offset:58560
    v_mfma_f32_16x16x32_bf16 v[52:55], a[68:71], a[180:183], v[88:91]
    ds_read_b64_tr_b16 a[124:125], v6 offset:50336
    ds_read_b64_tr_b16 a[126:127], v6 offset:58592
    v_mfma_f32_16x16x32_bf16 v[48:51], a[72:75], a[184:187], v[48:51]
    v_exp_f32 v40, v40
    v_mfma_f32_16x16x32_bf16 v[52:55], a[76:79], a[184:187], v[52:55]
    v_exp_f32 v41, v41
    v_mfma_f32_16x16x32_bf16 v[48:51], a[80:83], a[188:191], v[48:51]
    v_add_f32 v12, v12, v36
    v_add_f32 v12, v12, v37
    v_mfma_f32_16x16x32_bf16 v[52:55], a[84:87], a[188:191], v[52:55]
    v_cvt_pk_bf16_f32 v68, v40, v41
    v_add_f32 v12, v12, v38
    v_mfma_f32_16x16x32_bf16 v[48:51], a[88:91], a[192:195], v[48:51]
    v_exp_f32 v42, v42
    v_mfma_f32_16x16x32_bf16 v[52:55], a[92:95], a[192:195], v[52:55]
    s_waitcnt lgkmcnt(0)
    v_exp_f32 v43, v43
    v_mfma_f32_16x16x32_bf16 v[128:131], a[96:99], v[64:67], v[128:131]
    v_add_f32 v12, v12, v39
    v_cvt_pk_bf16_f32 v69, v42, v43
    v_mfma_f32_16x16x32_bf16 v[132:135], a[100:103], v[64:67], v[132:135]
    v_exp_f32 v44, v44
    v_mfma_f32_16x16x32_bf16 v[136:139], a[104:107], v[64:67], v[136:139]
    v_exp_f32 v45, v45
    v_mfma_f32_16x16x32_bf16 v[140:143], a[108:111], v[64:67], v[140:143]
    v_cvt_pk_bf16_f32 v70, v44, v45
    v_mov_b32 v17, v12
    v_mfma_f32_16x16x32_bf16 v[144:147], a[112:115], v[64:67], v[144:147]
    v_exp_f32 v46, v46
    v_mfma_f32_16x16x32_bf16 v[148:151], a[116:119], v[64:67], v[148:151]
    v_exp_f32 v47, v47
    v_mfma_f32_16x16x32_bf16 v[152:155], a[120:123], v[64:67], v[152:155]
    v_mov_b32 v16, v17
    v_cvt_pk_bf16_f32 v71, v46, v47
    v_mfma_f32_16x16x32_bf16 v[156:159], a[124:127], v[64:67], v[156:159]
    v_exp_f32 v48, v48
    v_permlane16_swap_b32 v17, v16
    v_add_f32 v17, v17, v16
    v_mfma_f32_16x16x32_bf16 v[56:59], a[64:67], a[196:199], v[92:95]
    v_mov_b32 v16, v17
    v_add_f32 v14, v14, v48
    v_mfma_f32_16x16x32_bf16 v[60:63], a[68:71], a[196:199], v[92:95]
    v_permlane32_swap_b32 v17, v16
    v_add_f32 v17, v17, v16
    v_mfma_f32_16x16x32_bf16 v[56:59], a[72:75], a[200:203], v[56:59]
    v_exp_f32 v49, v49
    v_mfma_f32_16x16x32_bf16 v[60:63], a[76:79], a[200:203], v[60:63]
    v_rcp_f32 v16, v17
    v_mfma_f32_16x16x32_bf16 v[56:59], a[80:83], a[204:207], v[56:59]
    s_mov_b32 s41, 65536
    v_cmp_nle_f32 s[48:49], v17, s40
    s_or_b64 s[46:47], s[46:47], s[48:49]
    v_mfma_f32_16x16x32_bf16 v[60:63], a[84:87], a[204:207], v[60:63]
    v_mul_f32 v128, v128, v16
    v_mul_f32 v129, v129, v16
    v_mul_f32 v130, v130, v16
    v_mul_f32 v131, v131, v16
    v_cvt_pk_bf16_f32 v96, v128, v129
    v_cvt_pk_bf16_f32 v97, v130, v131
    v_pk_mul_f32 v[132:133], v[132:133], v[16:17] op_sel_hi:[1,0]
    v_pk_mul_f32 v[134:135], v[134:135], v[16:17] op_sel_hi:[1,0]
    v_pk_mul_f32 v[136:137], v[136:137], v[16:17] op_sel_hi:[1,0]
    v_pk_mul_f32 v[138:139], v[138:139], v[16:17] op_sel_hi:[1,0]
    v_pk_mul_f32 v[140:141], v[140:141], v[16:17] op_sel_hi:[1,0]
    v_pk_mul_f32 v[142:143], v[142:143], v[16:17] op_sel_hi:[1,0]
    v_cvt_pk_bf16_f32 v98, v132, v133
    v_cvt_pk_bf16_f32 v99, v134, v135
    v_cvt_pk_bf16_f32 v100, v136, v137
    v_cvt_pk_bf16_f32 v101, v138, v139
    v_cvt_pk_bf16_f32 v102, v140, v141
    v_cvt_pk_bf16_f32 v103, v142, v143
    v_mfma_f32_16x16x32_bf16 v[56:59], a[88:91], a[208:211], v[56:59]
    v_cvt_pk_bf16_f32 v72, v48, v49
    v_add_f32 v14, v14, v49
    v_mfma_f32_16x16x32_bf16 v[60:63], a[92:95], a[208:211], v[60:63]
    ds_write2_b64 v9, v[96:97], v[98:99] offset0:0 offset1:4
    v_mfma_f32_16x16x32_bf16 v[160:163], a[96:99], v[68:71], v[160:163]
    ds_write2_b64 v9, v[100:101], v[102:103] offset0:8 offset1:12
    v_mfma_f32_16x16x32_bf16 v[164:167], a[100:103], v[68:71], v[164:167]
    v_exp_f32 v50, v50
    v_mfma_f32_16x16x32_bf16 v[168:171], a[104:107], v[68:71], v[168:171]
    v_exp_f32 v51, v51
    v_mfma_f32_16x16x32_bf16 v[172:175], a[108:111], v[68:71], v[172:175]
    v_cvt_pk_bf16_f32 v73, v50, v51
    v_add_f32 v14, v14, v50
    v_mfma_f32_16x16x32_bf16 v[176:179], a[112:115], v[68:71], v[176:179]
    v_mul_f32 v144, v144, v16
    v_mul_f32 v145, v145, v16
    v_mul_f32 v146, v146, v16
    v_mul_f32 v147, v147, v16
    v_cvt_pk_bf16_f32 v104, v144, v145
    v_cvt_pk_bf16_f32 v105, v146, v147
    v_pk_mul_f32 v[148:149], v[148:149], v[16:17] op_sel_hi:[1,0]
    v_pk_mul_f32 v[150:151], v[150:151], v[16:17] op_sel_hi:[1,0]
    v_pk_mul_f32 v[152:153], v[152:153], v[16:17] op_sel_hi:[1,0]
    v_pk_mul_f32 v[154:155], v[154:155], v[16:17] op_sel_hi:[1,0]
    v_pk_mul_f32 v[156:157], v[156:157], v[16:17] op_sel_hi:[1,0]
    v_pk_mul_f32 v[158:159], v[158:159], v[16:17] op_sel_hi:[1,0]
    v_cvt_pk_bf16_f32 v106, v148, v149
    v_cvt_pk_bf16_f32 v107, v150, v151
    v_cvt_pk_bf16_f32 v108, v152, v153
    v_cvt_pk_bf16_f32 v109, v154, v155
    v_cvt_pk_bf16_f32 v110, v156, v157
    v_cvt_pk_bf16_f32 v111, v158, v159
    v_mfma_f32_16x16x32_bf16 v[180:183], a[116:119], v[68:71], v[180:183]
    v_exp_f32 v52, v52
    v_mfma_f32_16x16x32_bf16 v[184:187], a[120:123], v[68:71], v[184:187]
    ds_write2_b64 v9, v[104:105], v[106:107] offset0:16 offset1:20
    v_mfma_f32_16x16x32_bf16 v[188:191], a[124:127], v[68:71], v[188:191]
    ds_write2_b64 v9, v[108:109], v[110:111] offset0:24 offset1:28
    v_mfma_f32_16x16x32_bf16 a[136:139], a[128:131], v[68:71], a[136:139]
    v_exp_f32 v53, v53
    s_nop 0
    v_cvt_pk_bf16_f32 v74, v52, v53
    v_exp_f32 v54, v54
    v_exp_f32 v56, v56
    ds_read_b128 a[148:151], v10 offset:0
    ds_read_b128 a[152:155], v10 offset:1088
    ds_read_b128 a[156:159], v10 offset:2176
    ds_read_b128 a[160:163], v10 offset:3264
    v_exp_f32 v55, v55
    v_exp_f32 v57, v57
    v_accvgpr_read_b32 v19, a136
    v_rcp_f32 v18, v19
    v_cmp_nle_f32 s[48:49], v19, s40
    s_or_b64 s[46:47], s[46:47], s[48:49]
    v_cvt_pk_bf16_f32 v75, v54, v55
    v_mul_f32 v160, v160, v18
    v_mul_f32 v161, v161, v18
    v_mul_f32 v162, v162, v18
    v_mul_f32 v163, v163, v18
    v_cvt_pk_bf16_f32 v96, v160, v161
    v_cvt_pk_bf16_f32 v97, v162, v163
    v_pk_mul_f32 v[164:165], v[164:165], v[18:19] op_sel_hi:[1,0]
    v_pk_mul_f32 v[166:167], v[166:167], v[18:19] op_sel_hi:[1,0]
    v_pk_mul_f32 v[168:169], v[168:169], v[18:19] op_sel_hi:[1,0]
    v_pk_mul_f32 v[170:171], v[170:171], v[18:19] op_sel_hi:[1,0]
    v_pk_mul_f32 v[172:173], v[172:173], v[18:19] op_sel_hi:[1,0]
    v_pk_mul_f32 v[174:175], v[174:175], v[18:19] op_sel_hi:[1,0]
    v_cvt_pk_bf16_f32 v98, v164, v165
    v_cvt_pk_bf16_f32 v99, v166, v167
    v_cvt_pk_bf16_f32 v100, v168, v169
    v_cvt_pk_bf16_f32 v101, v170, v171
    v_cvt_pk_bf16_f32 v102, v172, v173
    v_cvt_pk_bf16_f32 v103, v174, v175
    v_cvt_pk_bf16_f32 v76, v56, v57
    v_exp_f32 v58, v58
    v_exp_f32 v59, v59
    ds_write2_b64 v9, v[96:97], v[98:99] offset0:0 offset1:4
    ds_write2_b64 v9, v[100:101], v[102:103] offset0:8 offset1:12
    v_mfma_f32_16x16x32_bf16 v[192:195], a[96:99], v[72:75], v[192:195]
    s_waitcnt lgkmcnt(5)
    buffer_store_dwordx4 a[148:151], v11, s[24:27], s41 offen offset:0 nt
    v_cvt_pk_bf16_f32 v77, v58, v59
    v_exp_f32 v60, v60
    v_mfma_f32_16x16x32_bf16 v[196:199], a[100:103], v[72:75], v[196:199]
    s_waitcnt lgkmcnt(2)
    buffer_store_dwordx4 a[152:155], v11, s[24:27], s41 offen offset:1024 nt
    v_exp_f32 v61, v61
    v_mfma_f32_16x16x32_bf16 v[200:203], a[104:107], v[72:75], v[200:203]
    buffer_store_dwordx4 a[156:159], v11, s[24:27], s41 offen offset:2048 nt
    v_mfma_f32_16x16x32_bf16 v[204:207], a[108:111], v[72:75], v[204:207]
    buffer_store_dwordx4 a[160:163], v11, s[24:27], s41 offen offset:3072 nt
    v_cvt_pk_bf16_f32 v78, v60, v61
    v_exp_f32 v62, v62
    v_mfma_f32_16x16x32_bf16 v[208:211], a[112:115], v[72:75], v[208:211]
    s_mov_b32 s41, 69632
    v_add_f32 v14, v14, v51
    v_add_f32 v14, v14, v52
    v_mul_f32 v176, v176, v18
    v_mul_f32 v177, v177, v18
    v_mul_f32 v178, v178, v18
    v_mul_f32 v179, v179, v18
    v_cvt_pk_bf16_f32 v104, v176, v177
    v_cvt_pk_bf16_f32 v105, v178, v179
    v_pk_mul_f32 v[180:181], v[180:181], v[18:19] op_sel_hi:[1,0]
    v_pk_mul_f32 v[182:183], v[182:183], v[18:19] op_sel_hi:[1,0]
    v_pk_mul_f32 v[184:185], v[184:185], v[18:19] op_sel_hi:[1,0]
    v_pk_mul_f32 v[186:187], v[186:187], v[18:19] op_sel_hi:[1,0]
    v_pk_mul_f32 v[188:189], v[188:189], v[18:19] op_sel_hi:[1,0]
    v_pk_mul_f32 v[190:191], v[190:191], v[18:19] op_sel_hi:[1,0]
    v_cvt_pk_bf16_f32 v106, v180, v181
    v_cvt_pk_bf16_f32 v107, v182, v183
    v_cvt_pk_bf16_f32 v108, v184, v185
    v_cvt_pk_bf16_f32 v109, v186, v187
    v_cvt_pk_bf16_f32 v110, v188, v189
    v_cvt_pk_bf16_f32 v111, v190, v191
    v_exp_f32 v63, v63
    v_mfma_f32_16x16x32_bf16 v[212:215], a[116:119], v[72:75], v[212:215]
    v_add_f32 v14, v14, v53
    v_add_f32 v14, v14, v54
    v_mfma_f32_16x16x32_bf16 v[216:219], a[120:123], v[72:75], v[216:219]
    ds_write2_b64 v9, v[104:105], v[106:107] offset0:16 offset1:20
    v_cvt_pk_bf16_f32 v79, v62, v63
    v_mfma_f32_16x16x32_bf16 v[220:223], a[124:127], v[72:75], v[220:223]
    ds_write2_b64 v9, v[108:109], v[110:111] offset0:24 offset1:28
    v_add_f32 v14, v14, v55
    v_mov_b32 v21, v14
    v_mov_b32 v20, v21
    v_mfma_f32_16x16x32_bf16 v[224:227], a[96:99], v[76:79], v[224:227]
    s_nop 0
    v_permlane16_swap_b32 v21, v20
    v_add_f32 v21, v21, v20
    v_mov_b32 v20, v21
    v_mfma_f32_16x16x32_bf16 v[228:231], a[100:103], v[76:79], v[228:231]
    s_nop 0
    v_permlane32_swap_b32 v21, v20
    v_add_f32 v21, v21, v20
    v_mfma_f32_16x16x32_bf16 v[232:235], a[104:107], v[76:79], v[232:235]
    v_rcp_f32 v20, v21
    v_mfma_f32_16x16x32_bf16 v[236:239], a[108:111], v[76:79], v[236:239]
    ds_read_b128 a[164:167], v10 offset:0
    ds_read_b128 a[168:171], v10 offset:1088
    ds_read_b128 a[172:175], v10 offset:2176
    ds_read_b128 a[176:179], v10 offset:3264
    v_mfma_f32_16x16x32_bf16 v[240:243], a[112:115], v[76:79], v[240:243]
    v_cmp_nle_f32 s[48:49], v21, s40
    s_or_b64 s[46:47], s[46:47], s[48:49]
    v_mfma_f32_16x16x32_bf16 v[244:247], a[116:119], v[76:79], v[244:247]
    v_mul_f32 v192, v192, v20
    v_mul_f32 v193, v193, v20
    v_mul_f32 v194, v194, v20
    v_mul_f32 v195, v195, v20
    v_cvt_pk_bf16_f32 v96, v192, v193
    v_cvt_pk_bf16_f32 v97, v194, v195
    v_pk_mul_f32 v[196:197], v[196:197], v[20:21] op_sel_hi:[1,0]
    v_pk_mul_f32 v[198:199], v[198:199], v[20:21] op_sel_hi:[1,0]
    v_pk_mul_f32 v[200:201], v[200:201], v[20:21] op_sel_hi:[1,0]
    v_pk_mul_f32 v[202:203], v[202:203], v[20:21] op_sel_hi:[1,0]
    v_pk_mul_f32 v[204:205], v[204:205], v[20:21] op_sel_hi:[1,0]
    v_pk_mul_f32 v[206:207], v[206:207], v[20:21] op_sel_hi:[1,0]
    v_cvt_pk_bf16_f32 v98, v196, v197
    v_cvt_pk_bf16_f32 v99, v198, v199
    v_cvt_pk_bf16_f32 v100, v200, v201
    v_cvt_pk_bf16_f32 v101, v202, v203
    v_cvt_pk_bf16_f32 v102, v204, v205
    v_cvt_pk_bf16_f32 v103, v206, v207
    v_mfma_f32_16x16x32_bf16 v[248:251], a[120:123], v[76:79], v[248:251]
    v_mfma_f32_16x16x32_bf16 v[252:255], a[124:127], v[76:79], v[252:255]
    ds_write2_b64 v9, v[96:97], v[98:99] offset0:0 offset1:4
    v_mfma_f32_16x16x32_bf16 a[144:147], a[128:131], v[76:79], a[144:147]
    s_waitcnt lgkmcnt(4)
    buffer_store_dwordx4 a[164:167], v11, s[24:27], s41 offen offset:0 nt
    ds_write2_b64 v9, v[100:101], v[102:103] offset0:8 offset1:12
    s_waitcnt lgkmcnt(2)
    buffer_store_dwordx4 a[168:171], v11, s[24:27], s41 offen offset:1024 nt
    buffer_store_dwordx4 a[172:175], v11, s[24:27], s41 offen offset:2048 nt
    buffer_store_dwordx4 a[176:179], v11, s[24:27], s41 offen offset:3072 nt
    s_mov_b32 s41, 73728
    v_mul_f32 v208, v208, v20
    v_mul_f32 v209, v209, v20
    v_mul_f32 v210, v210, v20
    v_mul_f32 v211, v211, v20
    v_cvt_pk_bf16_f32 v104, v208, v209
    v_cvt_pk_bf16_f32 v105, v210, v211
    v_pk_mul_f32 v[212:213], v[212:213], v[20:21] op_sel_hi:[1,0]
    v_pk_mul_f32 v[214:215], v[214:215], v[20:21] op_sel_hi:[1,0]
    v_pk_mul_f32 v[216:217], v[216:217], v[20:21] op_sel_hi:[1,0]
    v_pk_mul_f32 v[218:219], v[218:219], v[20:21] op_sel_hi:[1,0]
    v_pk_mul_f32 v[220:221], v[220:221], v[20:21] op_sel_hi:[1,0]
    v_pk_mul_f32 v[222:223], v[222:223], v[20:21] op_sel_hi:[1,0]
    v_cvt_pk_bf16_f32 v106, v212, v213
    v_cvt_pk_bf16_f32 v107, v214, v215
    v_cvt_pk_bf16_f32 v108, v216, v217
    v_cvt_pk_bf16_f32 v109, v218, v219
    v_cvt_pk_bf16_f32 v110, v220, v221
    v_cvt_pk_bf16_f32 v111, v222, v223
    v_accvgpr_read_b32 v23, a144
    v_rcp_f32 v22, v23
    ds_write2_b64 v9, v[104:105], v[106:107] offset0:16 offset1:20
    ds_write2_b64 v9, v[108:109], v[110:111] offset0:24 offset1:28
    v_cmp_nle_f32 s[48:49], v23, s40
    s_or_b64 s[46:47], s[46:47], s[48:49]
    v_pk_mul_f32 v[224:225], v[224:225], v[22:23] op_sel_hi:[1,0]
    v_pk_mul_f32 v[226:227], v[226:227], v[22:23] op_sel_hi:[1,0]
    v_pk_mul_f32 v[228:229], v[228:229], v[22:23] op_sel_hi:[1,0]
    v_pk_mul_f32 v[230:231], v[230:231], v[22:23] op_sel_hi:[1,0]
    v_pk_mul_f32 v[232:233], v[232:233], v[22:23] op_sel_hi:[1,0]
    v_pk_mul_f32 v[234:235], v[234:235], v[22:23] op_sel_hi:[1,0]
    v_pk_mul_f32 v[236:237], v[236:237], v[22:23] op_sel_hi:[1,0]
    v_pk_mul_f32 v[238:239], v[238:239], v[22:23] op_sel_hi:[1,0]
    v_cvt_pk_bf16_f32 v96, v224, v225
    v_cvt_pk_bf16_f32 v97, v226, v227
    v_cvt_pk_bf16_f32 v98, v228, v229
    v_cvt_pk_bf16_f32 v99, v230, v231
    v_cvt_pk_bf16_f32 v100, v232, v233
    v_cvt_pk_bf16_f32 v101, v234, v235
    v_cvt_pk_bf16_f32 v102, v236, v237
    v_cvt_pk_bf16_f32 v103, v238, v239
    ds_read_b128 a[180:183], v10 offset:0
    ds_read_b128 a[184:187], v10 offset:1088
    ds_read_b128 a[188:191], v10 offset:2176
    ds_read_b128 a[192:195], v10 offset:3264
    ds_write2_b64 v9, v[96:97], v[98:99] offset0:0 offset1:4
    ds_write2_b64 v9, v[100:101], v[102:103] offset0:8 offset1:12
    s_waitcnt lgkmcnt(5)
    buffer_store_dwordx4 a[180:183], v11, s[24:27], s41 offen offset:0 nt
    v_pk_mul_f32 v[240:241], v[240:241], v[22:23] op_sel_hi:[1,0]
    v_pk_mul_f32 v[242:243], v[242:243], v[22:23] op_sel_hi:[1,0]
    v_pk_mul_f32 v[244:245], v[244:245], v[22:23] op_sel_hi:[1,0]
    v_pk_mul_f32 v[246:247], v[246:247], v[22:23] op_sel_hi:[1,0]
    v_pk_mul_f32 v[248:249], v[248:249], v[22:23] op_sel_hi:[1,0]
    v_pk_mul_f32 v[250:251], v[250:251], v[22:23] op_sel_hi:[1,0]
    v_pk_mul_f32 v[252:253], v[252:253], v[22:23] op_sel_hi:[1,0]
    v_pk_mul_f32 v[254:255], v[254:255], v[22:23] op_sel_hi:[1,0]
    v_cvt_pk_bf16_f32 v104, v240, v241
    v_cvt_pk_bf16_f32 v105, v242, v243
    v_cvt_pk_bf16_f32 v106, v244, v245
    v_cvt_pk_bf16_f32 v107, v246, v247
    v_cvt_pk_bf16_f32 v108, v248, v249
    v_cvt_pk_bf16_f32 v109, v250, v251
    v_cvt_pk_bf16_f32 v110, v252, v253
    v_cvt_pk_bf16_f32 v111, v254, v255
    s_waitcnt lgkmcnt(0)
    buffer_store_dwordx4 a[184:187], v11, s[24:27], s41 offen offset:1024 nt
    buffer_store_dwordx4 a[188:191], v11, s[24:27], s41 offen offset:2048 nt
    ds_write2_b64 v9, v[104:105], v[106:107] offset0:16 offset1:20
    ds_write2_b64 v9, v[108:109], v[110:111] offset0:24 offset1:28
    buffer_store_dwordx4 a[192:195], v11, s[24:27], s41 offen offset:3072 nt
    ds_read_b128 a[196:199], v10 offset:0
    s_mov_b32 s41, 77824
    ds_read_b128 a[200:203], v10 offset:1088
    ds_read_b128 a[204:207], v10 offset:2176
    ds_read_b128 a[208:211], v10 offset:3264
    s_waitcnt lgkmcnt(3)
    buffer_store_dwordx4 a[196:199], v11, s[24:27], s41 offen offset:0 nt
    s_waitcnt lgkmcnt(2)
    buffer_store_dwordx4 a[200:203], v11, s[24:27], s41 offen offset:1024 nt
    s_waitcnt lgkmcnt(1)
    buffer_store_dwordx4 a[204:207], v11, s[24:27], s41 offen offset:2048 nt
    s_waitcnt lgkmcnt(0)
    buffer_store_dwordx4 a[208:211], v11, s[24:27], s41 offen offset:3072 nt
    s_or_b64 s[48:49], s[44:45], s[46:47]
    s_cbranch_scc0 L_end
    s_mov_b32 s51, 0
    s_cmp_eq_u64 s[44:45], 0
    s_cbranch_scc0 L_exact
L_exact1:
    s_mov_b32 s51, 1
    s_cmp_eq_u64 s[46:47], 0
    s_cbranch_scc1 L_end
L_exact:
    s_waitcnt vmcnt(0) lgkmcnt(0)
    s_mul_i32 s50, s28, 16512
    s_lshl_b32 s32, s51, 16
    s_lshl_b32 s31, s51, 17
    s_add_u32 m0, s50, 0
    s_add_u32 s37, s32, 0
    buffer_load_dwordx4 v2, s[12:15], s37 offen lds
    buffer_load_dwordx4 v2, s[12:15], s37 offen offset:1024 lds
    s_add_u32 m0, s50, 2080
    s_add_u32 s37, s32, 2048
    buffer_load_dwordx4 v2, s[12:15], s37 offen lds
    buffer_load_dwordx4 v2, s[12:15], s37 offen offset:1024 lds
    s_add_u32 m0, s50, 4128
    s_add_u32 s37, s32, 4096
    buffer_load_dwordx4 v2, s[12:15], s37 offen lds
    buffer_load_dwordx4 v2, s[12:15], s37 offen offset:1024 lds
    s_add_u32 m0, s50, 6208
    s_add_u32 s37, s32, 6144
    buffer_load_dwordx4 v2, s[12:15], s37 offen lds
    buffer_load_dwordx4 v2, s[12:15], s37 offen offset:1024 lds
    s_add_u32 m0, s50, 8256
    s_add_u32 s37, s32, 8192
    buffer_load_dwordx4 v2, s[12:15], s37 offen lds
    buffer_load_dwordx4 v2, s[12:15], s37 offen offset:1024 lds
    s_add_u32 m0, s50, 10336
    s_add_u32 s37, s32, 10240
    buffer_load_dwordx4 v2, s[12:15], s37 offen lds
    buffer_load_dwordx4 v2, s[12:15], s37 offen offset:1024 lds
    s_add_u32 m0, s50, 12384
    s_add_u32 s37, s32, 12288
    buffer_load_dwordx4 v2, s[12:15], s37 offen lds
    buffer_load_dwordx4 v2, s[12:15], s37 offen offset:1024 lds
    s_add_u32 m0, s50, 14464
    s_add_u32 s37, s32, 14336
    buffer_load_dwordx4 v2, s[12:15], s37 offen lds
    buffer_load_dwordx4 v2, s[12:15], s37 offen offset:1024 lds
    s_sub_u32 s37, s50, s30
    v_add_u32 v27, s37, v7
    v_add_u32 v28, s50, v3
    v_add_u32 v29, s50, v5
    v_and_b32 v30, 0x7ff, v1
    s_waitcnt vmcnt(0)
    ds_read_b128 a[0:3], v27 offset:0
    ds_read_b128 a[4:7], v27 offset:256
    ds_read_b128 a[8:11], v27 offset:512
    ds_read_b128 a[12:15], v27 offset:768
    s_waitcnt lgkmcnt(0)
    ds_read_b128 a[16:19], v27 offset:4128
    ds_read_b128 a[20:23], v27 offset:4384
    ds_read_b128 a[24:27], v27 offset:4640
    ds_read_b128 a[28:31], v27 offset:4896
    s_waitcnt lgkmcnt(0)
    ds_read_b128 a[32:35], v27 offset:8256
    ds_read_b128 a[36:39], v27 offset:8512
    ds_read_b128 a[40:43], v27 offset:8768
    ds_read_b128 a[44:47], v27 offset:9024
    s_waitcnt lgkmcnt(0)
    ds_read_b128 a[48:51], v27 offset:12384
    ds_read_b128 a[52:55], v27 offset:12640
    ds_read_b128 a[56:59], v27 offset:12896
    ds_read_b128 a[60:63], v27 offset:13152
    s_waitcnt lgkmcnt(0)
    v_mov_b32 v128, 0
    v_mov_b32 v129, 0
    v_mov_b32 v130, 0
    v_mov_b32 v131, 0
    v_mov_b32 v132, 0
    v_mov_b32 v133, 0
    v_mov_b32 v134, 0
    v_mov_b32 v135, 0
    v_mov_b32 v136, 0
    v_mov_b32 v137, 0
    v_mov_b32 v138, 0
    v_mov_b32 v139, 0
    v_mov_b32 v140, 0
    v_mov_b32 v141, 0
    v_mov_b32 v142, 0
    v_mov_b32 v143, 0
    v_mov_b32 v144, 0
    v_mov_b32 v145, 0
    v_mov_b32 v146, 0
    v_mov_b32 v147, 0
    v_mov_b32 v148, 0
    v_mov_b32 v149, 0
    v_mov_b32 v150, 0
    v_mov_b32 v151, 0
    v_mov_b32 v152, 0
    v_mov_b32 v153, 0
    v_mov_b32 v154, 0
    v_mov_b32 v155, 0
    v_mov_b32 v156, 0
    v_mov_b32 v157, 0
    v_mov_b32 v158, 0
    v_mov_b32 v159, 0
    v_mov_b32 v160, 0
    v_mov_b32 v161, 0
    v_mov_b32 v162, 0
    v_mov_b32 v163, 0
    v_mov_b32 v164, 0
    v_mov_b32 v165, 0
    v_mov_b32 v166, 0
    v_mov_b32 v167, 0
    v_mov_b32 v168, 0
    v_mov_b32 v169, 0
    v_mov_b32 v170, 0
    v_mov_b32 v171, 0
    v_mov_b32 v172, 0
    v_mov_b32 v173, 0
    v_mov_b32 v174, 0
    v_mov_b32 v175, 0
    v_mov_b32 v176, 0
    v_mov_b32 v177, 0
    v_mov_b32 v178, 0
    v_mov_b32 v179, 0
    v_mov_b32 v180, 0
    v_mov_b32 v181, 0
    v_mov_b32 v182, 0
    v_mov_b32 v183, 0
    v_mov_b32 v184, 0
    v_mov_b32 v185, 0
    v_mov_b32 v186, 0
    v_mov_b32 v187, 0
    v_mov_b32 v188, 0
    v_mov_b32 v189, 0
    v_mov_b32 v190, 0
    v_mov_b32 v191, 0
    v_mov_b32 v192, 0
    v_mov_b32 v193, 0
    v_mov_b32 v194, 0
    v_mov_b32 v195, 0
    v_mov_b32 v196, 0
    v_mov_b32 v197, 0
    v_mov_b32 v198, 0
    v_mov_b32 v199, 0
    v_mov_b32 v200, 0
    v_mov_b32 v201, 0
    v_mov_b32 v202, 0
    v_mov_b32 v203, 0
    v_mov_b32 v204, 0
    v_mov_b32 v205, 0
    v_mov_b32 v206, 0
    v_mov_b32 v207, 0
    v_mov_b32 v208, 0
    v_mov_b32 v209, 0
    v_mov_b32 v210, 0
    v_mov_b32 v211, 0
    v_mov_b32 v212, 0
    v_mov_b32 v213, 0
    v_mov_b32 v214, 0
    v_mov_b32 v215, 0
    v_mov_b32 v216, 0
    v_mov_b32 v217, 0
    v_mov_b32 v218, 0
    v_mov_b32 v219, 0
    v_mov_b32 v220, 0
    v_mov_b32 v221, 0
    v_mov_b32 v222, 0
    v_mov_b32 v223, 0
    v_mov_b32 v224, 0
    v_mov_b32 v225, 0
    v_mov_b32 v226, 0
    v_mov_b32 v227, 0
    v_mov_b32 v228, 0
    v_mov_b32 v229, 0
    v_mov_b32 v230, 0
    v_mov_b32 v231, 0
    v_mov_b32 v232, 0
    v_mov_b32 v233, 0
    v_mov_b32 v234, 0
    v_mov_b32 v235, 0
    v_mov_b32 v236, 0
    v_mov_b32 v237, 0
    v_mov_b32 v238, 0
    v_mov_b32 v239, 0
    v_mov_b32 v240, 0
    v_mov_b32 v241, 0
    v_mov_b32 v242, 0
    v_mov_b32 v243, 0
    v_mov_b32 v244, 0
    v_mov_b32 v245, 0
    v_mov_b32 v246, 0
    v_mov_b32 v247, 0
    v_mov_b32 v248, 0
    v_mov_b32 v249, 0
    v_mov_b32 v250, 0
    v_mov_b32 v251, 0
    v_mov_b32 v252, 0
    v_mov_b32 v253, 0
    v_mov_b32 v254, 0
    v_mov_b32 v255, 0
    v_accvgpr_write_b32 a132, 0
    v_accvgpr_write_b32 a133, 0
    v_accvgpr_write_b32 a134, 0
    v_accvgpr_write_b32 a135, 0
    v_accvgpr_write_b32 a136, 0
    v_accvgpr_write_b32 a137, 0
    v_accvgpr_write_b32 a138, 0
    v_accvgpr_write_b32 a139, 0
    v_accvgpr_write_b32 a140, 0
    v_accvgpr_write_b32 a141, 0
    v_accvgpr_write_b32 a142, 0
    v_accvgpr_write_b32 a143, 0
    v_accvgpr_write_b32 a144, 0
    v_accvgpr_write_b32 a145, 0
    v_accvgpr_write_b32 a146, 0
    v_accvgpr_write_b32 a147, 0
    v_mov_b32 v12, 0xff7fffff
    v_mov_b32 v13, 0xff7fffff
    v_mov_b32 v14, 0xff7fffff
    v_mov_b32 v15, 0xff7fffff
    s_mov_b32 s34, 0
L_xloop:
    s_add_u32 m0, s50, 0
    s_add_u32 s37, s31, 0
    buffer_load_dwordx4 v30, s[16:19], s37 offen lds
    buffer_load_dwordx4 v30, s[16:19], s37 offen offset:1024 lds
    s_add_u32 m0, s50, 2048
    s_nop 0
    buffer_load_dwordx4 v30, s[20:23], s37 offen lds
    s_add_u32 m0, m0, 32
    s_nop 0
    buffer_load_dwordx4 v30, s[20:23], s37 offen offset:1024 lds
    s_add_u32 m0, s50, 4128
    s_add_u32 s37, s31, 2048
    buffer_load_dwordx4 v30, s[16:19], s37 offen lds
    buffer_load_dwordx4 v30, s[16:19], s37 offen offset:1024 lds
    s_add_u32 m0, s50, 6176
    s_nop 0
    buffer_load_dwordx4 v30, s[20:23], s37 offen lds
    s_add_u32 m0, m0, 32
    s_nop 0
    buffer_load_dwordx4 v30, s[20:23], s37 offen offset:1024 lds
    s_add_u32 m0, s50, 8256
    s_add_u32 s37, s31, 4096
    buffer_load_dwordx4 v30, s[16:19], s37 offen lds
    buffer_load_dwordx4 v30, s[16:19], s37 offen offset:1024 lds
    s_add_u32 m0, s50, 10304
    s_nop 0
    buffer_load_dwordx4 v30, s[20:23], s37 offen lds
    s_add_u32 m0, m0, 32
    s_nop 0
    buffer_load_dwordx4 v30, s[20:23], s37 offen offset:1024 lds
    s_add_u32 m0, s50, 12384
    s_add_u32 s37, s31, 6144
    buffer_load_dwordx4 v30, s[16:19], s37 offen lds
    buffer_load_dwordx4 v30, s[16:19], s37 offen offset:1024 lds
    s_add_u32 m0, s50, 14432
    s_nop 0
    buffer_load_dwordx4 v30, s[20:23], s37 offen lds
    s_add_u32 m0, m0, 32
    s_nop 0
    buffer_load_dwordx4 v30, s[20:23], s37 offen offset:1024 lds
    s_waitcnt vmcnt(0)
    ds_read_b128 a[64:67], v28 offset:0
    ds_read_b128 a[68:71], v28 offset:8256
    ds_read_b128 a[72:75], v28 offset:256
    ds_read_b128 a[76:79], v28 offset:8512
    ds_read_b128 a[80:83], v28 offset:512
    ds_read_b128 a[84:87], v28 offset:8768
    ds_read_b128 a[88:91], v28 offset:768
    ds_read_b128 a[92:95], v28 offset:9024
    s_waitcnt lgkmcnt(0)
    ds_read_b64_tr_b16 a[96:97], v29 offset:0
    ds_read_b64_tr_b16 a[98:99], v29 offset:8256
    ds_read_b64_tr_b16 a[100:101], v29 offset:32
    ds_read_b64_tr_b16 a[102:103], v29 offset:8288
    ds_read_b64_tr_b16 a[104:105], v29 offset:256
    ds_read_b64_tr_b16 a[106:107], v29 offset:8512
    ds_read_b64_tr_b16 a[108:109], v29 offset:288
    ds_read_b64_tr_b16 a[110:111], v29 offset:8544
    s_waitcnt lgkmcnt(0)
    ds_read_b64_tr_b16 a[112:113], v29 offset:512
    ds_read_b64_tr_b16 a[114:115], v29 offset:8768
    ds_read_b64_tr_b16 a[116:117], v29 offset:544
    ds_read_b64_tr_b16 a[118:119], v29 offset:8800
    ds_read_b64_tr_b16 a[120:121], v29 offset:768
    ds_read_b64_tr_b16 a[122:123], v29 offset:9024
    ds_read_b64_tr_b16 a[124:125], v29 offset:800
    ds_read_b64_tr_b16 a[126:127], v29 offset:9056
    s_waitcnt lgkmcnt(0)
    v_mfma_f32_16x16x32_bf16 v[32:35], a[64:67], a[0:3], 0
    v_mfma_f32_16x16x32_bf16 v[36:39], a[68:71], a[0:3], 0
    v_mfma_f32_16x16x32_bf16 v[32:35], a[72:75], a[4:7], v[32:35]
    v_mfma_f32_16x16x32_bf16 v[36:39], a[76:79], a[4:7], v[36:39]
    v_mfma_f32_16x16x32_bf16 v[32:35], a[80:83], a[8:11], v[32:35]
    v_mfma_f32_16x16x32_bf16 v[36:39], a[84:87], a[8:11], v[36:39]
    v_mfma_f32_16x16x32_bf16 v[32:35], a[88:91], a[12:15], v[32:35]
    v_mfma_f32_16x16x32_bf16 v[36:39], a[92:95], a[12:15], v[36:39]
    v_mfma_f32_16x16x32_bf16 v[40:43], a[64:67], a[16:19], 0
    v_mfma_f32_16x16x32_bf16 v[44:47], a[68:71], a[16:19], 0
    v_mfma_f32_16x16x32_bf16 v[40:43], a[72:75], a[20:23], v[40:43]
    v_mfma_f32_16x16x32_bf16 v[44:47], a[76:79], a[20:23], v[44:47]
    v_mfma_f32_16x16x32_bf16 v[40:43], a[80:83], a[24:27], v[40:43]
    v_mfma_f32_16x16x32_bf16 v[44:47], a[84:87], a[24:27], v[44:47]
    v_mfma_f32_16x16x32_bf16 v[40:43], a[88:91], a[28:31], v[40:43]
    v_mfma_f32_16x16x32_bf16 v[44:47], a[92:95], a[28:31], v[44:47]
    v_mfma_f32_16x16x32_bf16 v[48:51], a[64:67], a[32:35], 0
    v_mfma_f32_16x16x32_bf16 v[52:55], a[68:71], a[32:35], 0
    v_mfma_f32_16x16x32_bf16 v[48:51], a[72:75], a[36:39], v[48:51]
    v_mfma_f32_16x16x32_bf16 v[52:55], a[76:79], a[36:39], v[52:55]
    v_mfma_f32_16x16x32_bf16 v[48:51], a[80:83], a[40:43], v[48:51]
    v_mfma_f32_16x16x32_bf16 v[52:55], a[84:87], a[40:43], v[52:55]
    v_mfma_f32_16x16x32_bf16 v[48:51], a[88:91], a[44:47], v[48:51]
    v_mfma_f32_16x16x32_bf16 v[52:55], a[92:95], a[44:47], v[52:55]
    v_mfma_f32_16x16x32_bf16 v[56:59], a[64:67], a[48:51], 0
    v_mfma_f32_16x16x32_bf16 v[60:63], a[68:71], a[48:51], 0
    v_mfma_f32_16x16x32_bf16 v[56:59], a[72:75], a[52:55], v[56:59]
    v_mfma_f32_16x16x32_bf16 v[60:63], a[76:79], a[52:55], v[60:63]
    v_mfma_f32_16x16x32_bf16 v[56:59], a[80:83], a[56:59], v[56:59]
    v_mfma_f32_16x16x32_bf16 v[60:63], a[84:87], a[56:59], v[60:63]
    v_mfma_f32_16x16x32_bf16 v[56:59], a[88:91], a[60:63], v[56:59]
    v_mfma_f32_16x16x32_bf16 v[60:63], a[92:95], a[60:63], v[60:63]
    s_nop 7
    v_max3_f32 v24, v32, v33, v34
    v_max3_f32 v24, v24, v35, v36
    v_max3_f32 v24, v24, v37, v38
    v_max_f32 v24, v24, v39
    v_mov_b32 v25, v24
    s_nop 1
    v_permlane16_swap_b32 v24, v25
    v_max_f32 v24, v24, v25
    v_mov_b32 v25, v24
    s_nop 1
    v_permlane32_swap_b32 v24, v25
    v_max_f32 v24, v24, v25
    v_mul_f32 v24, s39, v24
    v_max_f32 v24, v24, v12
    v_sub_f32 v26, v12, v24
    v_exp_f32 v26, v26
    v_mov_b32 v12, v24
    v_mul_f32 v128, v128, v26
    v_mul_f32 v129, v129, v26
    v_mul_f32 v130, v130, v26
    v_mul_f32 v131, v131, v26
    v_mul_f32 v132, v132, v26
    v_mul_f32 v133, v133, v26
    v_mul_f32 v134, v134, v26
    v_mul_f32 v135, v135, v26
    v_mul_f32 v136, v136, v26
    v_mul_f32 v137, v137, v26
    v_mul_f32 v138, v138, v26
    v_mul_f32 v139, v139, v26
    v_mul_f32 v140, v140, v26
    v_mul_f32 v141, v141, v26
    v_mul_f32 v142, v142, v26
    v_mul_f32 v143, v143, v26
    v_mul_f32 v144, v144, v26
    v_mul_f32 v145, v145, v26
    v_mul_f32 v146, v146, v26
    v_mul_f32 v147, v147, v26
    v_mul_f32 v148, v148, v26
    v_mul_f32 v149, v149, v26
    v_mul_f32 v150, v150, v26
    v_mul_f32 v151, v151, v26
    v_mul_f32 v152, v152, v26
    v_mul_f32 v153, v153, v26
    v_mul_f32 v154, v154, v26
    v_mul_f32 v155, v155, v26
    v_mul_f32 v156, v156, v26
    v_mul_f32 v157, v157, v26
    v_mul_f32 v158, v158, v26
    v_mul_f32 v159, v159, v26
    v_accvgpr_read_b32 v25, a132
    v_mul_f32 v25, v25, v26
    v_accvgpr_write_b32 a132, v25
    v_accvgpr_write_b32 a133, v25
    v_accvgpr_write_b32 a134, v25
    v_accvgpr_write_b32 a135, v25
    v_fma_f32 v32, v32, s39, -v12
    v_fma_f32 v33, v33, s39, -v12
    v_fma_f32 v34, v34, s39, -v12
    v_fma_f32 v35, v35, s39, -v12
    v_fma_f32 v36, v36, s39, -v12
    v_fma_f32 v37, v37, s39, -v12
    v_fma_f32 v38, v38, s39, -v12
    v_fma_f32 v39, v39, s39, -v12
    v_exp_f32 v32, v32
    v_exp_f32 v33, v33
    v_exp_f32 v34, v34
    v_exp_f32 v35, v35
    v_exp_f32 v36, v36
    v_exp_f32 v37, v37
    v_exp_f32 v38, v38
    v_exp_f32 v39, v39
    s_nop 0
    v_cvt_pk_bf16_f32 v64, v32, v33
    v_cvt_pk_bf16_f32 v65, v34, v35
    v_cvt_pk_bf16_f32 v66, v36, v37
    v_cvt_pk_bf16_f32 v67, v38, v39
    v_max3_f32 v24, v40, v41, v42
    v_max3_f32 v24, v24, v43, v44
    v_max3_f32 v24, v24, v45, v46
    v_max_f32 v24, v24, v47
    v_mov_b32 v25, v24
    s_nop 1
    v_permlane16_swap_b32 v24, v25
    v_max_f32 v24, v24, v25
    v_mov_b32 v25, v24
    s_nop 1
    v_permlane32_swap_b32 v24, v25
    v_max_f32 v24, v24, v25
    v_mul_f32 v24, s39, v24
    v_max_f32 v24, v24, v13
    v_sub_f32 v26, v13, v24
    v_exp_f32 v26, v26
    v_mov_b32 v13, v24
    v_mul_f32 v160, v160, v26
    v_mul_f32 v161, v161, v26
    v_mul_f32 v162, v162, v26
    v_mul_f32 v163, v163, v26
    v_mul_f32 v164, v164, v26
    v_mul_f32 v165, v165, v26
    v_mul_f32 v166, v166, v26
    v_mul_f32 v167, v167, v26
    v_mul_f32 v168, v168, v26
    v_mul_f32 v169, v169, v26
    v_mul_f32 v170, v170, v26
    v_mul_f32 v171, v171, v26
    v_mul_f32 v172, v172, v26
    v_mul_f32 v173, v173, v26
    v_mul_f32 v174, v174, v26
    v_mul_f32 v175, v175, v26
    v_mul_f32 v176, v176, v26
    v_mul_f32 v177, v177, v26
    v_mul_f32 v178, v178, v26
    v_mul_f32 v179, v179, v26
    v_mul_f32 v180, v180, v26
    v_mul_f32 v181, v181, v26
    v_mul_f32 v182, v182, v26
    v_mul_f32 v183, v183, v26
    v_mul_f32 v184, v184, v26
    v_mul_f32 v185, v185, v26
    v_mul_f32 v186, v186, v26
    v_mul_f32 v187, v187, v26
    v_mul_f32 v188, v188, v26
    v_mul_f32 v189, v189, v26
    v_mul_f32 v190, v190, v26
    v_mul_f32 v191, v191, v26
    v_accvgpr_read_b32 v25, a136
    v_mul_f32 v25, v25, v26
    v_accvgpr_write_b32 a136, v25
    v_accvgpr_write_b32 a137, v25
    v_accvgpr_write_b32 a138, v25
    v_accvgpr_write_b32 a139, v25
    v_fma_f32 v40, v40, s39, -v13
    v_fma_f32 v41, v41, s39, -v13
    v_fma_f32 v42, v42, s39, -v13
    v_fma_f32 v43, v43, s39, -v13
    v_fma_f32 v44, v44, s39, -v13
    v_fma_f32 v45, v45, s39, -v13
    v_fma_f32 v46, v46, s39, -v13
    v_fma_f32 v47, v47, s39, -v13
    v_exp_f32 v40, v40
    v_exp_f32 v41, v41
    v_exp_f32 v42, v42
    v_exp_f32 v43, v43
    v_exp_f32 v44, v44
    v_exp_f32 v45, v45
    v_exp_f32 v46, v46
    v_exp_f32 v47, v47
    s_nop 0
    v_cvt_pk_bf16_f32 v68, v40, v41
    v_cvt_pk_bf16_f32 v69, v42, v43
    v_cvt_pk_bf16_f32 v70, v44, v45
    v_cvt_pk_bf16_f32 v71, v46, v47
    v_max3_f32 v24, v48, v49, v50
    v_max3_f32 v24, v24, v51, v52
    v_max3_f32 v24, v24, v53, v54
    v_max_f32 v24, v24, v55
    v_mov_b32 v25, v24
    s_nop 1
    v_permlane16_swap_b32 v24, v25
    v_max_f32 v24, v24, v25
    v_mov_b32 v25, v24
    s_nop 1
    v_permlane32_swap_b32 v24, v25
    v_max_f32 v24, v24, v25
    v_mul_f32 v24, s39, v24
    v_max_f32 v24, v24, v14
    v_sub_f32 v26, v14, v24
    v_exp_f32 v26, v26
    v_mov_b32 v14, v24
    v_mul_f32 v192, v192, v26
    v_mul_f32 v193, v193, v26
    v_mul_f32 v194, v194, v26
    v_mul_f32 v195, v195, v26
    v_mul_f32 v196, v196, v26
    v_mul_f32 v197, v197, v26
    v_mul_f32 v198, v198, v26
    v_mul_f32 v199, v199, v26
    v_mul_f32 v200, v200, v26
    v_mul_f32 v201, v201, v26
    v_mul_f32 v202, v202, v26
    v_mul_f32 v203, v203, v26
    v_mul_f32 v204, v204, v26
    v_mul_f32 v205, v205, v26
    v_mul_f32 v206, v206, v26
    v_mul_f32 v207, v207, v26
    v_mul_f32 v208, v208, v26
    v_mul_f32 v209, v209, v26
    v_mul_f32 v210, v210, v26
    v_mul_f32 v211, v211, v26
    v_mul_f32 v212, v212, v26
    v_mul_f32 v213, v213, v26
    v_mul_f32 v214, v214, v26
    v_mul_f32 v215, v215, v26
    v_mul_f32 v216, v216, v26
    v_mul_f32 v217, v217, v26
    v_mul_f32 v218, v218, v26
    v_mul_f32 v219, v219, v26
    v_mul_f32 v220, v220, v26
    v_mul_f32 v221, v221, v26
    v_mul_f32 v222, v222, v26
    v_mul_f32 v223, v223, v26
    v_accvgpr_read_b32 v25, a140
    v_mul_f32 v25, v25, v26
    v_accvgpr_write_b32 a140, v25
    v_accvgpr_write_b32 a141, v25
    v_accvgpr_write_b32 a142, v25
    v_accvgpr_write_b32 a143, v25
    v_fma_f32 v48, v48, s39, -v14
    v_fma_f32 v49, v49, s39, -v14
    v_fma_f32 v50, v50, s39, -v14
    v_fma_f32 v51, v51, s39, -v14
    v_fma_f32 v52, v52, s39, -v14
    v_fma_f32 v53, v53, s39, -v14
    v_fma_f32 v54, v54, s39, -v14
    v_fma_f32 v55, v55, s39, -v14
    v_exp_f32 v48, v48
    v_exp_f32 v49, v49
    v_exp_f32 v50, v50
    v_exp_f32 v51, v51
    v_exp_f32 v52, v52
    v_exp_f32 v53, v53
    v_exp_f32 v54, v54
    v_exp_f32 v55, v55
    s_nop 0
    v_cvt_pk_bf16_f32 v72, v48, v49
    v_cvt_pk_bf16_f32 v73, v50, v51
    v_cvt_pk_bf16_f32 v74, v52, v53
    v_cvt_pk_bf16_f32 v75, v54, v55
    v_max3_f32 v24, v56, v57, v58
    v_max3_f32 v24, v24, v59, v60
    v_max3_f32 v24, v24, v61, v62
    v_max_f32 v24, v24, v63
    v_mov_b32 v25, v24
    s_nop 1
    v_permlane16_swap_b32 v24, v25
    v_max_f32 v24, v24, v25
    v_mov_b32 v25, v24
    s_nop 1
    v_permlane32_swap_b32 v24, v25
    v_max_f32 v24, v24, v25
    v_mul_f32 v24, s39, v24
    v_max_f32 v24, v24, v15
    v_sub_f32 v26, v15, v24
    v_exp_f32 v26, v26
    v_mov_b32 v15, v24
    v_mul_f32 v224, v224, v26
    v_mul_f32 v225, v225, v26
    v_mul_f32 v226, v226, v26
    v_mul_f32 v227, v227, v26
    v_mul_f32 v228, v228, v26
    v_mul_f32 v229, v229, v26
    v_mul_f32 v230, v230, v26
    v_mul_f32 v231, v231, v26
    v_mul_f32 v232, v232, v26
    v_mul_f32 v233, v233, v26
    v_mul_f32 v234, v234, v26
    v_mul_f32 v235, v235, v26
    v_mul_f32 v236, v236, v26
    v_mul_f32 v237, v237, v26
    v_mul_f32 v238, v238, v26
    v_mul_f32 v239, v239, v26
    v_mul_f32 v240, v240, v26
    v_mul_f32 v241, v241, v26
    v_mul_f32 v242, v242, v26
    v_mul_f32 v243, v243, v26
    v_mul_f32 v244, v244, v26
    v_mul_f32 v245, v245, v26
    v_mul_f32 v246, v246, v26
    v_mul_f32 v247, v247, v26
    v_mul_f32 v248, v248, v26
    v_mul_f32 v249, v249, v26
    v_mul_f32 v250, v250, v26
    v_mul_f32 v251, v251, v26
    v_mul_f32 v252, v252, v26
    v_mul_f32 v253, v253, v26
    v_mul_f32 v254, v254, v26
    v_mul_f32 v255, v255, v26
    v_accvgpr_read_b32 v25, a144
    v_mul_f32 v25, v25, v26
    v_accvgpr_write_b32 a144, v25
    v_accvgpr_write_b32 a145, v25
    v_accvgpr_write_b32 a146, v25
    v_accvgpr_write_b32 a147, v25
    v_fma_f32 v56, v56, s39, -v15
    v_fma_f32 v57, v57, s39, -v15
    v_fma_f32 v58, v58, s39, -v15
    v_fma_f32 v59, v59, s39, -v15
    v_fma_f32 v60, v60, s39, -v15
    v_fma_f32 v61, v61, s39, -v15
    v_fma_f32 v62, v62, s39, -v15
    v_fma_f32 v63, v63, s39, -v15
    v_exp_f32 v56, v56
    v_exp_f32 v57, v57
    v_exp_f32 v58, v58
    v_exp_f32 v59, v59
    v_exp_f32 v60, v60
    v_exp_f32 v61, v61
    v_exp_f32 v62, v62
    v_exp_f32 v63, v63
    s_nop 0
    v_cvt_pk_bf16_f32 v76, v56, v57
    v_cvt_pk_bf16_f32 v77, v58, v59
    v_cvt_pk_bf16_f32 v78, v60, v61
    v_cvt_pk_bf16_f32 v79, v62, v63
    s_nop 1
    v_mfma_f32_16x16x32_bf16 v[128:131], a[96:99], v[64:67], v[128:131]
    v_mfma_f32_16x16x32_bf16 v[132:135], a[100:103], v[64:67], v[132:135]
    v_mfma_f32_16x16x32_bf16 v[136:139], a[104:107], v[64:67], v[136:139]
    v_mfma_f32_16x16x32_bf16 v[140:143], a[108:111], v[64:67], v[140:143]
    v_mfma_f32_16x16x32_bf16 v[144:147], a[112:115], v[64:67], v[144:147]
    v_mfma_f32_16x16x32_bf16 v[148:151], a[116:119], v[64:67], v[148:151]
    v_mfma_f32_16x16x32_bf16 v[152:155], a[120:123], v[64:67], v[152:155]
    v_mfma_f32_16x16x32_bf16 v[156:159], a[124:127], v[64:67], v[156:159]
    v_mfma_f32_16x16x32_bf16 a[132:135], a[128:131], v[64:67], a[132:135]
    v_mfma_f32_16x16x32_bf16 v[160:163], a[96:99], v[68:71], v[160:163]
    v_mfma_f32_16x16x32_bf16 v[164:167], a[100:103], v[68:71], v[164:167]
    v_mfma_f32_16x16x32_bf16 v[168:171], a[104:107], v[68:71], v[168:171]
    v_mfma_f32_16x16x32_bf16 v[172:175], a[108:111], v[68:71], v[172:175]
    v_mfma_f32_16x16x32_bf16 v[176:179], a[112:115], v[68:71], v[176:179]
    v_mfma_f32_16x16x32_bf16 v[180:183], a[116:119], v[68:71], v[180:183]
    v_mfma_f32_16x16x32_bf16 v[184:187], a[120:123], v[68:71], v[184:187]
    v_mfma_f32_16x16x32_bf16 v[188:191], a[124:127], v[68:71], v[188:191]
    v_mfma_f32_16x16x32_bf16 a[136:139], a[128:131], v[68:71], a[136:139]
    v_mfma_f32_16x16x32_bf16 v[192:195], a[96:99], v[72:75], v[192:195]
    v_mfma_f32_16x16x32_bf16 v[196:199], a[100:103], v[72:75], v[196:199]
    v_mfma_f32_16x16x32_bf16 v[200:203], a[104:107], v[72:75], v[200:203]
    v_mfma_f32_16x16x32_bf16 v[204:207], a[108:111], v[72:75], v[204:207]
    v_mfma_f32_16x16x32_bf16 v[208:211], a[112:115], v[72:75], v[208:211]
    v_mfma_f32_16x16x32_bf16 v[212:215], a[116:119], v[72:75], v[212:215]
    v_mfma_f32_16x16x32_bf16 v[216:219], a[120:123], v[72:75], v[216:219]
    v_mfma_f32_16x16x32_bf16 v[220:223], a[124:127], v[72:75], v[220:223]
    v_mfma_f32_16x16x32_bf16 a[140:143], a[128:131], v[72:75], a[140:143]
    v_mfma_f32_16x16x32_bf16 v[224:227], a[96:99], v[76:79], v[224:227]
    v_mfma_f32_16x16x32_bf16 v[228:231], a[100:103], v[76:79], v[228:231]
    v_mfma_f32_16x16x32_bf16 v[232:235], a[104:107], v[76:79], v[232:235]
    v_mfma_f32_16x16x32_bf16 v[236:239], a[108:111], v[76:79], v[236:239]
    v_mfma_f32_16x16x32_bf16 v[240:243], a[112:115], v[76:79], v[240:243]
    v_mfma_f32_16x16x32_bf16 v[244:247], a[116:119], v[76:79], v[244:247]
    v_mfma_f32_16x16x32_bf16 v[248:251], a[120:123], v[76:79], v[248:251]
    v_mfma_f32_16x16x32_bf16 v[252:255], a[124:127], v[76:79], v[252:255]
    v_mfma_f32_16x16x32_bf16 a[144:147], a[128:131], v[76:79], a[144:147]
    s_nop 7
    s_add_u32 s31, s31, 8192
    s_add_u32 s34, s34, 1
    s_cmp_lg_u32 s34, 16
    s_cbranch_scc1 L_xloop
    v_accvgpr_read_b32 v16, a132
    v_rcp_f32 v16, v16
    s_nop 0
    v_mul_f32 v128, v128, v16
    v_mul_f32 v129, v129, v16
    v_mul_f32 v130, v130, v16
    v_mul_f32 v131, v131, v16
    v_cvt_pk_bf16_f32 v96, v128, v129
    v_cvt_pk_bf16_f32 v97, v130, v131
    v_mul_f32 v132, v132, v16
    v_mul_f32 v133, v133, v16
    v_mul_f32 v134, v134, v16
    v_mul_f32 v135, v135, v16
    v_cvt_pk_bf16_f32 v98, v132, v133
    v_cvt_pk_bf16_f32 v99, v134, v135
    v_mul_f32 v136, v136, v16
    v_mul_f32 v137, v137, v16
    v_mul_f32 v138, v138, v16
    v_mul_f32 v139, v139, v16
    v_cvt_pk_bf16_f32 v100, v136, v137
    v_cvt_pk_bf16_f32 v101, v138, v139
    v_mul_f32 v140, v140, v16
    v_mul_f32 v141, v141, v16
    v_mul_f32 v142, v142, v16
    v_mul_f32 v143, v143, v16
    v_cvt_pk_bf16_f32 v102, v140, v141
    v_cvt_pk_bf16_f32 v103, v142, v143
    v_mul_f32 v144, v144, v16
    v_mul_f32 v145, v145, v16
    v_mul_f32 v146, v146, v16
    v_mul_f32 v147, v147, v16
    v_cvt_pk_bf16_f32 v104, v144, v145
    v_cvt_pk_bf16_f32 v105, v146, v147
    v_mul_f32 v148, v148, v16
    v_mul_f32 v149, v149, v16
    v_mul_f32 v150, v150, v16
    v_mul_f32 v151, v151, v16
    v_cvt_pk_bf16_f32 v106, v148, v149
    v_cvt_pk_bf16_f32 v107, v150, v151
    v_mul_f32 v152, v152, v16
    v_mul_f32 v153, v153, v16
    v_mul_f32 v154, v154, v16
    v_mul_f32 v155, v155, v16
    v_cvt_pk_bf16_f32 v108, v152, v153
    v_cvt_pk_bf16_f32 v109, v154, v155
    v_mul_f32 v156, v156, v16
    v_mul_f32 v157, v157, v16
    v_mul_f32 v158, v158, v16
    v_mul_f32 v159, v159, v16
    v_cvt_pk_bf16_f32 v110, v156, v157
    v_cvt_pk_bf16_f32 v111, v158, v159
    ds_write_b64 v9, v[96:97] offset:0
    ds_write_b64 v9, v[98:99] offset:32
    ds_write_b64 v9, v[100:101] offset:64
    ds_write_b64 v9, v[102:103] offset:96
    ds_write_b64 v9, v[104:105] offset:128
    ds_write_b64 v9, v[106:107] offset:160
    ds_write_b64 v9, v[108:109] offset:192
    ds_write_b64 v9, v[110:111] offset:224
    ds_read_b128 a[0:3], v10 offset:0
    ds_read_b128 a[4:7], v10 offset:1088
    ds_read_b128 a[8:11], v10 offset:2176
    ds_read_b128 a[12:15], v10 offset:3264
    s_waitcnt lgkmcnt(0)
    s_add_u32 s37, s32, 0
    buffer_store_dwordx4 a[0:3], v11, s[24:27], s37 offen offset:0
    buffer_store_dwordx4 a[4:7], v11, s[24:27], s37 offen offset:1024
    buffer_store_dwordx4 a[8:11], v11, s[24:27], s37 offen offset:2048
    buffer_store_dwordx4 a[12:15], v11, s[24:27], s37 offen offset:3072
    v_accvgpr_read_b32 v18, a136
    v_rcp_f32 v18, v18
    s_nop 0
    v_mul_f32 v160, v160, v18
    v_mul_f32 v161, v161, v18
    v_mul_f32 v162, v162, v18
    v_mul_f32 v163, v163, v18
    v_cvt_pk_bf16_f32 v96, v160, v161
    v_cvt_pk_bf16_f32 v97, v162, v163
    v_mul_f32 v164, v164, v18
    v_mul_f32 v165, v165, v18
    v_mul_f32 v166, v166, v18
    v_mul_f32 v167, v167, v18
    v_cvt_pk_bf16_f32 v98, v164, v165
    v_cvt_pk_bf16_f32 v99, v166, v167
    v_mul_f32 v168, v168, v18
    v_mul_f32 v169, v169, v18
    v_mul_f32 v170, v170, v18
    v_mul_f32 v171, v171, v18
    v_cvt_pk_bf16_f32 v100, v168, v169
    v_cvt_pk_bf16_f32 v101, v170, v171
    v_mul_f32 v172, v172, v18
    v_mul_f32 v173, v173, v18
    v_mul_f32 v174, v174, v18
    v_mul_f32 v175, v175, v18
    v_cvt_pk_bf16_f32 v102, v172, v173
    v_cvt_pk_bf16_f32 v103, v174, v175
    v_mul_f32 v176, v176, v18
    v_mul_f32 v177, v177, v18
    v_mul_f32 v178, v178, v18
    v_mul_f32 v179, v179, v18
    v_cvt_pk_bf16_f32 v104, v176, v177
    v_cvt_pk_bf16_f32 v105, v178, v179
    v_mul_f32 v180, v180, v18
    v_mul_f32 v181, v181, v18
    v_mul_f32 v182, v182, v18
    v_mul_f32 v183, v183, v18
    v_cvt_pk_bf16_f32 v106, v180, v181
    v_cvt_pk_bf16_f32 v107, v182, v183
    v_mul_f32 v184, v184, v18
    v_mul_f32 v185, v185, v18
    v_mul_f32 v186, v186, v18
    v_mul_f32 v187, v187, v18
    v_cvt_pk_bf16_f32 v108, v184, v185
    v_cvt_pk_bf16_f32 v109, v186, v187
    v_mul_f32 v188, v188, v18
    v_mul_f32 v189, v189, v18
    v_mul_f32 v190, v190, v18
    v_mul_f32 v191, v191, v18
    v_cvt_pk_bf16_f32 v110, v188, v189
    v_cvt_pk_bf16_f32 v111, v190, v191
    ds_write_b64 v9, v[96:97] offset:0
    ds_write_b64 v9, v[98:99] offset:32
    ds_write_b64 v9, v[100:101] offset:64
    ds_write_b64 v9, v[102:103] offset:96
    ds_write_b64 v9, v[104:105] offset:128
    ds_write_b64 v9, v[106:107] offset:160
    ds_write_b64 v9, v[108:109] offset:192
    ds_write_b64 v9, v[110:111] offset:224
    ds_read_b128 a[16:19], v10 offset:0
    ds_read_b128 a[20:23], v10 offset:1088
    ds_read_b128 a[24:27], v10 offset:2176
    ds_read_b128 a[28:31], v10 offset:3264
    s_waitcnt lgkmcnt(0)
    s_add_u32 s37, s32, 4096
    buffer_store_dwordx4 a[16:19], v11, s[24:27], s37 offen offset:0
    buffer_store_dwordx4 a[20:23], v11, s[24:27], s37 offen offset:1024
    buffer_store_dwordx4 a[24:27], v11, s[24:27], s37 offen offset:2048
    buffer_store_dwordx4 a[28:31], v11, s[24:27], s37 offen offset:3072
    v_accvgpr_read_b32 v20, a140
    v_rcp_f32 v20, v20
    s_nop 0
    v_mul_f32 v192, v192, v20
    v_mul_f32 v193, v193, v20
    v_mul_f32 v194, v194, v20
    v_mul_f32 v195, v195, v20
    v_cvt_pk_bf16_f32 v96, v192, v193
    v_cvt_pk_bf16_f32 v97, v194, v195
    v_mul_f32 v196, v196, v20
    v_mul_f32 v197, v197, v20
    v_mul_f32 v198, v198, v20
    v_mul_f32 v199, v199, v20
    v_cvt_pk_bf16_f32 v98, v196, v197
    v_cvt_pk_bf16_f32 v99, v198, v199
    v_mul_f32 v200, v200, v20
    v_mul_f32 v201, v201, v20
    v_mul_f32 v202, v202, v20
    v_mul_f32 v203, v203, v20
    v_cvt_pk_bf16_f32 v100, v200, v201
    v_cvt_pk_bf16_f32 v101, v202, v203
    v_mul_f32 v204, v204, v20
    v_mul_f32 v205, v205, v20
    v_mul_f32 v206, v206, v20
    v_mul_f32 v207, v207, v20
    v_cvt_pk_bf16_f32 v102, v204, v205
    v_cvt_pk_bf16_f32 v103, v206, v207
    v_mul_f32 v208, v208, v20
    v_mul_f32 v209, v209, v20
    v_mul_f32 v210, v210, v20
    v_mul_f32 v211, v211, v20
    v_cvt_pk_bf16_f32 v104, v208, v209
    v_cvt_pk_bf16_f32 v105, v210, v211
    v_mul_f32 v212, v212, v20
    v_mul_f32 v213, v213, v20
    v_mul_f32 v214, v214, v20
    v_mul_f32 v215, v215, v20
    v_cvt_pk_bf16_f32 v106, v212, v213
    v_cvt_pk_bf16_f32 v107, v214, v215
    v_mul_f32 v216, v216, v20
    v_mul_f32 v217, v217, v20
    v_mul_f32 v218, v218, v20
    v_mul_f32 v219, v219, v20
    v_cvt_pk_bf16_f32 v108, v216, v217
    v_cvt_pk_bf16_f32 v109, v218, v219
    v_mul_f32 v220, v220, v20
    v_mul_f32 v221, v221, v20
    v_mul_f32 v222, v222, v20
    v_mul_f32 v223, v223, v20
    v_cvt_pk_bf16_f32 v110, v220, v221
    v_cvt_pk_bf16_f32 v111, v222, v223
    ds_write_b64 v9, v[96:97] offset:0
    ds_write_b64 v9, v[98:99] offset:32
    ds_write_b64 v9, v[100:101] offset:64
    ds_write_b64 v9, v[102:103] offset:96
    ds_write_b64 v9, v[104:105] offset:128
    ds_write_b64 v9, v[106:107] offset:160
    ds_write_b64 v9, v[108:109] offset:192
    ds_write_b64 v9, v[110:111] offset:224
    ds_read_b128 a[32:35], v10 offset:0
    ds_read_b128 a[36:39], v10 offset:1088
    ds_read_b128 a[40:43], v10 offset:2176
    ds_read_b128 a[44:47], v10 offset:3264
    s_waitcnt lgkmcnt(0)
    s_add_u32 s37, s32, 8192
    buffer_store_dwordx4 a[32:35], v11, s[24:27], s37 offen offset:0
    buffer_store_dwordx4 a[36:39], v11, s[24:27], s37 offen offset:1024
    buffer_store_dwordx4 a[40:43], v11, s[24:27], s37 offen offset:2048
    buffer_store_dwordx4 a[44:47], v11, s[24:27], s37 offen offset:3072
    v_accvgpr_read_b32 v22, a144
    v_rcp_f32 v22, v22
    s_nop 0
    v_mul_f32 v224, v224, v22
    v_mul_f32 v225, v225, v22
    v_mul_f32 v226, v226, v22
    v_mul_f32 v227, v227, v22
    v_cvt_pk_bf16_f32 v96, v224, v225
    v_cvt_pk_bf16_f32 v97, v226, v227
    v_mul_f32 v228, v228, v22
    v_mul_f32 v229, v229, v22
    v_mul_f32 v230, v230, v22
    v_mul_f32 v231, v231, v22
    v_cvt_pk_bf16_f32 v98, v228, v229
    v_cvt_pk_bf16_f32 v99, v230, v231
    v_mul_f32 v232, v232, v22
    v_mul_f32 v233, v233, v22
    v_mul_f32 v234, v234, v22
    v_mul_f32 v235, v235, v22
    v_cvt_pk_bf16_f32 v100, v232, v233
    v_cvt_pk_bf16_f32 v101, v234, v235
    v_mul_f32 v236, v236, v22
    v_mul_f32 v237, v237, v22
    v_mul_f32 v238, v238, v22
    v_mul_f32 v239, v239, v22
    v_cvt_pk_bf16_f32 v102, v236, v237
    v_cvt_pk_bf16_f32 v103, v238, v239
    v_mul_f32 v240, v240, v22
    v_mul_f32 v241, v241, v22
    v_mul_f32 v242, v242, v22
    v_mul_f32 v243, v243, v22
    v_cvt_pk_bf16_f32 v104, v240, v241
    v_cvt_pk_bf16_f32 v105, v242, v243
    v_mul_f32 v244, v244, v22
    v_mul_f32 v245, v245, v22
    v_mul_f32 v246, v246, v22
    v_mul_f32 v247, v247, v22
    v_cvt_pk_bf16_f32 v106, v244, v245
    v_cvt_pk_bf16_f32 v107, v246, v247
    v_mul_f32 v248, v248, v22
    v_mul_f32 v249, v249, v22
    v_mul_f32 v250, v250, v22
    v_mul_f32 v251, v251, v22
    v_cvt_pk_bf16_f32 v108, v248, v249
    v_cvt_pk_bf16_f32 v109, v250, v251
    v_mul_f32 v252, v252, v22
    v_mul_f32 v253, v253, v22
    v_mul_f32 v254, v254, v22
    v_mul_f32 v255, v255, v22
    v_cvt_pk_bf16_f32 v110, v252, v253
    v_cvt_pk_bf16_f32 v111, v254, v255
    ds_write_b64 v9, v[96:97] offset:0
    ds_write_b64 v9, v[98:99] offset:32
    ds_write_b64 v9, v[100:101] offset:64
    ds_write_b64 v9, v[102:103] offset:96
    ds_write_b64 v9, v[104:105] offset:128
    ds_write_b64 v9, v[106:107] offset:160
    ds_write_b64 v9, v[108:109] offset:192
    ds_write_b64 v9, v[110:111] offset:224
    ds_read_b128 a[48:51], v10 offset:0
    ds_read_b128 a[52:55], v10 offset:1088
    ds_read_b128 a[56:59], v10 offset:2176
    ds_read_b128 a[60:63], v10 offset:3264
    s_waitcnt lgkmcnt(0)
    s_add_u32 s37, s32, 12288
    buffer_store_dwordx4 a[48:51], v11, s[24:27], s37 offen offset:0
    buffer_store_dwordx4 a[52:55], v11, s[24:27], s37 offen offset:1024
    buffer_store_dwordx4 a[56:59], v11, s[24:27], s37 offen offset:2048
    buffer_store_dwordx4 a[60:63], v11, s[24:27], s37 offen offset:3072
    s_cmp_eq_u32 s51, 0
    s_cbranch_scc1 L_exact1
L_end:
    s_endpgm
.section .rodata,"a"
.p2align 6
.amdhsa_kernel standalone__mha_softmax__near_ridge_kernel
  .amdhsa_next_free_vgpr 472
  .amdhsa_next_free_sgpr 100
  .amdhsa_accum_offset 256
  .amdhsa_group_segment_fixed_size 0
  .amdhsa_kernarg_size 48
  .amdhsa_user_sgpr_count 2
  .amdhsa_user_sgpr_kernarg_segment_ptr 1
  .amdhsa_system_sgpr_workgroup_id_x 1
  .amdhsa_float_denorm_mode_32 3
.end_amdhsa_kernel
```
